```python
import torch

def _softmax(x, axis=-1):
    return torch.softmax(x, dim=axis)
def _gelu(x):
    return torch.nn.functional.gelu(x, approximate="tanh")
def _silu(x):
    return torch.nn.functional.silu(x)
def _sigmoid(x):
    return torch.sigmoid(x)
def _layernorm(x, axis=-1, eps=1e-5):
    m = x.mean(dim=axis, keepdim=True)
    v = x.var(dim=axis, keepdim=True, unbiased=False)
    return (x - m) / torch.sqrt(v + eps)
def _scatter_add(tgt, idx, src, axis=0):
    return tgt.clone().index_add_(axis, idx, src)
def _segment_sum(src, seg, n):
    out = torch.zeros((n,) + src.shape[1:], dtype=src.dtype)
    return out.index_add_(0, seg, src)
def _pad(x, pw):
    flat = tuple(v for pair in reversed(pw) for v in pair)
    return torch.nn.functional.pad(x, flat)

kernel_name = 'sequential_preLN__grouped_kv_mqa__geglu_ffn__prompt'

def setup_inputs():

    _w = (lambda a: (lambda t: t.to(torch.bfloat16) if t.is_floating_point() else t)(torch.as_tensor(a)))
    def _A_setup():
        B, S, D, H = 1, 2048, 1024, 32
        Dh = D // H
        return {
            "x": _w((lambda *s: torch.randn(*s, dtype=torch.bfloat16) * 0.05)(B, S, D)),
            "wq": _w((lambda *s: torch.randn(*s, dtype=torch.bfloat16) * 0.05)(D, H * Dh)),
            "wk": _w((lambda *s: torch.randn(*s, dtype=torch.bfloat16) * 0.05)(D, Dh)),
            "wv": _w((lambda *s: torch.randn(*s, dtype=torch.bfloat16) * 0.05)(D, Dh)),
            "wo": _w((lambda *s: torch.randn(*s, dtype=torch.bfloat16) * 0.05)(H * Dh, D)),
        }
    _A_in = _A_setup()

    def _B_setup():
        B, S, D, F = 1, 2048, 1024, 3584
        return {
            "x": _w((lambda *s: torch.randn(*s, dtype=torch.bfloat16) * 0.05)(B, S, D)),
            "w_gate": _w((lambda *s: torch.randn(*s, dtype=torch.bfloat16) * 0.05)(D, F)),
            "w_up": _w((lambda *s: torch.randn(*s, dtype=torch.bfloat16) * 0.05)(D, F)),
            "w_down": _w((lambda *s: torch.randn(*s, dtype=torch.bfloat16) * 0.05)(F, D)),
        }
    _B_in = _B_setup()

    return {
        "A_x": _A_in["x"],
        "A_wq": _A_in["wq"],
        "A_wk": _A_in["wk"],
        "A_wv": _A_in["wv"],
        "A_wo": _A_in["wo"],
        "B_x": _B_in["x"],
        "B_w_gate": _B_in["w_gate"],
        "B_w_up": _B_in["w_up"],
        "B_w_down": _B_in["w_down"],
    }

def reference(A_x, A_wq, A_wk, A_wv, A_wo, B_x, B_w_gate, B_w_up, B_w_down):
    def _A_ref(x, wq, wk, wv, wo):
        B, S, D = x.shape
        H = 32
        Dh = D // H
        q = (lambda x, *d: x.permute(*d))((x @ wq).reshape(B, S, H, Dh), 0, 2, 1, 3)
        k = x @ wk
        v = x @ wv
        scores = torch.einsum("bhqd,bkd->bhqk", q, k) * (Dh ** -0.5)
        p = _softmax(scores, axis=-1)
        o = torch.einsum("bhqk,bkd->bhqd", p, v)
        return (lambda x, *d: x.permute(*d))(o, 0, 2, 1, 3).reshape(B, S, H * Dh) @ wo

    def _B_ref(x, w_gate, w_up, w_down):
        return (_gelu(x @ w_gate) * (x @ w_up)) @ w_down

    x = A_x
    h = x + _A_ref(_layernorm(x, axis=-1), A_wq, A_wk, A_wv, A_wo)
    h2 = h + _B_ref(_layernorm(h, axis=-1), B_w_gate, B_w_up, B_w_down)
    return h2
```

```asm
; @launch kernel=k2_attn_kernel grid=(256,1,1) block=(512,1,1) lds=154880
; @launch kernel=k3_ffn_kernel grid=(256,1,1) block=(256,1,1) lds=122880
.amdgcn_target "amdgcn-amd-amdhsa--gfx950"
.text
.globl k2_attn_kernel
.p2align 8
.type k2_attn_kernel,@function
k2_attn_kernel:
    s_cmp_ge_u32 s2, 256
    s_cbranch_scc1 L_k2_attn_kernel_end
    s_load_dwordx2 s[4:5], s[0:1], 88
    s_load_dwordx2 s[80:81], s[0:1], 32
    s_load_dwordx4 s[84:87], s[0:1], 48
    s_load_dwordx2 s[88:89], s[0:1], 64
    s_load_dwordx2 s[98:99], s[0:1], 0
    s_load_dwordx2 s[60:61], s[0:1], 8
    s_load_dwordx4 s[40:43], s[0:1], 16
    s_load_dwordx2 s[100:101], s[0:1], 80
    v_lshrrev_b32 v4, 6, v0
    v_and_b32 v0, 63, v0
    s_and_b32 s25, s2, 7
    s_lshl_b32 s25, s25, 2
    s_bfe_u32 s33, s2, 0x20003
    s_add_u32 s25, s25, s33
    v_readfirstlane_b32 s24, v4
    s_lshr_b32 s26, s2, 5
    v_lshlrev_b32 v1, 4, v0
    s_and_b32 s33, s24, 3
    s_lshr_b32 s30, s24, 2
    s_lshl_b32 s27, s26, 2
    s_add_u32 s27, s27, s33
    s_lshl_b32 s29, s33, 12
    s_waitcnt lgkmcnt(0)
    v_mov_b32 v13, 60817408
    global_load_dword v14, v13, s[4:5] sc1
    s_add_u32 s46, s4, 61865984
    s_addc_u32 s47, s5, 0
    s_mul_i32 s33, s2, 768
    v_lshlrev_b32 v12, 7, v0
    v_add_u32 v12, s33, v12
    v_mov_b32 v11, 0
    s_mov_b64 exec, 63
    global_store_dword v12, v11, s[46:47]
    s_mov_b64 exec, -1
    s_mov_b32 s56, s60
    s_and_b32 s57, s61, 0xffff
    s_mov_b32 s58, 2097152
    s_mov_b32 s59, 0x20000
    v_lshrrev_b32 v4, 3, v0
    s_lshl_b32 s33, s24, 3
    v_add_u32 v4, s33, v4
    v_lshrrev_b32 v5, 1, v4
    v_and_b32 v5, 7, v5
    v_and_b32 v6, 7, v0
    v_xor_b32 v5, v5, v6
    v_lshlrev_b32 v4, 11, v4
    v_lshl_add_u32 v134, v5, 4, v4
    s_lshl_b32 s33, s25, 17
    v_add_u32 v134, s33, v134
    s_lshl_b32 s91, s24, 10
    s_add_u32 s47, s91, 40960
    s_add_u32 s91, s91, 32768
    v_bfe_u32 v5, v0, 4, 1
    v_lshlrev_b32 v5, 2, v5
    v_xor_b32 v5, v5, v6
    v_lshrrev_b32 v4, 3, v0
    s_lshl_b32 s33, s24, 3
    v_add_u32 v4, s33, v4
    v_lshlrev_b32 v4, 11, v4
    v_lshl_add_u32 v4, v5, 4, v4
    s_lshl_b32 s33, s26, 8
    v_add_u32 v135, s33, v4
    v_add_u32 v136, 128, v135
    s_and_b32 s90, s25, 15
    s_mov_b32 s45, 0
    s_lshl_b32 s62, s90, 7
    s_lshl_b32 s63, s90, 17
    s_lshr_b32 s31, s2, 1
    s_and_b32 s32, s2, 1
    s_mov_b32 s8, s98
    s_and_b32 s9, s99, 0xffff
    s_mov_b32 s10, 4194304
    s_mov_b32 s11, 0x20000
    v_lshrrev_b32 v2, 4, v0
    v_and_b32 v3, 15, v0
    s_lshl_b32 s33, s31, 15
    s_lshl_b32 s34, s24, 8
    s_add_u32 s33, s33, s34
    s_lshl_b32 s35, s24, 12
    v_add_u32 v4, 0, v2
    v_xor_b32 v5, v4, v3
    v_lshlrev_b32 v5, 4, v5
    v_lshl_add_u32 v5, v4, 11, v5
    s_add_u32 m0, s35, 0
    s_nop 0
    buffer_load_dwordx4 v5, s[8:11], s33 offen lds
    v_add_u32 v4, 4, v2
    v_xor_b32 v5, v4, v3
    v_lshlrev_b32 v5, 4, v5
    v_lshl_add_u32 v5, v4, 11, v5
    s_add_u32 m0, s35, 1024
    s_nop 0
    buffer_load_dwordx4 v5, s[8:11], s33 offen lds
    v_add_u32 v4, 8, v2
    v_xor_b32 v5, v4, v3
    v_lshlrev_b32 v5, 4, v5
    v_lshl_add_u32 v5, v4, 11, v5
    s_add_u32 m0, s35, 2048
    s_nop 0
    buffer_load_dwordx4 v5, s[8:11], s33 offen lds
    v_add_u32 v4, 12, v2
    v_xor_b32 v5, v4, v3
    v_lshlrev_b32 v5, 4, v5
    v_lshl_add_u32 v5, v4, 11, v5
    s_add_u32 m0, s35, 3072
    s_nop 0
    buffer_load_dwordx4 v5, s[8:11], s33 offen lds
    s_cmp_eq_u32 s32, 0
    s_cselect_b32 s6, s40, s42
    s_cselect_b32 s7, s41, s43
    s_mov_b32 s12, s6
    s_and_b32 s13, s7, 0xffff
    s_mov_b32 s14, 65536
    s_mov_b32 s15, 0x20000
    v_bfe_u32 v4, v0, 1, 1
    v_lshrrev_b32 v5, 5, v0
    v_xor_b32 v4, v4, v5
    v_and_b32 v5, 1, v0
    v_lshl_or_b32 v4, v4, 1, v5
    v_lshrrev_b32 v5, 2, v0
    v_lshlrev_b32 v5, 6, v5
    v_lshl_add_u32 v6, v4, 4, v5
    s_lshl_b32 s34, s24, 13
    s_mov_b32 s39, s34
    v_mov_b32 v15, v6
    s_add_u32 m0, s39, 32768
    s_add_u32 s36, s39, 0
    buffer_load_dwordx4 v15, s[12:15], s36 offen offset:0 lds
    buffer_load_dwordx4 v15, s[12:15], s36 offen offset:1024 lds
    buffer_load_dwordx4 v15, s[12:15], s36 offen offset:2048 lds
    buffer_load_dwordx4 v15, s[12:15], s36 offen offset:3072 lds
    s_and_b32 s33, s24, 3
    s_add_u32 s33, s33, s30
    s_and_b32 s95, s33, 3
    v_and_b32 v4, 31, v0
    v_lshrrev_b32 v5, 1, v4
    v_and_b32 v5, 7, v5
    v_lshrrev_b32 v6, 5, v0
    v_xor_b32 v5, v5, v6
    v_lshlrev_b32 v5, 4, v5
    v_lshl_add_u32 v5, v4, 7, v5
    s_lshl_b32 s33, s30, 12
    s_add_u32 s33, s33, 32768
    v_add_u32 v7, s33, v5
    v_bfe_u32 v5, v0, 2, 2
    v_lshl_add_u32 v6, v6, 3, v5
    v_lshlrev_b32 v6, 7, v6
    v_bfe_u32 v4, v0, 4, 1
    s_and_b32 s33, s24, 1
    s_lshl_b32 s33, s33, 1
    v_or_b32 v4, s33, v4
    v_lshrrev_b32 v5, 1, v5
    v_lshlrev_b32 v5, 1, v5
    v_xor_b32 v4, v4, v5
    v_lshl_add_u32 v6, v4, 5, v6
    v_and_b32 v4, 3, v0
    v_lshl_add_u32 v6, v4, 3, v6
    s_bfe_u32 s33, s24, 0x10001
    s_lshl_b32 s33, s33, 13
    s_add_u32 s33, s33, 40960
    v_add_u32 v6, s33, v6
    s_add_u32 s33, s95, 0
    s_and_b32 s33, s33, 3
    s_lshl_b32 s34, s33, 5
    v_xor_b32 v137, s34, v7
    v_add_u32 v141, 49152, v137
    s_lshl_b32 s34, s33, 11
    v_add_u32 v145, s34, v6
    v_add_u32 v149, 49152, v145
    s_add_u32 s33, s95, 1
    s_and_b32 s33, s33, 3
    s_lshl_b32 s34, s33, 5
    v_xor_b32 v138, s34, v7
    v_add_u32 v142, 49152, v138
    s_lshl_b32 s34, s33, 11
    v_add_u32 v146, s34, v6
    v_add_u32 v150, 49152, v146
    s_add_u32 s33, s95, 2
    s_and_b32 s33, s33, 3
    s_lshl_b32 s34, s33, 5
    v_xor_b32 v139, s34, v7
    v_add_u32 v143, 49152, v139
    s_lshl_b32 s34, s33, 11
    v_add_u32 v147, s34, v6
    v_add_u32 v151, 49152, v147
    s_add_u32 s33, s95, 3
    s_and_b32 s33, s33, 3
    s_lshl_b32 s34, s33, 5
    v_xor_b32 v140, s34, v7
    v_add_u32 v144, 49152, v140
    s_lshl_b32 s34, s33, 11
    v_add_u32 v148, s34, v6
    v_add_u32 v152, 49152, v148
    v_mov_b64 v[156:157], 0
    v_mov_b64 v[158:159], 0
    v_lshrrev_b32 v4, 4, v0
    v_lshrrev_b32 v5, 2, v0
    v_xor_b32 v4, v4, v5
    v_and_b32 v4, 1, v4
    v_mov_b32 v5, 0x3f803f80
    v_cmp_eq_u32 vcc, 0, v4
    s_nop 1
    v_cndmask_b32 v172, 0, v5, vcc
    v_mov_b32 v173, v172
    v_mov_b32 v174, v172
    v_mov_b32 v175, v172
    v_mov_b32 v112, 0x3f803f80
    v_mov_b32 v113, 0x3f803f80
    v_mov_b32 v114, 0x3f803f80
    v_mov_b32 v115, 0x3f803f80
    v_mov_b64 v[96:97], 0
    v_mov_b64 v[116:117], 0
    v_mov_b64 v[98:99], 0
    v_mov_b64 v[118:119], 0
    v_mov_b64 v[100:101], 0
    v_mov_b64 v[120:121], 0
    v_mov_b64 v[102:103], 0
    v_mov_b64 v[122:123], 0
    v_and_b32 v2, 15, v0
    v_lshrrev_b32 v3, 4, v0
    v_xor_b32 v4, v2, v3
    v_lshlrev_b32 v4, 4, v4
    v_lshl_add_u32 v4, v2, 8, v4
    v_add_u32 v4, s35, v4
    s_waitcnt vmcnt(4)
    s_cmp_lg_u32 s2, 0
    s_cbranch_scc1 L_k2_attn_kernel_nononce
    s_cmp_lg_u32 s24, 0
    s_cbranch_scc1 L_k2_attn_kernel_nononce
    v_add_u32 v14, 1, v14
    v_max_u32 v14, 1, v14
    global_store_dword v13, v14, s[4:5] sc1
    v_mov_b32 v13, 0
    global_store_dword v13, v14, s[100:101] sc1
L_k2_attn_kernel_nononce:
    v_xor_b32 v5, 0, v4
    ds_read_b128 v[16:19], v5
    v_xor_b32 v5, 64, v4
    ds_read_b128 v[20:23], v5
    v_xor_b32 v5, 128, v4
    ds_read_b128 v[24:27], v5
    v_xor_b32 v5, 192, v4
    ds_read_b128 v[28:31], v5
    s_waitcnt lgkmcnt(3)
    v_mfma_f32_16x16x32_bf16 v[96:99], v[112:115], v[16:19], v[96:99]
    v_mfma_f32_16x16x32_bf16 v[100:103], v[16:19], v[16:19], v[100:103]
    s_waitcnt lgkmcnt(2)
    v_mfma_f32_16x16x32_bf16 v[96:99], v[112:115], v[20:23], v[96:99]
    v_mfma_f32_16x16x32_bf16 v[100:103], v[20:23], v[20:23], v[100:103]
    s_waitcnt lgkmcnt(1)
    v_mfma_f32_16x16x32_bf16 v[96:99], v[112:115], v[24:27], v[96:99]
    v_mfma_f32_16x16x32_bf16 v[100:103], v[24:27], v[24:27], v[100:103]
    s_waitcnt lgkmcnt(0)
    v_mfma_f32_16x16x32_bf16 v[96:99], v[112:115], v[28:31], v[96:99]
    v_mfma_f32_16x16x32_bf16 v[100:103], v[28:31], v[28:31], v[100:103]
    s_add_u32 m0, s39, 36864
    s_add_u32 s36, s39, 4096
    buffer_load_dwordx4 v15, s[12:15], s36 offen offset:0 lds
    buffer_load_dwordx4 v15, s[12:15], s36 offen offset:1024 lds
    buffer_load_dwordx4 v15, s[12:15], s36 offen offset:2048 lds
    buffer_load_dwordx4 v15, s[12:15], s36 offen offset:3072 lds
    s_mov_b32 s20, s80
    s_and_b32 s21, s81, 0xffff
    s_mov_b32 s22, 2097152
    s_mov_b32 s23, 0x20000
    s_lshl_b32 s38, s2, 2
    s_and_b32 s33, s24, 3
    s_add_u32 s38, s38, s33
    s_lshl_b32 s33, s38, 11
    s_cmp_ge_u32 s24, 4
    s_cselect_b32 s33, s33, 0x7ff00000
    v_lshlrev_b32 v4, 5, v0
    buffer_load_dwordx4 v[124:127], v4, s[20:23], s33 offen
    buffer_load_dwordx4 v[128:131], v4, s[20:23], s33 offen offset:16
    s_mov_b32 s20, s60
    s_and_b32 s21, s61, 0xffff
    s_mov_b32 s22, 2097152
    s_mov_b32 s23, 0x20000
    v_lshlrev_b32 v4, 7, v0
    s_mov_b64 exec, 0xffff
    buffer_load_dword v12, v4, s[20:23], s33 offen
    s_mov_b64 exec, -1
    v_and_b32 v5, 3, v0
    v_bfe_u32 v6, v0, 2, 2
    v_cmp_eq_u32 s[34:35], v6, v3
    v_cmp_eq_u32 s[36:37], 1, v5
    v_cmp_eq_u32 s[42:43], 2, v5
    v_cmp_eq_u32 s[96:97], 3, v5
    s_nop 3
    v_cndmask_b32 v7, v100, v101, s[36:37]
    v_cndmask_b32 v7, v7, v102, s[42:43]
    v_cndmask_b32 v7, v7, v103, s[96:97]
    v_cndmask_b32 v7, 0, v7, s[34:35]
    v_mov_b32 v8, v7
    s_nop 1
    v_permlane16_swap_b32 v7, v8
    v_add_f32 v7, v7, v8
    v_mov_b32 v8, v7
    s_nop 1
    v_permlane32_swap_b32 v7, v8
    v_add_f32 v7, v7, v8
    v_mov_b32 v6, v96
    s_lshl_b32 s33, s24, 7
    s_add_u32 s33, s33, 131072
    v_lshlrev_b32 v8, 3, v2
    v_add_u32 v9, s33, v8
    ds_write_b64 v9, v[6:7]
    s_waitcnt lgkmcnt(0)
    s_barrier
    v_add_u32 v9, 131072, v8
    ds_read_b64 v[96:97], v9 offset:0
    ds_read_b64 v[98:99], v9 offset:128
    ds_read_b64 v[100:101], v9 offset:256
    ds_read_b64 v[102:103], v9 offset:384
    ds_read_b64 v[104:105], v9 offset:512
    ds_read_b64 v[106:107], v9 offset:640
    ds_read_b64 v[108:109], v9 offset:768
    ds_read_b64 v[110:111], v9 offset:896
    v_lshrrev_b32 v6, 4, v0
    v_bfe_u32 v7, v0, 2, 2
    v_lshl_add_u32 v7, v6, 3, v7
    v_lshlrev_b32 v7, 6, v7
    v_and_b32 v8, 3, v0
    v_lshl_add_u32 v7, v8, 3, v7
    v_and_b32 v6, 1, v6
    v_lshl_add_u32 v7, v6, 5, v7
    s_lshl_b32 s33, s24, 13
    s_add_u32 s33, s33, 32768
    v_add_u32 v7, s33, v7
    v_xor_b32 v8, 32, v7
    v_mov_b32 v132, v7
    s_waitcnt lgkmcnt(0)
    v_add_f32 v96, v96, v104
    v_add_f32 v97, v97, v105
    v_add_f32 v98, v98, v106
    v_add_f32 v99, v99, v107
    v_add_f32 v100, v100, v108
    v_add_f32 v101, v101, v109
    v_add_f32 v102, v102, v110
    v_add_f32 v103, v103, v111
    v_add_f32 v96, v96, v100
    v_add_f32 v97, v97, v101
    v_add_f32 v98, v98, v102
    v_add_f32 v99, v99, v103
    v_add_f32 v96, v96, v98
    v_add_f32 v97, v97, v99
    v_mul_f32 v98, 0x3a800000, v96
    v_mul_f32 v6, 0x3a800000, v97
    v_fma_f32 v6, -v98, v98, v6
    v_max_f32 v6, 0, v6
    v_add_f32 v6, 0x3727c5ac, v6
    v_rsq_f32 v99, v6
    s_nop 0
    v_mul_f32 v100, v98, v99
    v_lshlrev_b32 v10, 16, v16
    v_and_b32 v11, 0xffff0000, v16
    v_fma_f32 v10, v10, v99, -v100
    v_fma_f32 v11, v11, v99, -v100
    v_cvt_pk_bf16_f32 v16, v10, v11
    v_lshlrev_b32 v10, 16, v17
    v_and_b32 v11, 0xffff0000, v17
    v_fma_f32 v10, v10, v99, -v100
    v_fma_f32 v11, v11, v99, -v100
    v_cvt_pk_bf16_f32 v17, v10, v11
    v_lshlrev_b32 v10, 16, v18
    v_and_b32 v11, 0xffff0000, v18
    v_fma_f32 v10, v10, v99, -v100
    v_fma_f32 v11, v11, v99, -v100
    v_cvt_pk_bf16_f32 v18, v10, v11
    v_lshlrev_b32 v10, 16, v19
    v_and_b32 v11, 0xffff0000, v19
    v_fma_f32 v10, v10, v99, -v100
    v_fma_f32 v11, v11, v99, -v100
    v_cvt_pk_bf16_f32 v19, v10, v11
    v_lshlrev_b32 v10, 16, v20
    v_and_b32 v11, 0xffff0000, v20
    v_fma_f32 v10, v10, v99, -v100
    v_fma_f32 v11, v11, v99, -v100
    v_cvt_pk_bf16_f32 v20, v10, v11
    v_lshlrev_b32 v10, 16, v21
    v_and_b32 v11, 0xffff0000, v21
    v_fma_f32 v10, v10, v99, -v100
    v_fma_f32 v11, v11, v99, -v100
    v_cvt_pk_bf16_f32 v21, v10, v11
    v_lshlrev_b32 v10, 16, v22
    v_and_b32 v11, 0xffff0000, v22
    v_fma_f32 v10, v10, v99, -v100
    v_fma_f32 v11, v11, v99, -v100
    v_cvt_pk_bf16_f32 v22, v10, v11
    v_lshlrev_b32 v10, 16, v23
    v_and_b32 v11, 0xffff0000, v23
    v_fma_f32 v10, v10, v99, -v100
    v_fma_f32 v11, v11, v99, -v100
    v_cvt_pk_bf16_f32 v23, v10, v11
    v_lshlrev_b32 v10, 16, v24
    v_and_b32 v11, 0xffff0000, v24
    v_fma_f32 v10, v10, v99, -v100
    v_fma_f32 v11, v11, v99, -v100
    v_cvt_pk_bf16_f32 v24, v10, v11
    v_lshlrev_b32 v10, 16, v25
    v_and_b32 v11, 0xffff0000, v25
    v_fma_f32 v10, v10, v99, -v100
    v_fma_f32 v11, v11, v99, -v100
    v_cvt_pk_bf16_f32 v25, v10, v11
    v_lshlrev_b32 v10, 16, v26
    v_and_b32 v11, 0xffff0000, v26
    v_fma_f32 v10, v10, v99, -v100
    v_fma_f32 v11, v11, v99, -v100
    v_cvt_pk_bf16_f32 v26, v10, v11
    v_lshlrev_b32 v10, 16, v27
    v_and_b32 v11, 0xffff0000, v27
    v_fma_f32 v10, v10, v99, -v100
    v_fma_f32 v11, v11, v99, -v100
    v_cvt_pk_bf16_f32 v27, v10, v11
    v_lshlrev_b32 v10, 16, v28
    v_and_b32 v11, 0xffff0000, v28
    v_fma_f32 v10, v10, v99, -v100
    v_fma_f32 v11, v11, v99, -v100
    v_cvt_pk_bf16_f32 v28, v10, v11
    v_lshlrev_b32 v10, 16, v29
    v_and_b32 v11, 0xffff0000, v29
    v_fma_f32 v10, v10, v99, -v100
    v_fma_f32 v11, v11, v99, -v100
    v_cvt_pk_bf16_f32 v29, v10, v11
    v_lshlrev_b32 v10, 16, v30
    v_and_b32 v11, 0xffff0000, v30
    v_fma_f32 v10, v10, v99, -v100
    v_fma_f32 v11, v11, v99, -v100
    v_cvt_pk_bf16_f32 v30, v10, v11
    v_lshlrev_b32 v10, 16, v31
    v_and_b32 v11, 0xffff0000, v31
    v_fma_f32 v10, v10, v99, -v100
    v_fma_f32 v11, v11, v99, -v100
    v_cvt_pk_bf16_f32 v31, v10, v11
    s_lshl_b32 s33, s31, 7
    s_or_b32 s34, s32, s24
    s_cmp_eq_u32 s34, 0
    s_cselect_b32 s33, s33, 0x7ff00000
    s_add_u32 s16, s4, 4460544
    s_addc_u32 s17, s5, 0
    s_and_b32 s17, s17, 0xffff
    s_mov_b32 s18, 16384
    s_mov_b32 s19, 0x20000
    v_lshlrev_b32 v6, 3, v2
    buffer_store_dwordx2 v[98:99], v6, s[16:19], s33 offen sc1
    v_xor_b32 v11, 32, v132
    s_waitcnt vmcnt(4)
    ds_read_b64_tr_b16 v[32:33], v132 offset:0
    ds_read_b64_tr_b16 v[34:35], v132 offset:256
    ds_read_b64_tr_b16 v[48:49], v11 offset:0
    ds_read_b64_tr_b16 v[50:51], v11 offset:256
    ds_read_b64_tr_b16 v[36:37], v132 offset:2048
    ds_read_b64_tr_b16 v[38:39], v132 offset:2304
    ds_read_b64_tr_b16 v[52:53], v11 offset:2048
    ds_read_b64_tr_b16 v[54:55], v11 offset:2304
    ds_read_b64_tr_b16 v[40:41], v132 offset:4096
    ds_read_b64_tr_b16 v[42:43], v132 offset:4352
    ds_read_b64_tr_b16 v[56:57], v11 offset:4096
    ds_read_b64_tr_b16 v[58:59], v11 offset:4352
    ds_read_b64_tr_b16 v[44:45], v132 offset:6144
    ds_read_b64_tr_b16 v[46:47], v132 offset:6400
    ds_read_b64_tr_b16 v[60:61], v11 offset:6144
    ds_read_b64_tr_b16 v[62:63], v11 offset:6400
    s_waitcnt lgkmcnt(0)
    v_mfma_f32_16x16x32_bf16 v[116:119], v[32:35], v[16:19], v[116:119]
    v_mfma_f32_16x16x32_bf16 v[120:123], v[48:51], v[16:19], v[120:123]
    v_mfma_f32_16x16x32_bf16 v[116:119], v[36:39], v[20:23], v[116:119]
    v_mfma_f32_16x16x32_bf16 v[120:123], v[52:55], v[20:23], v[120:123]
    v_mfma_f32_16x16x32_bf16 v[116:119], v[40:43], v[24:27], v[116:119]
    v_mfma_f32_16x16x32_bf16 v[120:123], v[56:59], v[24:27], v[120:123]
    v_mfma_f32_16x16x32_bf16 v[116:119], v[44:47], v[28:31], v[116:119]
    v_mfma_f32_16x16x32_bf16 v[120:123], v[60:63], v[28:31], v[120:123]
    s_lshl_b32 s33, s24, 11
    s_add_u32 s33, s33, 0
    v_lshlrev_b32 v6, 4, v0
    v_add_u32 v7, s33, v6
    s_nop 4
    ds_write_b128 v7, v[116:119] offset:0
    ds_write_b128 v7, v[120:123] offset:1024
    s_waitcnt lgkmcnt(0)
    s_barrier
    s_mov_b32 s20, s100
    s_and_b32 s21, s101, 0xffff
    s_mov_b32 s22, 256
    s_mov_b32 s23, 0x20000
    v_mov_b32 v13, 0
    buffer_load_dword v14, v13, s[20:23], 0 offen sc1
    s_mov_b32 s12, s98
    s_and_b32 s13, s99, 0xffff
    s_mov_b32 s14, 4194304
    s_mov_b32 s15, 0x20000
    s_add_u32 m0, s91, 0
    s_nop 0
    buffer_load_dwordx4 v134, s[12:15], s62 offen lds
    s_add_u32 m0, s47, 0
    s_add_u32 s90, s90, 1
    s_and_b32 s90, s90, 15
    s_add_u32 s45, s45, 1
    buffer_load_dwordx4 v135, s[56:59], s63 offen lds
    s_add_u32 m0, s47, 8192
    s_nop 0
    buffer_load_dwordx4 v136, s[56:59], s63 offen lds
    s_lshl_b32 s62, s90, 7
    s_lshl_b32 s63, s90, 17
    s_cmp_lt_u32 s45, 16
    s_cselect_b32 s62, s62, 0x7ff00000
    s_cselect_b32 s63, s63, 0x7ff00000
    s_add_u32 m0, s91, 24576
    s_nop 0
    buffer_load_dwordx4 v134, s[12:15], s62 offen lds
    s_add_u32 m0, s47, 24576
    s_add_u32 s90, s90, 1
    s_and_b32 s90, s90, 15
    s_add_u32 s45, s45, 1
    buffer_load_dwordx4 v135, s[56:59], s63 offen lds
    s_add_u32 m0, s47, 32768
    s_nop 0
    buffer_load_dwordx4 v136, s[56:59], s63 offen lds
    s_lshl_b32 s62, s90, 7
    s_lshl_b32 s63, s90, 17
    s_cmp_lt_u32 s45, 16
    s_cselect_b32 s62, s62, 0x7ff00000
    s_cselect_b32 s63, s63, 0x7ff00000
    s_cmp_lg_u32 s24, 0
    s_cbranch_scc1 L_k2_attn_kernel_wbar
    ds_read_b128 v[32:35], v6 offset:2048
    ds_read_b128 v[36:39], v6 offset:3072
    ds_read_b128 v[40:43], v6 offset:4096
    ds_read_b128 v[44:47], v6 offset:5120
    ds_read_b128 v[48:51], v6 offset:6144
    ds_read_b128 v[52:55], v6 offset:7168
    ds_read_b128 v[56:59], v6 offset:8192
    ds_read_b128 v[60:63], v6 offset:9216
    ds_read_b128 v[64:67], v6 offset:10240
    ds_read_b128 v[68:71], v6 offset:11264
    ds_read_b128 v[72:75], v6 offset:12288
    ds_read_b128 v[76:79], v6 offset:13312
    ds_read_b128 v[80:83], v6 offset:14336
    ds_read_b128 v[84:87], v6 offset:15360
    s_waitcnt lgkmcnt(12)
    v_add_f32 v116, v116, v32
    v_add_f32 v117, v117, v33
    v_add_f32 v118, v118, v34
    v_add_f32 v119, v119, v35
    v_add_f32 v120, v120, v36
    v_add_f32 v121, v121, v37
    v_add_f32 v122, v122, v38
    v_add_f32 v123, v123, v39
    s_waitcnt lgkmcnt(10)
    v_add_f32 v116, v116, v40
    v_add_f32 v117, v117, v41
    v_add_f32 v118, v118, v42
    v_add_f32 v119, v119, v43
    v_add_f32 v120, v120, v44
    v_add_f32 v121, v121, v45
    v_add_f32 v122, v122, v46
    v_add_f32 v123, v123, v47
    s_waitcnt lgkmcnt(8)
    v_add_f32 v116, v116, v48
    v_add_f32 v117, v117, v49
    v_add_f32 v118, v118, v50
    v_add_f32 v119, v119, v51
    v_add_f32 v120, v120, v52
    v_add_f32 v121, v121, v53
    v_add_f32 v122, v122, v54
    v_add_f32 v123, v123, v55
    s_waitcnt lgkmcnt(6)
    v_add_f32 v116, v116, v56
    v_add_f32 v117, v117, v57
    v_add_f32 v118, v118, v58
    v_add_f32 v119, v119, v59
    v_add_f32 v120, v120, v60
    v_add_f32 v121, v121, v61
    v_add_f32 v122, v122, v62
    v_add_f32 v123, v123, v63
    s_waitcnt lgkmcnt(4)
    v_add_f32 v116, v116, v64
    v_add_f32 v117, v117, v65
    v_add_f32 v118, v118, v66
    v_add_f32 v119, v119, v67
    v_add_f32 v120, v120, v68
    v_add_f32 v121, v121, v69
    v_add_f32 v122, v122, v70
    v_add_f32 v123, v123, v71
    s_waitcnt lgkmcnt(2)
    v_add_f32 v116, v116, v72
    v_add_f32 v117, v117, v73
    v_add_f32 v118, v118, v74
    v_add_f32 v119, v119, v75
    v_add_f32 v120, v120, v76
    v_add_f32 v121, v121, v77
    v_add_f32 v122, v122, v78
    v_add_f32 v123, v123, v79
    s_waitcnt lgkmcnt(0)
    v_add_f32 v116, v116, v80
    v_add_f32 v117, v117, v81
    v_add_f32 v118, v118, v82
    v_add_f32 v119, v119, v83
    v_add_f32 v120, v120, v84
    v_add_f32 v121, v121, v85
    v_add_f32 v122, v122, v86
    v_add_f32 v123, v123, v87
    v_mul_f32 v32, v116, v116
    v_fmac_f32 v32, v117, v117
    v_fmac_f32 v32, v118, v118
    v_fmac_f32 v32, v119, v119
    v_fmac_f32 v32, v120, v120
    v_fmac_f32 v32, v121, v121
    v_fmac_f32 v32, v122, v122
    v_fmac_f32 v32, v123, v123
    v_cvt_pk_bf16_f32 v116, v116, v117
    v_cvt_pk_bf16_f32 v117, v118, v119
    v_cvt_pk_bf16_f32 v120, v120, v121
    v_cvt_pk_bf16_f32 v121, v122, v123
    s_add_u32 s16, s4, 4194304
    s_addc_u32 s17, s5, 0
    s_and_b32 s17, s17, 0xffff
    s_mov_b32 s18, 262144
    s_mov_b32 s19, 0x20000
    s_lshr_b32 s33, s31, 1
    s_lshl_b32 s33, s33, 12
    s_and_b32 s34, s31, 1
    s_cmp_lg_u32 s32, 0
    s_cbranch_scc1 L_k2_attn_kernel_isv
    s_lshl_b32 s34, s34, 8
    s_add_u32 s33, s33, s34
    v_bfe_u32 v6, v0, 4, 1
    v_lshlrev_b32 v6, 9, v6
    v_lshrrev_b32 v7, 5, v0
    v_lshl_add_u32 v6, v7, 3, v6
    v_lshl_add_u32 v6, v2, 4, v6
    buffer_store_dwordx2 v[116:117], v6, s[16:19], s33 offen offset:0 sc1
    buffer_store_dwordx2 v[120:121], v6, s[16:19], s33 offen offset:1024 sc1
    s_branch L_k2_attn_kernel_nrm
L_k2_attn_kernel_isv:
    s_lshl_b32 s34, s34, 10
    s_add_u32 s33, s33, s34
    s_add_u32 s33, s33, 2048
    v_bfe_u32 v6, v0, 2, 1
    v_lshlrev_b32 v7, 9, v6
    v_lshrrev_b32 v6, 4, v0
    v_lshl_add_u32 v7, v6, 6, v7
    v_bfe_u32 v6, v0, 3, 1
    v_lshl_add_u32 v7, v6, 3, v7
    v_and_b32 v6, 3, v0
    v_lshl_add_u32 v7, v6, 1, v7
    buffer_store_short v116, v7, s[16:19], s33 offen offset:0 sc1
    buffer_store_short_d16_hi v116, v7, s[16:19], s33 offen offset:16 sc1
    buffer_store_short v117, v7, s[16:19], s33 offen offset:32 sc1
    buffer_store_short_d16_hi v117, v7, s[16:19], s33 offen offset:48 sc1
    buffer_store_short v120, v7, s[16:19], s33 offen offset:256 sc1
    buffer_store_short_d16_hi v120, v7, s[16:19], s33 offen offset:272 sc1
    buffer_store_short v121, v7, s[16:19], s33 offen offset:288 sc1
    buffer_store_short_d16_hi v121, v7, s[16:19], s33 offen offset:304 sc1
L_k2_attn_kernel_nrm:
    v_mov_b32 v8, v32
    s_nop 1
    v_permlane16_swap_b32 v32, v8
    v_add_f32 v32, v32, v8
    v_mov_b32 v8, v32
    s_nop 1
    v_permlane32_swap_b32 v32, v8
    v_add_f32 v32, v32, v8
    s_nop 1
    v_max_f32_dpp v32, v32, v32 row_ror:8 row_mask:0xf bank_mask:0xf
    s_nop 1
    v_max_f32_dpp v32, v32, v32 row_ror:4 row_mask:0xf bank_mask:0xf
    s_nop 1
    v_max_f32_dpp v32, v32, v32 row_ror:2 row_mask:0xf bank_mask:0xf
    s_nop 1
    v_max_f32_dpp v32, v32, v32 row_ror:1 row_mask:0xf bank_mask:0xf
    s_add_u32 s20, s4, 4456448
    s_addc_u32 s21, s5, 0
    s_and_b32 s21, s21, 0xffff
    s_mov_b32 s22, 1024
    s_mov_b32 s23, 0x20000
    s_lshl_b32 s33, s32, 7
    s_add_u32 s33, s33, s31
    s_lshl_b32 s33, s33, 2
    v_mov_b32 v6, 0
    buffer_store_dword v32, v6, s[20:23], s33 offen sc1
    s_branch L_k2_attn_kernel_adone
L_k2_attn_kernel_wbar:
    s_cmp_lt_u32 s24, 4
    s_cbranch_scc1 L_k2_attn_kernel_adone
    s_waitcnt vmcnt(0)
    v_mov_b32 v2, 0
    v_dot2c_f32_bf16 v2, v124, v112
    v_dot2c_f32_bf16 v2, v125, v112
    v_dot2c_f32_bf16 v2, v126, v112
    v_dot2c_f32_bf16 v2, v127, v112
    v_dot2c_f32_bf16 v2, v128, v112
    v_dot2c_f32_bf16 v2, v129, v112
    v_dot2c_f32_bf16 v2, v130, v112
    v_dot2c_f32_bf16 v2, v131, v112
    s_nop 2
    v_add_f32_dpp v2, v2, v2 row_ror:8 row_mask:0xf bank_mask:0xf
    s_nop 1
    v_add_f32_dpp v2, v2, v2 row_ror:4 row_mask:0xf bank_mask:0xf
    s_nop 1
    v_add_f32_dpp v2, v2, v2 row_ror:2 row_mask:0xf bank_mask:0xf
    s_nop 1
    v_add_f32_dpp v2, v2, v2 row_ror:1 row_mask:0xf bank_mask:0xf
    s_nop 1
    v_mov_b32 v3, v2
    s_nop 1
    v_permlane16_swap_b32 v2, v3
    v_add_f32 v2, v2, v3
    v_mov_b32 v3, v2
    s_nop 1
    v_permlane32_swap_b32 v2, v3
    v_add_f32 v2, v2, v3
    v_mul_f32 v2, 0x3a800000, v2
    v_cvt_pk_bf16_f32 v3, v2, v2
    v_lshlrev_b32 v4, 16, v3
    v_sub_f32 v4, v2, v4
    v_cvt_pk_bf16_f32 v4, v4, v4
    s_lshr_b32 s33, s38, 5
    s_lshl_b32 s33, s33, 7
    s_bfe_u32 s34, s38, 0x10004
    s_lshl_b32 s34, s34, 5
    s_add_u32 s33, s33, s34
    s_bfe_u32 s34, s38, 0x10002
    s_lshl_b32 s34, s34, 4
    s_add_u32 s33, s33, s34
    s_bfe_u32 s34, s38, 0x10003
    s_lshl_b32 s34, s34, 3
    s_add_u32 s33, s33, s34
    s_and_b32 s34, s38, 3
    s_lshl_b32 s34, s34, 1
    s_add_u32 s33, s33, s34
    s_add_u32 s20, s4, 4476928
    s_addc_u32 s21, s5, 0
    s_and_b32 s21, s21, 0xffff
    s_mov_b32 s22, 4096
    s_mov_b32 s23, 0x20000
    v_mov_b32 v5, 0
    buffer_store_short v3, v5, s[20:23], s33 offen
    buffer_store_short v4, v5, s[20:23], s33 offen offset:64
L_k2_attn_kernel_adone:
    v_mov_b64 v[28:29], 0
    v_mov_b64 v[30:31], 0
    v_mov_b64 v[32:33], 0
    v_mov_b64 v[34:35], 0
    v_mov_b64 v[36:37], 0
    v_mov_b64 v[38:39], 0
    v_mov_b64 v[40:41], 0
    v_mov_b64 v[42:43], 0
    s_waitcnt vmcnt(0)
    v_readfirstlane_b32 s94, v14
    s_mov_b32 s37, 0x8000
    s_cmp_lg_u32 s94, 0
    s_cbranch_scc1 L_k2_attn_kernel_gnx
    s_mov_b32 s20, s100
    s_and_b32 s21, s101, 0xffff
    s_mov_b32 s22, 256
    s_mov_b32 s23, 0x20000
L_k2_attn_kernel_gn:
    buffer_load_dword v14, v13, s[20:23], 0 offen sc1
    s_waitcnt vmcnt(0)
    v_readfirstlane_b32 s94, v14
    s_sub_u32 s37, s37, 1
    s_cmp_eq_u32 s37, 0
    s_cbranch_scc1 L_k2_attn_kernel_gnx
    s_cmp_eq_u32 s94, 0
    s_cbranch_scc1 L_k2_attn_kernel_gn
L_k2_attn_kernel_gnx:
    s_add_u32 s20, s4, 59768832
    s_addc_u32 s21, s5, 0
    s_and_b32 s21, s21, 0xffff
    s_mov_b32 s22, 17408
    s_mov_b32 s23, 0x20000
    s_cmp_lg_u32 s24, 0
    s_cbranch_scc1 L_k2_attn_kernel_noflag
    v_mov_b32 v14, s94
    s_lshl_b32 s33, s2, 2
    s_add_u32 s33, s33, 16384
    buffer_store_dword v14, v13, s[20:23], s33 offen sc1
L_k2_attn_kernel_noflag:
    s_add_u32 m0, s91, 49152
    s_nop 0
    buffer_load_dwordx4 v134, s[12:15], s62 offen lds
    s_add_u32 m0, s47, 49152
    s_add_u32 s90, s90, 1
    s_and_b32 s90, s90, 15
    s_add_u32 s45, s45, 1
    buffer_load_dwordx4 v135, s[56:59], s63 offen lds
    s_add_u32 m0, s47, 57344
    s_nop 0
    buffer_load_dwordx4 v136, s[56:59], s63 offen lds
    s_lshl_b32 s62, s90, 7
    s_lshl_b32 s63, s90, 17
    s_cmp_lt_u32 s45, 16
    s_cselect_b32 s62, s62, 0x7ff00000
    s_cselect_b32 s63, s63, 0x7ff00000
    s_add_u32 m0, s91, 73728
    s_nop 0
    buffer_load_dwordx4 v134, s[12:15], s62 offen lds
    s_add_u32 m0, s47, 73728
    s_add_u32 s90, s90, 1
    s_and_b32 s90, s90, 15
    s_add_u32 s45, s45, 1
    buffer_load_dwordx4 v135, s[56:59], s63 offen lds
    s_add_u32 m0, s47, 81920
    s_nop 0
    buffer_load_dwordx4 v136, s[56:59], s63 offen lds
    s_lshl_b32 s62, s90, 7
    s_lshl_b32 s63, s90, 17
    s_cmp_lt_u32 s45, 16
    s_cselect_b32 s62, s62, 0x7ff00000
    s_cselect_b32 s63, s63, 0x7ff00000
    v_add_u32 v3, s29, v1
    s_add_u32 s8, s4, 4194304
    s_addc_u32 s9, s5, 0
    s_and_b32 s9, s9, 0xffff
    s_mov_b32 s10, 262144
    s_mov_b32 s11, 0x20000
    s_add_u32 s16, s4, 5242880
    s_addc_u32 s17, s5, 0
    s_and_b32 s17, s17, 0xffff
    s_mov_b32 s18, 4194304
    s_mov_b32 s19, 0x20000
    s_barrier
    ds_read_b128 v[76:79], v137 offset:0
    ds_read_b64_tr_b16 v[44:45], v145 offset:0
    ds_read_b64_tr_b16 v[46:47], v145 offset:512
    ds_read_b128 v[80:83], v138 offset:0
    ds_read_b64_tr_b16 v[48:49], v146 offset:0
    ds_read_b64_tr_b16 v[50:51], v146 offset:512
    ds_read_b128 v[84:87], v139 offset:0
    ds_read_b64_tr_b16 v[52:53], v147 offset:0
    ds_read_b64_tr_b16 v[54:55], v147 offset:512
    ds_read_b128 v[88:91], v140 offset:0
    ds_read_b64_tr_b16 v[56:57], v148 offset:0
    ds_read_b64_tr_b16 v[58:59], v148 offset:512
    s_mov_b32 s93, 0
    s_mov_b32 s44, 4
L_k2_attn_kernel_qloop:
    s_waitcnt vmcnt(6) lgkmcnt(0)
    s_barrier
    s_add_u32 m0, s91, 0
    s_nop 0
    buffer_load_dwordx4 v134, s[12:15], s62 offen lds
    s_add_u32 m0, s47, 0
    s_add_u32 s90, s90, 1
    s_and_b32 s90, s90, 15
    s_add_u32 s45, s45, 1
    v_mfma_f32_32x32x16_bf16 v[28:43], v[44:47], v[76:79], v[28:43]
    buffer_load_dwordx4 v135, s[56:59], s63 offen lds
    s_add_u32 m0, s47, 8192
    s_nop 0
    ds_read_b128 v[92:95], v137 offset:24576
    ds_read_b64_tr_b16 v[60:61], v145 offset:24576
    ds_read_b64_tr_b16 v[62:63], v145 offset:25088
    ds_read_b128 v[96:99], v138 offset:24576
    v_mfma_f32_16x16x32_bf16 v[156:159], v[172:175], v[44:47], v[156:159]
    buffer_load_dwordx4 v136, s[56:59], s63 offen lds
    s_lshl_b32 s62, s90, 7
    s_lshl_b32 s63, s90, 17
    s_cmp_lt_u32 s45, 16
    s_cselect_b32 s62, s62, 0x7ff00000
    s_cselect_b32 s63, s63, 0x7ff00000
    ds_read_b64_tr_b16 v[64:65], v146 offset:24576
    ds_read_b64_tr_b16 v[66:67], v146 offset:25088
    ds_read_b128 v[100:103], v139 offset:24576
    ds_read_b64_tr_b16 v[68:69], v147 offset:24576
    v_mfma_f32_32x32x16_bf16 v[28:43], v[48:51], v[80:83], v[28:43]
    ds_read_b64_tr_b16 v[70:71], v147 offset:25088
    ds_read_b128 v[104:107], v140 offset:24576
    ds_read_b64_tr_b16 v[72:73], v148 offset:24576
    ds_read_b64_tr_b16 v[74:75], v148 offset:25088
    v_mfma_f32_32x32x16_bf16 v[28:43], v[52:55], v[84:87], v[28:43]
    v_mfma_f32_16x16x32_bf16 v[156:159], v[172:175], v[52:55], v[156:159]
    v_mfma_f32_32x32x16_bf16 v[28:43], v[56:59], v[88:91], v[28:43]
    s_waitcnt vmcnt(6) lgkmcnt(0)
    s_barrier
    s_add_u32 m0, s91, 24576
    s_nop 0
    buffer_load_dwordx4 v134, s[12:15], s62 offen lds
    s_add_u32 m0, s47, 24576
    s_add_u32 s90, s90, 1
    s_and_b32 s90, s90, 15
    s_add_u32 s45, s45, 1
    v_mfma_f32_32x32x16_bf16 v[28:43], v[60:63], v[92:95], v[28:43]
    buffer_load_dwordx4 v135, s[56:59], s63 offen lds
    s_add_u32 m0, s47, 32768
    s_nop 0
    ds_read_b128 v[76:79], v141 offset:0
    ds_read_b64_tr_b16 v[44:45], v149 offset:0
    ds_read_b64_tr_b16 v[46:47], v149 offset:512
    ds_read_b128 v[80:83], v142 offset:0
    v_mfma_f32_16x16x32_bf16 v[156:159], v[172:175], v[60:63], v[156:159]
    buffer_load_dwordx4 v136, s[56:59], s63 offen lds
    s_lshl_b32 s62, s90, 7
    s_lshl_b32 s63, s90, 17
    s_cmp_lt_u32 s45, 16
    s_cselect_b32 s62, s62, 0x7ff00000
    s_cselect_b32 s63, s63, 0x7ff00000
    ds_read_b64_tr_b16 v[48:49], v150 offset:0
    ds_read_b64_tr_b16 v[50:51], v150 offset:512
    ds_read_b128 v[84:87], v143 offset:0
    ds_read_b64_tr_b16 v[52:53], v151 offset:0
    v_mfma_f32_32x32x16_bf16 v[28:43], v[64:67], v[96:99], v[28:43]
    ds_read_b64_tr_b16 v[54:55], v151 offset:512
    ds_read_b128 v[88:91], v144 offset:0
    ds_read_b64_tr_b16 v[56:57], v152 offset:0
    ds_read_b64_tr_b16 v[58:59], v152 offset:512
    v_mfma_f32_32x32x16_bf16 v[28:43], v[68:71], v[100:103], v[28:43]
    v_mfma_f32_16x16x32_bf16 v[156:159], v[172:175], v[68:71], v[156:159]
    v_mfma_f32_32x32x16_bf16 v[28:43], v[72:75], v[104:107], v[28:43]
    s_waitcnt vmcnt(6) lgkmcnt(0)
    s_barrier
    s_add_u32 m0, s91, 49152
    s_nop 0
    buffer_load_dwordx4 v134, s[12:15], s62 offen lds
    s_add_u32 m0, s47, 49152
    s_add_u32 s90, s90, 1
    s_and_b32 s90, s90, 15
    s_add_u32 s45, s45, 1
    v_mfma_f32_32x32x16_bf16 v[28:43], v[44:47], v[76:79], v[28:43]
    buffer_load_dwordx4 v135, s[56:59], s63 offen lds
    s_add_u32 m0, s47, 57344
    s_nop 0
    ds_read_b128 v[92:95], v141 offset:24576
    ds_read_b64_tr_b16 v[60:61], v149 offset:24576
    ds_read_b64_tr_b16 v[62:63], v149 offset:25088
    ds_read_b128 v[96:99], v142 offset:24576
    v_mfma_f32_16x16x32_bf16 v[156:159], v[172:175], v[44:47], v[156:159]
    buffer_load_dwordx4 v136, s[56:59], s63 offen lds
    s_lshl_b32 s62, s90, 7
    s_lshl_b32 s63, s90, 17
    s_cmp_lt_u32 s45, 16
    s_cselect_b32 s62, s62, 0x7ff00000
    s_cselect_b32 s63, s63, 0x7ff00000
    ds_read_b64_tr_b16 v[64:65], v150 offset:24576
    ds_read_b64_tr_b16 v[66:67], v150 offset:25088
    ds_read_b128 v[100:103], v143 offset:24576
    ds_read_b64_tr_b16 v[68:69], v151 offset:24576
    v_mfma_f32_32x32x16_bf16 v[28:43], v[48:51], v[80:83], v[28:43]
    ds_read_b64_tr_b16 v[70:71], v151 offset:25088
    ds_read_b128 v[104:107], v144 offset:24576
    ds_read_b64_tr_b16 v[72:73], v152 offset:24576
    ds_read_b64_tr_b16 v[74:75], v152 offset:25088
    v_mfma_f32_32x32x16_bf16 v[28:43], v[52:55], v[84:87], v[28:43]
    v_mfma_f32_16x16x32_bf16 v[156:159], v[172:175], v[52:55], v[156:159]
    v_mfma_f32_32x32x16_bf16 v[28:43], v[56:59], v[88:91], v[28:43]
    s_waitcnt vmcnt(6) lgkmcnt(0)
    s_barrier
    s_add_u32 m0, s91, 73728
    s_nop 0
    buffer_load_dwordx4 v134, s[12:15], s62 offen lds
    s_add_u32 m0, s47, 73728
    s_add_u32 s90, s90, 1
    s_and_b32 s90, s90, 15
    s_add_u32 s45, s45, 1
    v_mfma_f32_32x32x16_bf16 v[28:43], v[60:63], v[92:95], v[28:43]
    buffer_load_dwordx4 v135, s[56:59], s63 offen lds
    s_add_u32 m0, s47, 81920
    s_nop 0
    ds_read_b128 v[76:79], v137 offset:0
    ds_read_b64_tr_b16 v[44:45], v145 offset:0
    ds_read_b64_tr_b16 v[46:47], v145 offset:512
    ds_read_b128 v[80:83], v138 offset:0
    v_mfma_f32_16x16x32_bf16 v[156:159], v[172:175], v[60:63], v[156:159]
    buffer_load_dwordx4 v136, s[56:59], s63 offen lds
    s_lshl_b32 s62, s90, 7
    s_lshl_b32 s63, s90, 17
    s_cmp_lt_u32 s45, 16
    s_cselect_b32 s62, s62, 0x7ff00000
    s_cselect_b32 s63, s63, 0x7ff00000
    ds_read_b64_tr_b16 v[48:49], v146 offset:0
    ds_read_b64_tr_b16 v[50:51], v146 offset:512
    ds_read_b128 v[84:87], v139 offset:0
    ds_read_b64_tr_b16 v[52:53], v147 offset:0
    v_mfma_f32_32x32x16_bf16 v[28:43], v[64:67], v[96:99], v[28:43]
    ds_read_b64_tr_b16 v[54:55], v147 offset:512
    ds_read_b128 v[88:91], v140 offset:0
    ds_read_b64_tr_b16 v[56:57], v148 offset:0
    ds_read_b64_tr_b16 v[58:59], v148 offset:512
    v_mfma_f32_32x32x16_bf16 v[28:43], v[68:71], v[100:103], v[28:43]
    v_mfma_f32_16x16x32_bf16 v[156:159], v[172:175], v[68:71], v[156:159]
    v_mfma_f32_32x32x16_bf16 v[28:43], v[72:75], v[104:107], v[28:43]
    s_cmp_le_u32 s44, 3
    s_cbranch_scc1 L_k2_attn_kernel_fb
L_k2_attn_kernel_fbback:
    s_sub_u32 s44, s44, 1
    s_cmp_lg_u32 s44, 0
    s_cbranch_scc1 L_k2_attn_kernel_qloop
    s_waitcnt lgkmcnt(0)
    s_cmp_eq_u32 s93, 1
    s_cbranch_scc1 L_k2_attn_kernel_kv0done
    s_waitcnt vmcnt(0)
    s_mov_b32 s33, 16384
    s_mov_b32 s37, 0x8000
L_k2_attn_kernel_pollb2:
    buffer_load_dwordx4 v[8:11], v1, s[20:23], s33 offen sc1
    s_waitcnt vmcnt(0)
    v_xor_b32 v8, s94, v8
    v_xor_b32 v9, s94, v9
    v_xor_b32 v10, s94, v10
    v_xor_b32 v11, s94, v11
    v_or3_b32 v8, v8, v9, v10
    v_or_b32 v8, v8, v11
    v_cmp_ne_u32 vcc, 0, v8
    s_sub_u32 s37, s37, 1
    s_cmp_eq_u32 s37, 0
    s_cbranch_scc1 L_k2_attn_kernel_gotb2
    s_nop 3
    s_cbranch_vccnz L_k2_attn_kernel_pollb2
L_k2_attn_kernel_gotb2:
    s_add_u32 s20, s4, 4456448
    s_addc_u32 s21, s5, 0
    s_and_b32 s21, s21, 0xffff
    s_mov_b32 s22, 1024
    s_mov_b32 s23, 0x20000
    s_mov_b32 s28, 0
    s_cmp_lg_u32 s30, 0
    s_cbranch_scc1 L_k2_attn_kernel_nod0late
    s_add_u32 m0, s29, 0
    s_add_u32 s46, s28, 0
    buffer_load_dwordx4 v3, s[8:11], s46 offen sc1 lds
    buffer_load_dwordx4 v3, s[8:11], s46 offen offset:1024 sc1 lds
    buffer_load_dwordx4 v3, s[8:11], s46 offen offset:2048 sc1 lds
    buffer_load_dwordx4 v3, s[8:11], s46 offen offset:3072 sc1 lds
    s_add_u32 m0, s29, 16384
    s_add_u32 s46, s28, 131072
    buffer_load_dwordx4 v3, s[8:11], s46 offen sc1 lds
    buffer_load_dwordx4 v3, s[8:11], s46 offen offset:1024 sc1 lds
    buffer_load_dwordx4 v3, s[8:11], s46 offen offset:2048 sc1 lds
    buffer_load_dwordx4 v3, s[8:11], s46 offen offset:3072 sc1 lds
    s_add_u32 s28, s28, 16384
L_k2_attn_kernel_nod0late:
    buffer_load_dwordx4 v[8:11], v1, s[20:23], 0 offen sc1
    s_add_u32 s20, s4, 4460544
    s_addc_u32 s21, s5, 0
    s_and_b32 s21, s21, 0xffff
    s_mov_b32 s22, 16384
    s_mov_b32 s23, 0x20000
    s_lshl_b32 s33, s25, 1
    s_add_u32 s33, s33, s30
    s_lshl_b32 s33, s33, 8
    v_and_b32 v178, 31, v0
    v_lshlrev_b32 v178, 3, v178
    buffer_load_dwordx2 v[176:177], v178, s[20:23], s33 offen sc1
L_k2_attn_kernel_kv0done:
    s_and_b32 s34, s24, 3
    s_lshl_b32 s35, s34, 8
    s_add_u32 s35, s35, 151808
    s_lshl_b32 s36, s30, 7
    s_add_u32 s36, s36, s35
    v_and_b32 v4, 31, v0
    v_lshlrev_b32 v4, 2, v4
    v_add_u32 v4, s36, v4
    ds_write_b32 v4, v156
    v_lshrrev_b32 v5, 5, v0
    v_lshlrev_b32 v5, 4, v5
    v_add_u32 v5, s35, v5
    s_waitcnt lgkmcnt(0)
    s_barrier
    ds_read_b128 v[76:79], v5 offset:0
    ds_read_b128 v[80:83], v5 offset:32
    ds_read_b128 v[84:87], v5 offset:64
    ds_read_b128 v[88:91], v5 offset:96
    ds_read_b128 v[92:95], v5 offset:128
    ds_read_b128 v[96:99], v5 offset:160
    ds_read_b128 v[100:103], v5 offset:192
    ds_read_b128 v[104:107], v5 offset:224
    s_waitcnt vmcnt(0)
    v_mul_f32 v177, 0x3e8293ee, v177
    s_waitcnt lgkmcnt(0)
    v_add_f32 v76, v76, v92
    v_add_f32 v77, v77, v93
    v_add_f32 v78, v78, v94
    v_add_f32 v79, v79, v95
    v_add_f32 v80, v80, v96
    v_add_f32 v81, v81, v97
    v_add_f32 v82, v82, v98
    v_add_f32 v83, v83, v99
    v_add_f32 v84, v84, v100
    v_add_f32 v85, v85, v101
    v_add_f32 v86, v86, v102
    v_add_f32 v87, v87, v103
    v_add_f32 v88, v88, v104
    v_add_f32 v89, v89, v105
    v_add_f32 v90, v90, v106
    v_add_f32 v91, v91, v107
    v_fma_f32 v28, -v176, v76, v28
    v_mul_f32 v28, v177, v28
    v_fma_f32 v29, -v176, v77, v29
    v_mul_f32 v29, v177, v29
    v_fma_f32 v30, -v176, v78, v30
    v_mul_f32 v30, v177, v30
    v_fma_f32 v31, -v176, v79, v31
    v_mul_f32 v31, v177, v31
    v_fma_f32 v32, -v176, v80, v32
    v_mul_f32 v32, v177, v32
    v_fma_f32 v33, -v176, v81, v33
    v_mul_f32 v33, v177, v33
    v_fma_f32 v34, -v176, v82, v34
    v_mul_f32 v34, v177, v34
    v_fma_f32 v35, -v176, v83, v35
    v_mul_f32 v35, v177, v35
    v_fma_f32 v36, -v176, v84, v36
    v_mul_f32 v36, v177, v36
    v_fma_f32 v37, -v176, v85, v37
    v_mul_f32 v37, v177, v37
    v_fma_f32 v38, -v176, v86, v38
    v_mul_f32 v38, v177, v38
    v_fma_f32 v39, -v176, v87, v39
    v_mul_f32 v39, v177, v39
    v_fma_f32 v40, -v176, v88, v40
    v_mul_f32 v40, v177, v40
    v_fma_f32 v41, -v176, v89, v41
    v_mul_f32 v41, v177, v41
    v_fma_f32 v42, -v176, v90, v42
    v_mul_f32 v42, v177, v42
    v_fma_f32 v43, -v176, v91, v43
    v_mul_f32 v43, v177, v43
    v_mul_f32 v4, v28, v28
    v_fmac_f32 v4, v29, v29
    v_fmac_f32 v4, v30, v30
    v_fmac_f32 v4, v31, v31
    v_fmac_f32 v4, v32, v32
    v_fmac_f32 v4, v33, v33
    v_fmac_f32 v4, v34, v34
    v_fmac_f32 v4, v35, v35
    v_fmac_f32 v4, v36, v36
    v_fmac_f32 v4, v37, v37
    v_fmac_f32 v4, v38, v38
    v_fmac_f32 v4, v39, v39
    v_fmac_f32 v4, v40, v40
    v_fmac_f32 v4, v41, v41
    v_fmac_f32 v4, v42, v42
    v_fmac_f32 v4, v43, v43
    v_cvt_pk_bf16_f32 v60, v28, v29
    v_cvt_pk_bf16_f32 v61, v30, v31
    v_cvt_pk_bf16_f32 v62, v32, v33
    v_cvt_pk_bf16_f32 v63, v34, v35
    v_cvt_pk_bf16_f32 v64, v36, v37
    v_cvt_pk_bf16_f32 v65, v38, v39
    v_cvt_pk_bf16_f32 v66, v40, v41
    v_cvt_pk_bf16_f32 v67, v42, v43
    s_and_b32 s33, s24, 3
    s_lshl_b32 s33, s33, 12
    s_add_u32 s34, s33, 135424
    v_add_u32 v186, s34, v1
    s_lshl_b32 s35, s30, 11
    v_add_u32 v7, s35, v186
    ds_write_b128 v7, v[60:63] offset:0
    ds_write_b128 v7, v[64:67] offset:1024
    v_mov_b32 v5, v4
    s_nop 1
    v_permlane32_swap_b32 v4, v5
    v_add_f32 v4, v4, v5
    s_nop 1
    v_max_f32_dpp v4, v4, v4 row_ror:8 row_mask:0xf bank_mask:0xf
    s_nop 1
    v_max_f32_dpp v4, v4, v4 row_ror:4 row_mask:0xf bank_mask:0xf
    s_nop 1
    v_max_f32_dpp v4, v4, v4 row_ror:2 row_mask:0xf bank_mask:0xf
    s_nop 1
    v_max_f32_dpp v4, v4, v4 row_ror:1 row_mask:0xf bank_mask:0xf
    v_mov_b32 v5, v4
    s_nop 1
    v_permlane16_swap_b32 v4, v5
    v_max_f32 v4, v4, v5
    v_mov_b32 v5, v4
    s_nop 1
    v_permlane32_swap_b32 v4, v5
    v_max_f32 v4, v4, v5
    v_mov_b32 v5, 131072
    s_lshl_b32 s33, s24, 2
    v_add_u32 v5, s33, v5
    ds_write_b32 v5, v4
    s_lshl_b32 s33, s30, 14
    v_add_u32 v1, s33, v1
    v_lshrrev_b32 v4, 4, v0
    v_lshrrev_b32 v5, 2, v0
    v_xor_b32 v4, v4, v5
    v_and_b32 v4, 1, v4
    v_mov_b32 v5, 0x3f803f80
    v_cmp_eq_u32 vcc, 0, v4
    s_nop 1
    v_cndmask_b32 v148, 0, v5, vcc
    v_mov_b32 v149, v148
    v_mov_b32 v150, v148
    v_mov_b32 v151, v148
    v_mov_b64 v[76:77], 0
    v_mov_b64 v[78:79], 0
    v_mov_b64 v[80:81], 0
    v_mov_b64 v[82:83], 0
    v_mov_b64 v[84:85], 0
    v_mov_b64 v[86:87], 0
    v_mov_b64 v[88:89], 0
    v_mov_b64 v[90:91], 0
    v_mov_b64 v[108:109], 0
    v_mov_b64 v[110:111], 0
    v_mov_b64 v[92:93], 0
    v_mov_b64 v[94:95], 0
    v_mov_b64 v[96:97], 0
    v_mov_b64 v[98:99], 0
    v_mov_b64 v[100:101], 0
    v_mov_b64 v[102:103], 0
    v_mov_b64 v[104:105], 0
    v_mov_b64 v[106:107], 0
    v_mov_b64 v[112:113], 0
    v_mov_b64 v[114:115], 0
    v_mov_b64 v[68:69], 0
    v_mov_b64 v[140:141], 0
    v_mov_b64 v[70:71], 0
    v_mov_b64 v[142:143], 0
    v_mov_b64 v[72:73], 0
    v_mov_b64 v[144:145], 0
    v_mov_b64 v[74:75], 0
    v_mov_b64 v[146:147], 0
    s_lshl_b32 s33, s2, 2
    s_and_b32 s34, s24, 3
    s_add_u32 s33, s33, s34
    s_mul_i32 s34, s33, 7168
    v_lshlrev_b32 v4, 7, v0
    v_add_u32 v155, s34, v4
    s_mov_b32 s92, 3584
    s_mov_b32 s48, s88
    s_and_b32 s49, s89, 0xffff
    s_mov_b32 s50, 7340032
    s_mov_b32 s51, 0x20000
    s_add_u32 s52, s4, 33554432
    s_addc_u32 s53, s5, 0
    s_and_b32 s53, s53, 0xffff
    s_mov_b32 s54, 7340032
    s_mov_b32 s55, 0x20000
    s_mov_b32 s93, s33
    v_lshrrev_b32 v4, 3, v0
    v_lshlrev_b32 v4, 11, v4
    v_and_b32 v5, 7, v0
    v_bfe_u32 v6, v0, 4, 2
    v_lshlrev_b32 v6, 1, v6
    v_xor_b32 v5, v5, v6
    v_lshl_add_u32 v184, v5, 4, v4
    v_lshlrev_b32 v185, 4, v0
    s_waitcnt vmcnt(0) lgkmcnt(0)
    v_max_f32 v8, v8, v9
    v_max3_f32 v8, v8, v10, v11
    s_nop 1
    v_max_f32_dpp v8, v8, v8 row_ror:8 row_mask:0xf bank_mask:0xf
    s_nop 1
    v_max_f32_dpp v8, v8, v8 row_ror:4 row_mask:0xf bank_mask:0xf
    s_nop 1
    v_max_f32_dpp v8, v8, v8 row_ror:2 row_mask:0xf bank_mask:0xf
    s_nop 1
    v_max_f32_dpp v8, v8, v8 row_ror:1 row_mask:0xf bank_mask:0xf
    s_barrier
    ds_read_b128 v[12:15], v186 offset:0
    ds_read_b128 v[16:19], v186 offset:1024
    ds_read_b128 v[20:23], v186 offset:2048
    ds_read_b128 v[24:27], v186 offset:3072
    v_mov_b32 v5, 131072
    ds_read_b128 v[124:127], v5
    ds_read_b128 v[128:131], v5 offset:16
    v_readlane_b32 s34, v8, 0
    v_readlane_b32 s35, v8, 16
    v_readlane_b32 s36, v8, 32
    v_readlane_b32 s37, v8, 48
    v_add_u32 v2, 32768, v1
    ds_read_b128 v[116:119], v1 offset:0
    ds_read_b128 v[120:123], v1 offset:1024
    s_max_u32 s34, s34, s35
    s_max_u32 s36, s36, s37
    s_waitcnt lgkmcnt(0)
    v_max3_f32 v124, v124, v125, v126
    v_max3_f32 v124, v124, v127, v128
    v_max3_f32 v124, v124, v129, v130
    v_max_f32 v124, v124, v131
    v_mul_f32 v4, s34, v124
    v_mov_b32 v6, s36
    v_mov_b32 v5, 0x45be79e8
    v_cmp_le_f32 vcc, v4, v5
    v_mov_b32 v5, 0x5d800000
    v_cmp_le_f32 s[36:37], v6, v5
    s_nop 1
    s_and_b64 vcc, vcc, s[36:37]
    s_nop 4
    s_cbranch_vccz L_k2_attn_kernel_slow
    v_mfma_f32_32x32x16_bf16 v[28:43], v[116:119], v[12:15], 0
    v_mfma_f32_32x32x16_bf16 v[28:43], v[120:123], v[16:19], v[28:43]
    s_nop 7
    s_nop 3
    s_mov_b32 s44, 8
    s_mov_b32 s45, 98304
    s_cmp_lg_u32 s30, 0
    s_cbranch_scc1 L_k2_attn_kernel_sstart
L_k2_attn_kernel_loopp:
    s_cmp_eq_u32 s44, 8
    s_cbranch_scc1 L_k2_attn_kernel_ramp0
L_k2_attn_kernel_rampback0:
    v_exp_f32 v28, v28
    v_mfma_f32_32x32x16_bf16 v[44:59], v[116:119], v[20:23], 0
    ds_read_b128 v[124:127], v1 offset:4096
    v_exp_f32 v29, v29
    v_exp_f32 v30, v30
    ds_read_b128 v[128:131], v1 offset:5120
    v_exp_f32 v31, v31
    v_cvt_pk_bf16_f32 v60, v28, v29
    v_mfma_f32_32x32x16_bf16 v[44:59], v[120:123], v[24:27], v[44:59]
    ds_read_b128 v[132:135], v1 offset:2048
    v_exp_f32 v32, v32
    v_exp_f32 v33, v33
    ds_read_b128 v[136:139], v1 offset:3072
    v_cvt_pk_bf16_f32 v61, v30, v31
    v_exp_f32 v34, v34
    v_exp_f32 v35, v35
    v_mfma_f32_32x32x16_bf16 v[92:107], v[140:143], v[68:71], v[92:107]
    v_cvt_pk_bf16_f32 v62, v32, v33
    v_exp_f32 v36, v36
    v_exp_f32 v37, v37
    v_cvt_pk_bf16_f32 v63, v34, v35
    v_mfma_f32_16x16x32_bf16 v[112:115], v[148:151], v[68:71], v[112:115]
    v_exp_f32 v38, v38
    v_exp_f32 v39, v39
    v_cvt_pk_bf16_f32 v64, v36, v37
    v_exp_f32 v40, v40
    v_mfma_f32_32x32x16_bf16 v[92:107], v[144:147], v[72:75], v[92:107]
    v_exp_f32 v41, v41
    v_cvt_pk_bf16_f32 v65, v38, v39
    v_exp_f32 v42, v42
    v_exp_f32 v43, v43
    v_mfma_f32_16x16x32_bf16 v[112:115], v[148:151], v[72:75], v[112:115]
    v_cvt_pk_bf16_f32 v66, v40, v41
    v_cvt_pk_bf16_f32 v67, v42, v43
    s_waitcnt lgkmcnt(0)
    v_exp_f32 v44, v44
    v_mfma_f32_32x32x16_bf16 v[28:43], v[124:127], v[12:15], 0
    v_exp_f32 v45, v45
    v_exp_f32 v46, v46
    v_exp_f32 v47, v47
    v_cvt_pk_bf16_f32 v68, v44, v45
    v_mfma_f32_32x32x16_bf16 v[28:43], v[128:131], v[16:19], v[28:43]
    v_exp_f32 v48, v48
    v_exp_f32 v49, v49
    v_cvt_pk_bf16_f32 v69, v46, v47
    v_exp_f32 v50, v50
    v_exp_f32 v51, v51
    v_mfma_f32_32x32x16_bf16 v[76:91], v[132:135], v[60:63], v[76:91]
    v_cvt_pk_bf16_f32 v70, v48, v49
    v_exp_f32 v52, v52
    v_exp_f32 v53, v53
    v_cvt_pk_bf16_f32 v71, v50, v51
    v_mfma_f32_16x16x32_bf16 v[108:111], v[148:151], v[60:63], v[108:111]
    v_exp_f32 v54, v54
    v_exp_f32 v55, v55
    v_cvt_pk_bf16_f32 v72, v52, v53
    v_exp_f32 v56, v56
    v_mfma_f32_32x32x16_bf16 v[76:91], v[136:139], v[64:67], v[76:91]
    v_exp_f32 v57, v57
    v_cvt_pk_bf16_f32 v73, v54, v55
    v_exp_f32 v58, v58
    v_exp_f32 v59, v59
    v_mfma_f32_16x16x32_bf16 v[108:111], v[148:151], v[64:67], v[108:111]
    v_cvt_pk_bf16_f32 v74, v56, v57
    v_cvt_pk_bf16_f32 v75, v58, v59
    s_cmp_eq_u32 s44, 8
    s_cbranch_scc1 L_k2_attn_kernel_ramp1
L_k2_attn_kernel_rampback1:
    v_exp_f32 v28, v28
    v_mfma_f32_32x32x16_bf16 v[44:59], v[124:127], v[20:23], 0
    ds_read_b128 v[116:119], v1 offset:8192
    v_exp_f32 v29, v29
    v_exp_f32 v30, v30
    ds_read_b128 v[120:123], v1 offset:9216
    v_exp_f32 v31, v31
    v_cvt_pk_bf16_f32 v60, v28, v29
    v_mfma_f32_32x32x16_bf16 v[44:59], v[128:131], v[24:27], v[44:59]
    ds_read_b128 v[140:143], v1 offset:6144
    v_exp_f32 v32, v32
    v_exp_f32 v33, v33
    ds_read_b128 v[144:147], v1 offset:7168
    v_cvt_pk_bf16_f32 v61, v30, v31
    v_exp_f32 v34, v34
    v_exp_f32 v35, v35
    v_mfma_f32_32x32x16_bf16 v[92:107], v[132:135], v[68:71], v[92:107]
    v_cvt_pk_bf16_f32 v62, v32, v33
    v_exp_f32 v36, v36
    v_exp_f32 v37, v37
    v_cvt_pk_bf16_f32 v63, v34, v35
    v_mfma_f32_16x16x32_bf16 v[112:115], v[148:151], v[68:71], v[112:115]
    v_exp_f32 v38, v38
    v_exp_f32 v39, v39
    v_cvt_pk_bf16_f32 v64, v36, v37
    v_exp_f32 v40, v40
    v_mfma_f32_32x32x16_bf16 v[92:107], v[136:139], v[72:75], v[92:107]
    v_exp_f32 v41, v41
    v_cvt_pk_bf16_f32 v65, v38, v39
    v_exp_f32 v42, v42
    v_exp_f32 v43, v43
    v_mfma_f32_16x16x32_bf16 v[112:115], v[148:151], v[72:75], v[112:115]
    v_cvt_pk_bf16_f32 v66, v40, v41
    v_cvt_pk_bf16_f32 v67, v42, v43
    s_waitcnt lgkmcnt(0)
    v_exp_f32 v44, v44
    v_mfma_f32_32x32x16_bf16 v[28:43], v[116:119], v[12:15], 0
    v_exp_f32 v45, v45
    v_exp_f32 v46, v46
    v_exp_f32 v47, v47
    v_cvt_pk_bf16_f32 v68, v44, v45
    v_mfma_f32_32x32x16_bf16 v[28:43], v[120:123], v[16:19], v[28:43]
    v_exp_f32 v48, v48
    v_exp_f32 v49, v49
    v_cvt_pk_bf16_f32 v69, v46, v47
    v_exp_f32 v50, v50
    v_exp_f32 v51, v51
    v_mfma_f32_32x32x16_bf16 v[76:91], v[140:143], v[60:63], v[76:91]
    v_cvt_pk_bf16_f32 v70, v48, v49
    v_exp_f32 v52, v52
    v_exp_f32 v53, v53
    v_cvt_pk_bf16_f32 v71, v50, v51
    v_mfma_f32_16x16x32_bf16 v[108:111], v[148:151], v[60:63], v[108:111]
    v_exp_f32 v54, v54
    v_exp_f32 v55, v55
    v_cvt_pk_bf16_f32 v72, v52, v53
    v_exp_f32 v56, v56
    v_mfma_f32_32x32x16_bf16 v[76:91], v[144:147], v[64:67], v[76:91]
    v_exp_f32 v57, v57
    v_cvt_pk_bf16_f32 v73, v54, v55
    v_exp_f32 v58, v58
    v_exp_f32 v59, v59
    v_mfma_f32_16x16x32_bf16 v[108:111], v[148:151], v[64:67], v[108:111]
    v_cvt_pk_bf16_f32 v74, v56, v57
    v_cvt_pk_bf16_f32 v75, v58, v59
    v_exp_f32 v28, v28
    v_mfma_f32_32x32x16_bf16 v[44:59], v[116:119], v[20:23], 0
    ds_read_b128 v[124:127], v1 offset:12288
    v_exp_f32 v29, v29
    v_exp_f32 v30, v30
    ds_read_b128 v[128:131], v1 offset:13312
    v_exp_f32 v31, v31
    v_cvt_pk_bf16_f32 v60, v28, v29
    v_mfma_f32_32x32x16_bf16 v[44:59], v[120:123], v[24:27], v[44:59]
    ds_read_b128 v[132:135], v1 offset:10240
    v_exp_f32 v32, v32
    v_exp_f32 v33, v33
    ds_read_b128 v[136:139], v1 offset:11264
    v_cvt_pk_bf16_f32 v61, v30, v31
    v_exp_f32 v34, v34
    v_exp_f32 v35, v35
    v_mfma_f32_32x32x16_bf16 v[92:107], v[140:143], v[68:71], v[92:107]
    v_cvt_pk_bf16_f32 v62, v32, v33
    v_exp_f32 v36, v36
    v_exp_f32 v37, v37
    v_cvt_pk_bf16_f32 v63, v34, v35
    v_mfma_f32_16x16x32_bf16 v[112:115], v[148:151], v[68:71], v[112:115]
    v_exp_f32 v38, v38
    v_exp_f32 v39, v39
    v_cvt_pk_bf16_f32 v64, v36, v37
    v_exp_f32 v40, v40
    v_mfma_f32_32x32x16_bf16 v[92:107], v[144:147], v[72:75], v[92:107]
    v_exp_f32 v41, v41
    v_cvt_pk_bf16_f32 v65, v38, v39
    v_exp_f32 v42, v42
    v_exp_f32 v43, v43
    v_mfma_f32_16x16x32_bf16 v[112:115], v[148:151], v[72:75], v[112:115]
    v_cvt_pk_bf16_f32 v66, v40, v41
    v_cvt_pk_bf16_f32 v67, v42, v43
    s_waitcnt lgkmcnt(0)
    v_exp_f32 v44, v44
    v_mfma_f32_32x32x16_bf16 v[28:43], v[124:127], v[12:15], 0
    v_exp_f32 v45, v45
    v_exp_f32 v46, v46
    v_exp_f32 v47, v47
    v_cvt_pk_bf16_f32 v68, v44, v45
    v_mfma_f32_32x32x16_bf16 v[28:43], v[128:131], v[16:19], v[28:43]
    v_exp_f32 v48, v48
    v_exp_f32 v49, v49
    v_cvt_pk_bf16_f32 v69, v46, v47
    v_exp_f32 v50, v50
    v_exp_f32 v51, v51
    v_mfma_f32_32x32x16_bf16 v[76:91], v[132:135], v[60:63], v[76:91]
    v_cvt_pk_bf16_f32 v70, v48, v49
    v_exp_f32 v52, v52
    v_exp_f32 v53, v53
    v_cvt_pk_bf16_f32 v71, v50, v51
    v_mfma_f32_16x16x32_bf16 v[108:111], v[148:151], v[60:63], v[108:111]
    v_exp_f32 v54, v54
    v_exp_f32 v55, v55
    v_cvt_pk_bf16_f32 v72, v52, v53
    v_exp_f32 v56, v56
    v_mfma_f32_32x32x16_bf16 v[76:91], v[136:139], v[64:67], v[76:91]
    v_exp_f32 v57, v57
    v_cvt_pk_bf16_f32 v73, v54, v55
    v_exp_f32 v58, v58
    v_exp_f32 v59, v59
    v_mfma_f32_16x16x32_bf16 v[108:111], v[148:151], v[64:67], v[108:111]
    v_cvt_pk_bf16_f32 v74, v56, v57
    v_cvt_pk_bf16_f32 v75, v58, v59
    s_waitcnt vmcnt(8)
    s_barrier
    v_exp_f32 v28, v28
    v_mfma_f32_32x32x16_bf16 v[44:59], v[124:127], v[20:23], 0
    ds_read_b128 v[116:119], v2 offset:0
    v_exp_f32 v29, v29
    v_exp_f32 v30, v30
    ds_read_b128 v[120:123], v2 offset:1024
    v_exp_f32 v31, v31
    v_cvt_pk_bf16_f32 v60, v28, v29
    v_mfma_f32_32x32x16_bf16 v[44:59], v[128:131], v[24:27], v[44:59]
    ds_read_b128 v[140:143], v1 offset:14336
    v_exp_f32 v32, v32
    s_add_u32 m0, s29, s45
    s_add_u32 s46, s28, 0
    buffer_load_dwordx4 v3, s[8:11], s46 offen sc1 lds
    v_exp_f32 v33, v33
    ds_read_b128 v[144:147], v1 offset:15360
    v_cvt_pk_bf16_f32 v61, v30, v31
    buffer_load_dwordx4 v3, s[8:11], s46 offen offset:1024 sc1 lds
    v_exp_f32 v34, v34
    v_exp_f32 v35, v35
    v_mfma_f32_32x32x16_bf16 v[92:107], v[132:135], v[68:71], v[92:107]
    buffer_load_dwordx4 v3, s[8:11], s46 offen offset:2048 sc1 lds
    v_cvt_pk_bf16_f32 v62, v32, v33
    v_exp_f32 v36, v36
    buffer_load_dwordx4 v3, s[8:11], s46 offen offset:3072 sc1 lds
    v_exp_f32 v37, v37
    v_cvt_pk_bf16_f32 v63, v34, v35
    v_mfma_f32_16x16x32_bf16 v[112:115], v[148:151], v[68:71], v[112:115]
    v_exp_f32 v38, v38
    v_exp_f32 v39, v39
    v_cvt_pk_bf16_f32 v64, v36, v37
    v_exp_f32 v40, v40
    v_mfma_f32_32x32x16_bf16 v[92:107], v[136:139], v[72:75], v[92:107]
    v_exp_f32 v41, v41
    v_cvt_pk_bf16_f32 v65, v38, v39
    v_exp_f32 v42, v42
    v_exp_f32 v43, v43
    v_mfma_f32_16x16x32_bf16 v[112:115], v[148:151], v[72:75], v[112:115]
    v_cvt_pk_bf16_f32 v66, v40, v41
    v_cvt_pk_bf16_f32 v67, v42, v43
    s_waitcnt lgkmcnt(0)
    v_exp_f32 v44, v44
    v_mfma_f32_32x32x16_bf16 v[28:43], v[116:119], v[12:15], 0
    v_exp_f32 v45, v45
    v_exp_f32 v46, v46
    v_exp_f32 v47, v47
    v_cvt_pk_bf16_f32 v68, v44, v45
    v_mfma_f32_32x32x16_bf16 v[28:43], v[120:123], v[16:19], v[28:43]
    v_exp_f32 v48, v48
    s_add_u32 m0, s29, s45
    s_add_u32 m0, m0, 16384
    s_add_u32 s46, s28, 131072
    buffer_load_dwordx4 v3, s[8:11], s46 offen sc1 lds
    v_exp_f32 v49, v49
    v_cvt_pk_bf16_f32 v69, v46, v47
    buffer_load_dwordx4 v3, s[8:11], s46 offen offset:1024 sc1 lds
    v_exp_f32 v50, v50
    v_exp_f32 v51, v51
    v_mfma_f32_32x32x16_bf16 v[76:91], v[140:143], v[60:63], v[76:91]
    buffer_load_dwordx4 v3, s[8:11], s46 offen offset:2048 sc1 lds
    v_cvt_pk_bf16_f32 v70, v48, v49
    v_exp_f32 v52, v52
    buffer_load_dwordx4 v3, s[8:11], s46 offen offset:3072 sc1 lds
    s_add_u32 s28, s28, 16384
    s_add_u32 s45, s45, 32768
    s_and_b32 s45, s45, 131071
    v_exp_f32 v53, v53
    v_cvt_pk_bf16_f32 v71, v50, v51
    v_mfma_f32_16x16x32_bf16 v[108:111], v[148:151], v[60:63], v[108:111]
    v_mov_b32 v1, v2
    v_exp_f32 v54, v54
    v_exp_f32 v55, v55
    v_add_u32 v2, 32768, v2
    v_cvt_pk_bf16_f32 v72, v52, v53
    v_exp_f32 v56, v56
    v_mfma_f32_32x32x16_bf16 v[76:91], v[144:147], v[64:67], v[76:91]
    v_and_b32 v2, 131071, v2
    v_exp_f32 v57, v57
    v_cvt_pk_bf16_f32 v73, v54, v55
    v_exp_f32 v58, v58
    v_exp_f32 v59, v59
    v_mfma_f32_16x16x32_bf16 v[108:111], v[148:151], v[64:67], v[108:111]
    v_cvt_pk_bf16_f32 v74, v56, v57
    v_cvt_pk_bf16_f32 v75, v58, v59
    s_sub_u32 s44, s44, 1
    s_cmp_lg_u32 s44, 0
    s_cbranch_scc1 L_k2_attn_kernel_loopp
    s_nop 1
    v_mfma_f32_32x32x16_bf16 v[92:107], v[140:143], v[68:71], v[92:107]
    v_mfma_f32_16x16x32_bf16 v[112:115], v[148:151], v[68:71], v[112:115]
    v_mfma_f32_32x32x16_bf16 v[92:107], v[144:147], v[72:75], v[92:107]
    v_mfma_f32_16x16x32_bf16 v[112:115], v[148:151], v[72:75], v[112:115]
    s_branch L_k2_attn_kernel_fin
L_k2_attn_kernel_ramp0:
    s_add_u32 m0, s29, 32768
    s_add_u32 s46, s28, 0
    buffer_load_dwordx4 v3, s[8:11], s46 offen sc1 lds
    buffer_load_dwordx4 v3, s[8:11], s46 offen offset:1024 sc1 lds
    buffer_load_dwordx4 v3, s[8:11], s46 offen offset:2048 sc1 lds
    buffer_load_dwordx4 v3, s[8:11], s46 offen offset:3072 sc1 lds
    s_add_u32 m0, s29, 49152
    s_add_u32 s46, s28, 131072
    buffer_load_dwordx4 v3, s[8:11], s46 offen sc1 lds
    buffer_load_dwordx4 v3, s[8:11], s46 offen offset:1024 sc1 lds
    buffer_load_dwordx4 v3, s[8:11], s46 offen offset:2048 sc1 lds
    buffer_load_dwordx4 v3, s[8:11], s46 offen offset:3072 sc1 lds
    s_add_u32 s28, s28, 16384
    s_branch L_k2_attn_kernel_rampback0
L_k2_attn_kernel_ramp1:
    s_add_u32 m0, s29, 65536
    s_add_u32 s46, s28, 0
    buffer_load_dwordx4 v3, s[8:11], s46 offen sc1 lds
    buffer_load_dwordx4 v3, s[8:11], s46 offen offset:1024 sc1 lds
    buffer_load_dwordx4 v3, s[8:11], s46 offen offset:2048 sc1 lds
    buffer_load_dwordx4 v3, s[8:11], s46 offen offset:3072 sc1 lds
    s_add_u32 m0, s29, 81920
    s_add_u32 s46, s28, 131072
    buffer_load_dwordx4 v3, s[8:11], s46 offen sc1 lds
    buffer_load_dwordx4 v3, s[8:11], s46 offen offset:1024 sc1 lds
    buffer_load_dwordx4 v3, s[8:11], s46 offen offset:2048 sc1 lds
    buffer_load_dwordx4 v3, s[8:11], s46 offen offset:3072 sc1 lds
    s_add_u32 s28, s28, 16384
    s_branch L_k2_attn_kernel_rampback1
L_k2_attn_kernel_fb:
    s_cmp_lg_u32 s44, 3
    s_cbranch_scc1 L_k2_attn_kernel_fb2
    s_mov_b32 s33, 16384
    buffer_load_dwordx4 v[8:11], v1, s[20:23], s33 offen sc1
    s_branch L_k2_attn_kernel_fbback
L_k2_attn_kernel_fb2:
    s_cmp_lg_u32 s44, 2
    s_cbranch_scc1 L_k2_attn_kernel_fbback
    v_xor_b32 v8, s94, v8
    v_xor_b32 v9, s94, v9
    v_xor_b32 v10, s94, v10
    v_xor_b32 v11, s94, v11
    v_or3_b32 v8, v8, v9, v10
    v_or_b32 v8, v8, v11
    v_cmp_ne_u32 vcc, 0, v8
    s_nop 4
    s_cbranch_vccnz L_k2_attn_kernel_fbback
    s_mov_b32 s93, 1
    s_add_u32 s20, s4, 4456448
    s_addc_u32 s21, s5, 0
    s_and_b32 s21, s21, 0xffff
    s_mov_b32 s22, 1024
    s_mov_b32 s23, 0x20000
    s_mov_b32 s28, 0
    s_cmp_lg_u32 s30, 0
    s_cbranch_scc1 L_k2_attn_kernel_nod0early
    s_add_u32 m0, s29, 0
    s_add_u32 s46, s28, 0
    buffer_load_dwordx4 v3, s[8:11], s46 offen sc1 lds
    buffer_load_dwordx4 v3, s[8:11], s46 offen offset:1024 sc1 lds
    buffer_load_dwordx4 v3, s[8:11], s46 offen offset:2048 sc1 lds
    buffer_load_dwordx4 v3, s[8:11], s46 offen offset:3072 sc1 lds
    s_add_u32 m0, s29, 16384
    s_add_u32 s46, s28, 131072
    buffer_load_dwordx4 v3, s[8:11], s46 offen sc1 lds
    buffer_load_dwordx4 v3, s[8:11], s46 offen offset:1024 sc1 lds
    buffer_load_dwordx4 v3, s[8:11], s46 offen offset:2048 sc1 lds
    buffer_load_dwordx4 v3, s[8:11], s46 offen offset:3072 sc1 lds
    s_add_u32 s28, s28, 16384
L_k2_attn_kernel_nod0early:
    buffer_load_dwordx4 v[8:11], v1, s[20:23], 0 offen sc1
    s_add_u32 s20, s4, 4460544
    s_addc_u32 s21, s5, 0
    s_and_b32 s21, s21, 0xffff
    s_mov_b32 s22, 16384
    s_mov_b32 s23, 0x20000
    s_lshl_b32 s33, s25, 1
    s_add_u32 s33, s33, s30
    s_lshl_b32 s33, s33, 8
    v_and_b32 v178, 31, v0
    v_lshlrev_b32 v178, 3, v178
    buffer_load_dwordx2 v[176:177], v178, s[20:23], s33 offen sc1
    s_branch L_k2_attn_kernel_fbback
L_k2_attn_kernel_sstart:
L_k2_attn_kernel_loops:
    v_exp_f32 v28, v28
    v_mfma_f32_32x32x16_bf16 v[44:59], v[116:119], v[20:23], 0
    ds_read_b128 v[124:127], v1 offset:4096
    v_exp_f32 v29, v29
    v_exp_f32 v30, v30
    ds_read_b128 v[128:131], v1 offset:5120
    v_exp_f32 v31, v31
    v_cvt_pk_bf16_f32 v60, v28, v29
    v_mfma_f32_32x32x16_bf16 v[44:59], v[120:123], v[24:27], v[44:59]
    ds_read_b128 v[132:135], v1 offset:2048
    v_exp_f32 v32, v32
    v_exp_f32 v33, v33
    ds_read_b128 v[136:139], v1 offset:3072
    v_cvt_pk_bf16_f32 v61, v30, v31
    v_exp_f32 v34, v34
    v_exp_f32 v35, v35
    v_mfma_f32_32x32x16_bf16 v[92:107], v[140:143], v[68:71], v[92:107]
    v_cvt_pk_bf16_f32 v62, v32, v33
    v_exp_f32 v36, v36
    v_exp_f32 v37, v37
    v_cvt_pk_bf16_f32 v63, v34, v35
    v_mfma_f32_16x16x32_bf16 v[112:115], v[148:151], v[68:71], v[112:115]
    v_exp_f32 v38, v38
    v_exp_f32 v39, v39
    v_cvt_pk_bf16_f32 v64, v36, v37
    v_exp_f32 v40, v40
    v_mfma_f32_32x32x16_bf16 v[92:107], v[144:147], v[72:75], v[92:107]
    v_exp_f32 v41, v41
    v_cvt_pk_bf16_f32 v65, v38, v39
    v_exp_f32 v42, v42
    v_exp_f32 v43, v43
    v_mfma_f32_16x16x32_bf16 v[112:115], v[148:151], v[72:75], v[112:115]
    v_cvt_pk_bf16_f32 v66, v40, v41
    v_cvt_pk_bf16_f32 v67, v42, v43
    s_waitcnt lgkmcnt(0)
    v_exp_f32 v44, v44
    v_mfma_f32_32x32x16_bf16 v[28:43], v[124:127], v[12:15], 0
    v_exp_f32 v45, v45
    v_exp_f32 v46, v46
    v_exp_f32 v47, v47
    v_cvt_pk_bf16_f32 v68, v44, v45
    v_mfma_f32_32x32x16_bf16 v[28:43], v[128:131], v[16:19], v[28:43]
    v_exp_f32 v48, v48
    v_exp_f32 v49, v49
    v_cvt_pk_bf16_f32 v69, v46, v47
    v_exp_f32 v50, v50
    v_exp_f32 v51, v51
    v_mfma_f32_32x32x16_bf16 v[76:91], v[132:135], v[60:63], v[76:91]
    v_cvt_pk_bf16_f32 v70, v48, v49
    v_exp_f32 v52, v52
    v_exp_f32 v53, v53
    v_cvt_pk_bf16_f32 v71, v50, v51
    v_mfma_f32_16x16x32_bf16 v[108:111], v[148:151], v[60:63], v[108:111]
    v_exp_f32 v54, v54
    v_exp_f32 v55, v55
    v_cvt_pk_bf16_f32 v72, v52, v53
    v_exp_f32 v56, v56
    v_mfma_f32_32x32x16_bf16 v[76:91], v[136:139], v[64:67], v[76:91]
    v_exp_f32 v57, v57
    v_cvt_pk_bf16_f32 v73, v54, v55
    v_exp_f32 v58, v58
    v_exp_f32 v59, v59
    v_mfma_f32_16x16x32_bf16 v[108:111], v[148:151], v[64:67], v[108:111]
    v_cvt_pk_bf16_f32 v74, v56, v57
    v_cvt_pk_bf16_f32 v75, v58, v59
    v_exp_f32 v28, v28
    v_mfma_f32_32x32x16_bf16 v[44:59], v[124:127], v[20:23], 0
    ds_read_b128 v[116:119], v1 offset:8192
    v_exp_f32 v29, v29
    v_exp_f32 v30, v30
    ds_read_b128 v[120:123], v1 offset:9216
    v_exp_f32 v31, v31
    v_cvt_pk_bf16_f32 v60, v28, v29
    v_mfma_f32_32x32x16_bf16 v[44:59], v[128:131], v[24:27], v[44:59]
    ds_read_b128 v[140:143], v1 offset:6144
    v_exp_f32 v32, v32
    v_exp_f32 v33, v33
    ds_read_b128 v[144:147], v1 offset:7168
    v_cvt_pk_bf16_f32 v61, v30, v31
    v_exp_f32 v34, v34
    v_exp_f32 v35, v35
    v_mfma_f32_32x32x16_bf16 v[92:107], v[132:135], v[68:71], v[92:107]
    v_cvt_pk_bf16_f32 v62, v32, v33
    v_exp_f32 v36, v36
    v_exp_f32 v37, v37
    v_cvt_pk_bf16_f32 v63, v34, v35
    v_mfma_f32_16x16x32_bf16 v[112:115], v[148:151], v[68:71], v[112:115]
    v_exp_f32 v38, v38
    v_exp_f32 v39, v39
    v_cvt_pk_bf16_f32 v64, v36, v37
    v_exp_f32 v40, v40
    v_mfma_f32_32x32x16_bf16 v[92:107], v[136:139], v[72:75], v[92:107]
    v_exp_f32 v41, v41
    v_cvt_pk_bf16_f32 v65, v38, v39
    v_exp_f32 v42, v42
    v_exp_f32 v43, v43
    v_mfma_f32_16x16x32_bf16 v[112:115], v[148:151], v[72:75], v[112:115]
    v_cvt_pk_bf16_f32 v66, v40, v41
    v_cvt_pk_bf16_f32 v67, v42, v43
    s_waitcnt lgkmcnt(0)
    v_exp_f32 v44, v44
    v_mfma_f32_32x32x16_bf16 v[28:43], v[116:119], v[12:15], 0
    v_exp_f32 v45, v45
    v_exp_f32 v46, v46
    v_exp_f32 v47, v47
    v_cvt_pk_bf16_f32 v68, v44, v45
    v_mfma_f32_32x32x16_bf16 v[28:43], v[120:123], v[16:19], v[28:43]
    v_exp_f32 v48, v48
    v_exp_f32 v49, v49
    v_cvt_pk_bf16_f32 v69, v46, v47
    v_exp_f32 v50, v50
    v_exp_f32 v51, v51
    v_mfma_f32_32x32x16_bf16 v[76:91], v[140:143], v[60:63], v[76:91]
    v_cvt_pk_bf16_f32 v70, v48, v49
    v_exp_f32 v52, v52
    v_exp_f32 v53, v53
    v_cvt_pk_bf16_f32 v71, v50, v51
    v_mfma_f32_16x16x32_bf16 v[108:111], v[148:151], v[60:63], v[108:111]
    v_exp_f32 v54, v54
    v_exp_f32 v55, v55
    v_cvt_pk_bf16_f32 v72, v52, v53
    v_exp_f32 v56, v56
    v_mfma_f32_32x32x16_bf16 v[76:91], v[144:147], v[64:67], v[76:91]
    v_exp_f32 v57, v57
    v_cvt_pk_bf16_f32 v73, v54, v55
    v_exp_f32 v58, v58
    v_exp_f32 v59, v59
    v_mfma_f32_16x16x32_bf16 v[108:111], v[148:151], v[64:67], v[108:111]
    v_cvt_pk_bf16_f32 v74, v56, v57
    v_cvt_pk_bf16_f32 v75, v58, v59
    v_exp_f32 v28, v28
    v_mfma_f32_32x32x16_bf16 v[44:59], v[116:119], v[20:23], 0
    ds_read_b128 v[124:127], v1 offset:12288
    v_exp_f32 v29, v29
    v_exp_f32 v30, v30
    ds_read_b128 v[128:131], v1 offset:13312
    v_exp_f32 v31, v31
    v_cvt_pk_bf16_f32 v60, v28, v29
    v_mfma_f32_32x32x16_bf16 v[44:59], v[120:123], v[24:27], v[44:59]
    ds_read_b128 v[132:135], v1 offset:10240
    v_exp_f32 v32, v32
    v_exp_f32 v33, v33
    ds_read_b128 v[136:139], v1 offset:11264
    v_cvt_pk_bf16_f32 v61, v30, v31
    v_exp_f32 v34, v34
    v_exp_f32 v35, v35
    v_mfma_f32_32x32x16_bf16 v[92:107], v[140:143], v[68:71], v[92:107]
    v_cvt_pk_bf16_f32 v62, v32, v33
    v_exp_f32 v36, v36
    v_exp_f32 v37, v37
    v_cvt_pk_bf16_f32 v63, v34, v35
    v_mfma_f32_16x16x32_bf16 v[112:115], v[148:151], v[68:71], v[112:115]
    v_exp_f32 v38, v38
    v_exp_f32 v39, v39
    v_cvt_pk_bf16_f32 v64, v36, v37
    v_exp_f32 v40, v40
    v_mfma_f32_32x32x16_bf16 v[92:107], v[144:147], v[72:75], v[92:107]
    v_exp_f32 v41, v41
    v_cvt_pk_bf16_f32 v65, v38, v39
    v_exp_f32 v42, v42
    v_exp_f32 v43, v43
    v_mfma_f32_16x16x32_bf16 v[112:115], v[148:151], v[72:75], v[112:115]
    v_cvt_pk_bf16_f32 v66, v40, v41
    v_cvt_pk_bf16_f32 v67, v42, v43
    s_waitcnt lgkmcnt(0)
    v_exp_f32 v44, v44
    v_mfma_f32_32x32x16_bf16 v[28:43], v[124:127], v[12:15], 0
    v_exp_f32 v45, v45
    v_exp_f32 v46, v46
    v_exp_f32 v47, v47
    v_cvt_pk_bf16_f32 v68, v44, v45
    v_mfma_f32_32x32x16_bf16 v[28:43], v[128:131], v[16:19], v[28:43]
    v_exp_f32 v48, v48
    v_exp_f32 v49, v49
    v_cvt_pk_bf16_f32 v69, v46, v47
    v_exp_f32 v50, v50
    v_exp_f32 v51, v51
    v_mfma_f32_32x32x16_bf16 v[76:91], v[132:135], v[60:63], v[76:91]
    v_cvt_pk_bf16_f32 v70, v48, v49
    v_exp_f32 v52, v52
    v_exp_f32 v53, v53
    v_cvt_pk_bf16_f32 v71, v50, v51
    v_mfma_f32_16x16x32_bf16 v[108:111], v[148:151], v[60:63], v[108:111]
    v_exp_f32 v54, v54
    v_exp_f32 v55, v55
    v_cvt_pk_bf16_f32 v72, v52, v53
    v_exp_f32 v56, v56
    v_mfma_f32_32x32x16_bf16 v[76:91], v[136:139], v[64:67], v[76:91]
    v_exp_f32 v57, v57
    v_cvt_pk_bf16_f32 v73, v54, v55
    v_exp_f32 v58, v58
    v_exp_f32 v59, v59
    v_mfma_f32_16x16x32_bf16 v[108:111], v[148:151], v[64:67], v[108:111]
    v_cvt_pk_bf16_f32 v74, v56, v57
    v_cvt_pk_bf16_f32 v75, v58, v59
    s_barrier
    v_exp_f32 v28, v28
    v_mfma_f32_32x32x16_bf16 v[44:59], v[124:127], v[20:23], 0
    ds_read_b128 v[116:119], v2 offset:0
    v_exp_f32 v29, v29
    v_exp_f32 v30, v30
    ds_read_b128 v[120:123], v2 offset:1024
    v_exp_f32 v31, v31
    v_cvt_pk_bf16_f32 v60, v28, v29
    v_mfma_f32_32x32x16_bf16 v[44:59], v[128:131], v[24:27], v[44:59]
    ds_read_b128 v[140:143], v1 offset:14336
    v_exp_f32 v32, v32
    s_mov_b64 exec, 0xfffffff
    global_load_dword v154, v155, s[84:85]
    s_mov_b64 exec, -1
    v_exp_f32 v33, v33
    ds_read_b128 v[144:147], v1 offset:15360
    v_cvt_pk_bf16_f32 v61, v30, v31
    v_add_u32 v155, s92, v155
    s_sub_u32 s92, 0, s92
    s_cmp_gt_i32 s92, 0
    s_cselect_b32 s84, s86, s84
    s_cselect_b32 s85, s87, s85
    v_exp_f32 v34, v34
    v_exp_f32 v35, v35
    v_mfma_f32_32x32x16_bf16 v[92:107], v[132:135], v[68:71], v[92:107]
    v_cvt_pk_bf16_f32 v62, v32, v33
    v_exp_f32 v36, v36
    v_exp_f32 v37, v37
    v_cvt_pk_bf16_f32 v63, v34, v35
    v_mfma_f32_16x16x32_bf16 v[112:115], v[148:151], v[68:71], v[112:115]
    v_exp_f32 v38, v38
    v_exp_f32 v39, v39
    v_cvt_pk_bf16_f32 v64, v36, v37
    v_exp_f32 v40, v40
    v_mfma_f32_32x32x16_bf16 v[92:107], v[136:139], v[72:75], v[92:107]
    v_exp_f32 v41, v41
    v_cvt_pk_bf16_f32 v65, v38, v39
    v_exp_f32 v42, v42
    v_exp_f32 v43, v43
    v_mfma_f32_16x16x32_bf16 v[112:115], v[148:151], v[72:75], v[112:115]
    v_cvt_pk_bf16_f32 v66, v40, v41
    v_cvt_pk_bf16_f32 v67, v42, v43
    s_waitcnt lgkmcnt(0)
    v_exp_f32 v44, v44
    v_mfma_f32_32x32x16_bf16 v[28:43], v[116:119], v[12:15], 0
    v_exp_f32 v45, v45
    v_exp_f32 v46, v46
    v_exp_f32 v47, v47
    v_cvt_pk_bf16_f32 v68, v44, v45
    v_mfma_f32_32x32x16_bf16 v[28:43], v[120:123], v[16:19], v[28:43]
    v_exp_f32 v48, v48
    v_mov_b32 v1, v2
    v_exp_f32 v49, v49
    v_cvt_pk_bf16_f32 v69, v46, v47
    v_add_u32 v2, 32768, v2
    v_exp_f32 v50, v50
    v_exp_f32 v51, v51
    v_mfma_f32_32x32x16_bf16 v[76:91], v[140:143], v[60:63], v[76:91]
    v_and_b32 v2, 131071, v2
    v_cvt_pk_bf16_f32 v70, v48, v49
    v_exp_f32 v52, v52
    v_exp_f32 v53, v53
    v_cvt_pk_bf16_f32 v71, v50, v51
    v_mfma_f32_16x16x32_bf16 v[108:111], v[148:151], v[60:63], v[108:111]
    v_exp_f32 v54, v54
    v_exp_f32 v55, v55
    v_cvt_pk_bf16_f32 v72, v52, v53
    v_exp_f32 v56, v56
    v_mfma_f32_32x32x16_bf16 v[76:91], v[144:147], v[64:67], v[76:91]
    v_exp_f32 v57, v57
    v_cvt_pk_bf16_f32 v73, v54, v55
    v_exp_f32 v58, v58
    v_exp_f32 v59, v59
    v_mfma_f32_16x16x32_bf16 v[108:111], v[148:151], v[64:67], v[108:111]
    v_cvt_pk_bf16_f32 v74, v56, v57
    v_cvt_pk_bf16_f32 v75, v58, v59
    s_cmp_ge_u32 s44, 2
    s_cbranch_scc1 L_k2_attn_kernel_jf
L_k2_attn_kernel_gof:
    s_sub_u32 s44, s44, 1
    s_cmp_lg_u32 s44, 0
    s_cbranch_scc1 L_k2_attn_kernel_loops
    s_nop 1
    v_mfma_f32_32x32x16_bf16 v[92:107], v[140:143], v[68:71], v[92:107]
    v_mfma_f32_16x16x32_bf16 v[112:115], v[148:151], v[68:71], v[112:115]
    v_mfma_f32_32x32x16_bf16 v[92:107], v[144:147], v[72:75], v[92:107]
    v_mfma_f32_16x16x32_bf16 v[112:115], v[148:151], v[72:75], v[112:115]
    s_branch L_k2_attn_kernel_fin
L_k2_attn_kernel_jf:
    s_cmp_lg_u32 s44, 8
    s_cbranch_scc1 L_k2_attn_kernel_n8f
    s_add_u32 s34, s93, 0
    s_mul_i32 s35, s34, 9363
    s_lshr_b32 s35, s35, 22
    s_mul_i32 s36, s35, 448
    s_sub_u32 s34, s34, s36
    s_lshr_b32 s36, s34, 2
    s_and_b32 s34, s34, 3
    s_cmp_ge_u32 s36, 56
    s_cselect_b32 s37, 56, 0
    s_sub_u32 s36, s36, s37
    s_lshr_b32 s46, s36, 2
    s_and_b32 s47, s36, 3
    s_sub_u32 s62, s36, 32
    s_mul_i32 s63, s62, 43
    s_lshr_b32 s63, s63, 7
    s_mul_i32 s90, s63, 3
    s_sub_u32 s62, s62, s90
    s_add_u32 s90, s62, 2
    s_cmp_lt_u32 s36, 32
    s_cselect_b32 s46, s46, s63
    s_cselect_b32 s90, s47, s90
    s_cselect_b32 s47, s47, s62
    s_lshr_b32 s47, s47, 1
    s_lshl_b32 s47, s47, 1
    s_add_u32 s90, s90, s47
    s_mul_i32 s46, s46, 7
    s_add_u32 s46, s46, s90
    s_add_u32 s46, s46, s37
    s_lshl_b32 s46, s46, 2
    s_add_u32 s34, s34, s46
    s_lshl_b32 s34, s34, 14
    s_lshl_b32 s35, s35, 7
    s_add_u32 s35, s35, s34
    buffer_load_dwordx4 v[156:159], v184, s[48:51], s35 offen
    s_add_u32 s34, s93, 1024
    s_mul_i32 s35, s34, 9363
    s_lshr_b32 s35, s35, 22
    s_mul_i32 s36, s35, 448
    s_sub_u32 s34, s34, s36
    s_lshr_b32 s36, s34, 2
    s_and_b32 s34, s34, 3
    s_cmp_ge_u32 s36, 56
    s_cselect_b32 s37, 56, 0
    s_sub_u32 s36, s36, s37
    s_lshr_b32 s46, s36, 2
    s_and_b32 s47, s36, 3
    s_sub_u32 s62, s36, 32
    s_mul_i32 s63, s62, 43
    s_lshr_b32 s63, s63, 7
    s_mul_i32 s90, s63, 3
    s_sub_u32 s62, s62, s90
    s_add_u32 s90, s62, 2
    s_cmp_lt_u32 s36, 32
    s_cselect_b32 s46, s46, s63
    s_cselect_b32 s90, s47, s90
    s_cselect_b32 s47, s47, s62
    s_lshr_b32 s47, s47, 1
    s_lshl_b32 s47, s47, 1
    s_add_u32 s90, s90, s47
    s_mul_i32 s46, s46, 7
    s_add_u32 s46, s46, s90
    s_add_u32 s46, s46, s37
    s_lshl_b32 s46, s46, 2
    s_add_u32 s34, s34, s46
    s_lshl_b32 s34, s34, 14
    s_lshl_b32 s35, s35, 7
    s_add_u32 s35, s35, s34
    buffer_load_dwordx4 v[160:163], v184, s[48:51], s35 offen
    s_branch L_k2_attn_kernel_gof
L_k2_attn_kernel_n8f:
    s_cmp_lg_u32 s44, 7
    s_cbranch_scc1 L_k2_attn_kernel_n7f
    s_add_u32 s34, s93, 2048
    s_mul_i32 s35, s34, 9363
    s_lshr_b32 s35, s35, 22
    s_mul_i32 s36, s35, 448
    s_sub_u32 s34, s34, s36
    s_lshr_b32 s36, s34, 2
    s_and_b32 s34, s34, 3
    s_cmp_ge_u32 s36, 56
    s_cselect_b32 s37, 56, 0
    s_sub_u32 s36, s36, s37
    s_lshr_b32 s46, s36, 2
    s_and_b32 s47, s36, 3
    s_sub_u32 s62, s36, 32
    s_mul_i32 s63, s62, 43
    s_lshr_b32 s63, s63, 7
    s_mul_i32 s90, s63, 3
    s_sub_u32 s62, s62, s90
    s_add_u32 s90, s62, 2
    s_cmp_lt_u32 s36, 32
    s_cselect_b32 s46, s46, s63
    s_cselect_b32 s90, s47, s90
    s_cselect_b32 s47, s47, s62
    s_lshr_b32 s47, s47, 1
    s_lshl_b32 s47, s47, 1
    s_add_u32 s90, s90, s47
    s_mul_i32 s46, s46, 7
    s_add_u32 s46, s46, s90
    s_add_u32 s46, s46, s37
    s_lshl_b32 s46, s46, 2
    s_add_u32 s34, s34, s46
    s_lshl_b32 s34, s34, 14
    s_lshl_b32 s35, s35, 7
    s_add_u32 s35, s35, s34
    buffer_load_dwordx4 v[164:167], v184, s[48:51], s35 offen
    s_add_u32 s34, s93, 3072
    s_mul_i32 s35, s34, 9363
    s_lshr_b32 s35, s35, 22
    s_mul_i32 s36, s35, 448
    s_sub_u32 s34, s34, s36
    s_lshr_b32 s36, s34, 2
    s_and_b32 s34, s34, 3
    s_cmp_ge_u32 s36, 56
    s_cselect_b32 s37, 56, 0
    s_sub_u32 s36, s36, s37
    s_lshr_b32 s46, s36, 2
    s_and_b32 s47, s36, 3
    s_sub_u32 s62, s36, 32
    s_mul_i32 s63, s62, 43
    s_lshr_b32 s63, s63, 7
    s_mul_i32 s90, s63, 3
    s_sub_u32 s62, s62, s90
    s_add_u32 s90, s62, 2
    s_cmp_lt_u32 s36, 32
    s_cselect_b32 s46, s46, s63
    s_cselect_b32 s90, s47, s90
    s_cselect_b32 s47, s47, s62
    s_lshr_b32 s47, s47, 1
    s_lshl_b32 s47, s47, 1
    s_add_u32 s90, s90, s47
    s_mul_i32 s46, s46, 7
    s_add_u32 s46, s46, s90
    s_add_u32 s46, s46, s37
    s_lshl_b32 s46, s46, 2
    s_add_u32 s34, s34, s46
    s_lshl_b32 s34, s34, 14
    s_lshl_b32 s35, s35, 7
    s_add_u32 s35, s35, s34
    buffer_load_dwordx4 v[168:171], v184, s[48:51], s35 offen
    s_branch L_k2_attn_kernel_gof
L_k2_attn_kernel_n7f:
    s_cmp_lg_u32 s44, 6
    s_cbranch_scc1 L_k2_attn_kernel_n6f
    s_add_u32 s34, s93, 4096
    s_mul_i32 s35, s34, 9363
    s_lshr_b32 s35, s35, 22
    s_mul_i32 s36, s35, 448
    s_sub_u32 s34, s34, s36
    s_lshr_b32 s36, s34, 2
    s_and_b32 s34, s34, 3
    s_cmp_ge_u32 s36, 56
    s_cselect_b32 s37, 56, 0
    s_sub_u32 s36, s36, s37
    s_lshr_b32 s46, s36, 2
    s_and_b32 s47, s36, 3
    s_sub_u32 s62, s36, 32
    s_mul_i32 s63, s62, 43
    s_lshr_b32 s63, s63, 7
    s_mul_i32 s90, s63, 3
    s_sub_u32 s62, s62, s90
    s_add_u32 s90, s62, 2
    s_cmp_lt_u32 s36, 32
    s_cselect_b32 s46, s46, s63
    s_cselect_b32 s90, s47, s90
    s_cselect_b32 s47, s47, s62
    s_lshr_b32 s47, s47, 1
    s_lshl_b32 s47, s47, 1
    s_add_u32 s90, s90, s47
    s_mul_i32 s46, s46, 7
    s_add_u32 s46, s46, s90
    s_add_u32 s46, s46, s37
    s_lshl_b32 s46, s46, 2
    s_add_u32 s34, s34, s46
    s_lshl_b32 s34, s34, 14
    s_lshl_b32 s35, s35, 7
    s_add_u32 s35, s35, s34
    buffer_load_dwordx4 v[172:175], v184, s[48:51], s35 offen
    s_branch L_k2_attn_kernel_gof
L_k2_attn_kernel_n6f:
    s_cmp_lg_u32 s44, 5
    s_cbranch_scc1 L_k2_attn_kernel_n5f
    s_waitcnt vmcnt(6)
    s_add_u32 s35, s93, 0
    s_lshl_b32 s35, s35, 10
    buffer_store_dwordx4 v[156:159], v185, s[52:55], s35 offen sc1
    s_add_u32 s35, s93, 1024
    s_lshl_b32 s35, s35, 10
    buffer_store_dwordx4 v[160:163], v185, s[52:55], s35 offen sc1
    s_add_u32 s34, s93, 5120
    s_mul_i32 s35, s34, 9363
    s_lshr_b32 s35, s35, 22
    s_mul_i32 s36, s35, 448
    s_sub_u32 s34, s34, s36
    s_lshr_b32 s36, s34, 2
    s_and_b32 s34, s34, 3
    s_cmp_ge_u32 s36, 56
    s_cselect_b32 s37, 56, 0
    s_sub_u32 s36, s36, s37
    s_lshr_b32 s46, s36, 2
    s_and_b32 s47, s36, 3
    s_sub_u32 s62, s36, 32
    s_mul_i32 s63, s62, 43
    s_lshr_b32 s63, s63, 7
    s_mul_i32 s90, s63, 3
    s_sub_u32 s62, s62, s90
    s_add_u32 s90, s62, 2
    s_cmp_lt_u32 s36, 32
    s_cselect_b32 s46, s46, s63
    s_cselect_b32 s90, s47, s90
    s_cselect_b32 s47, s47, s62
    s_lshr_b32 s47, s47, 1
    s_lshl_b32 s47, s47, 1
    s_add_u32 s90, s90, s47
    s_mul_i32 s46, s46, 7
    s_add_u32 s46, s46, s90
    s_add_u32 s46, s46, s37
    s_lshl_b32 s46, s46, 2
    s_add_u32 s34, s34, s46
    s_lshl_b32 s34, s34, 14
    s_lshl_b32 s35, s35, 7
    s_add_u32 s35, s35, s34
    buffer_load_dwordx4 v[176:179], v184, s[48:51], s35 offen
    s_branch L_k2_attn_kernel_gof
L_k2_attn_kernel_n5f:
    s_cmp_lg_u32 s44, 4
    s_cbranch_scc1 L_k2_attn_kernel_n4f
    s_waitcnt vmcnt(7)
    s_add_u32 s35, s93, 2048
    s_lshl_b32 s35, s35, 10
    buffer_store_dwordx4 v[164:167], v185, s[52:55], s35 offen sc1
    s_add_u32 s35, s93, 3072
    s_lshl_b32 s35, s35, 10
    buffer_store_dwordx4 v[168:171], v185, s[52:55], s35 offen sc1
    s_add_u32 s34, s93, 6144
    s_mul_i32 s35, s34, 9363
    s_lshr_b32 s35, s35, 22
    s_mul_i32 s36, s35, 448
    s_sub_u32 s34, s34, s36
    s_lshr_b32 s36, s34, 2
    s_and_b32 s34, s34, 3
    s_cmp_ge_u32 s36, 56
    s_cselect_b32 s37, 56, 0
    s_sub_u32 s36, s36, s37
    s_lshr_b32 s46, s36, 2
    s_and_b32 s47, s36, 3
    s_sub_u32 s62, s36, 32
    s_mul_i32 s63, s62, 43
    s_lshr_b32 s63, s63, 7
    s_mul_i32 s90, s63, 3
    s_sub_u32 s62, s62, s90
    s_add_u32 s90, s62, 2
    s_cmp_lt_u32 s36, 32
    s_cselect_b32 s46, s46, s63
    s_cselect_b32 s90, s47, s90
    s_cselect_b32 s47, s47, s62
    s_lshr_b32 s47, s47, 1
    s_lshl_b32 s47, s47, 1
    s_add_u32 s90, s90, s47
    s_mul_i32 s46, s46, 7
    s_add_u32 s46, s46, s90
    s_add_u32 s46, s46, s37
    s_lshl_b32 s46, s46, 2
    s_add_u32 s34, s34, s46
    s_lshl_b32 s34, s34, 14
    s_lshl_b32 s35, s35, 7
    s_add_u32 s35, s35, s34
    buffer_load_dwordx4 v[180:183], v184, s[48:51], s35 offen
    s_branch L_k2_attn_kernel_gof
L_k2_attn_kernel_n4f:
    s_cmp_lg_u32 s44, 3
    s_cbranch_scc1 L_k2_attn_kernel_n3f
    s_waitcnt vmcnt(5)
    s_add_u32 s35, s93, 4096
    s_lshl_b32 s35, s35, 10
    buffer_store_dwordx4 v[172:175], v185, s[52:55], s35 offen sc1
    s_add_u32 s35, s93, 5120
    s_lshl_b32 s35, s35, 10
    buffer_store_dwordx4 v[176:179], v185, s[52:55], s35 offen sc1
    s_lshr_b32 s33, s2, 3
    s_lshl_b32 s33, s33, 2
    s_and_b32 s34, s24, 3
    s_add_u32 s33, s33, s34
    s_lshl_b32 s34, s33, 13
    v_lshlrev_b32 v4, 7, v0
    v_add_u32 v5, s34, v4
    global_load_dword v154, v5, s[80:81]
    s_branch L_k2_attn_kernel_gof
L_k2_attn_kernel_n3f:
    s_waitcnt vmcnt(5)
    s_add_u32 s35, s93, 6144
    s_lshl_b32 s35, s35, 10
    buffer_store_dwordx4 v[180:183], v185, s[52:55], s35 offen sc1
    s_lshr_b32 s33, s2, 3
    s_lshl_b32 s33, s33, 2
    s_and_b32 s34, s24, 3
    s_add_u32 s33, s33, s34
    s_lshl_b32 s34, s33, 13
    s_add_u32 s34, s34, 0x100000
    v_lshlrev_b32 v4, 7, v0
    v_add_u32 v5, s34, v4
    global_load_dword v154, v5, s[80:81]
    s_lshl_b32 s34, s33, 12
    s_and_b32 s35, s2, 7
    s_lshl_b32 s35, s35, 19
    s_add_u32 s34, s34, s35
    v_add_u32 v5, s34, v4
    s_mov_b32 exec_lo, -1
    s_mov_b32 exec_hi, 0
    global_load_dword v154, v5, s[98:99]
    s_mov_b64 exec, -1
    s_branch L_k2_attn_kernel_gof
L_k2_attn_kernel_slow:
    s_cmp_lg_u32 s30, 0
    s_cbranch_scc1 L_k2_attn_kernel_s12
    s_add_u32 m0, s29, 32768
    s_add_u32 s46, s28, 0
    buffer_load_dwordx4 v3, s[8:11], s46 offen sc1 lds
    buffer_load_dwordx4 v3, s[8:11], s46 offen offset:1024 sc1 lds
    buffer_load_dwordx4 v3, s[8:11], s46 offen offset:2048 sc1 lds
    buffer_load_dwordx4 v3, s[8:11], s46 offen offset:3072 sc1 lds
    s_add_u32 m0, s29, 49152
    s_add_u32 s46, s28, 131072
    buffer_load_dwordx4 v3, s[8:11], s46 offen sc1 lds
    buffer_load_dwordx4 v3, s[8:11], s46 offen offset:1024 sc1 lds
    buffer_load_dwordx4 v3, s[8:11], s46 offen offset:2048 sc1 lds
    buffer_load_dwordx4 v3, s[8:11], s46 offen offset:3072 sc1 lds
    s_add_u32 s28, s28, 16384
    s_add_u32 m0, s29, 65536
    s_add_u32 s46, s28, 0
    buffer_load_dwordx4 v3, s[8:11], s46 offen sc1 lds
    buffer_load_dwordx4 v3, s[8:11], s46 offen offset:1024 sc1 lds
    buffer_load_dwordx4 v3, s[8:11], s46 offen offset:2048 sc1 lds
    buffer_load_dwordx4 v3, s[8:11], s46 offen offset:3072 sc1 lds
    s_add_u32 m0, s29, 81920
    s_add_u32 s46, s28, 131072
    buffer_load_dwordx4 v3, s[8:11], s46 offen sc1 lds
    buffer_load_dwordx4 v3, s[8:11], s46 offen offset:1024 sc1 lds
    buffer_load_dwordx4 v3, s[8:11], s46 offen offset:2048 sc1 lds
    buffer_load_dwordx4 v3, s[8:11], s46 offen offset:3072 sc1 lds
    s_add_u32 s28, s28, 16384
L_k2_attn_kernel_s12:
    v_mov_b32 v152, 0xff7fffff
    v_mov_b32 v153, 0xff7fffff
    s_mov_b32 s44, 8
    s_mov_b32 s45, 98304
L_k2_attn_kernel_so:
    v_mov_b32 v10, v1
    s_mov_b32 s46, 4
L_k2_attn_kernel_si:
    ds_read_b128 v[116:119], v10 offset:0
    ds_read_b128 v[120:123], v10 offset:1024
    ds_read_b128 v[132:135], v10 offset:2048
    ds_read_b128 v[136:139], v10 offset:3072
    s_waitcnt lgkmcnt(0)
    v_mfma_f32_32x32x16_bf16 v[28:43], v[116:119], v[12:15], 0
    v_mfma_f32_32x32x16_bf16 v[28:43], v[120:123], v[16:19], v[28:43]
    s_nop 7
    s_nop 4
    v_max_f32 v4, v28, v29
    v_max3_f32 v4, v4, v30, v31
    v_max3_f32 v4, v4, v32, v33
    v_max3_f32 v4, v4, v34, v35
    v_max3_f32 v4, v4, v36, v37
    v_max3_f32 v4, v4, v38, v39
    v_max3_f32 v4, v4, v40, v41
    v_max3_f32 v4, v4, v42, v43
    v_mov_b32 v5, v4
    s_nop 1
    v_permlane32_swap_b32 v4, v5
    v_max3_f32 v4, v4, v5, v152
    v_sub_f32 v5, v152, v4
    v_exp_f32 v5, v5
    v_mov_b32 v152, v4
    v_sub_f32 v28, v28, v4
    v_sub_f32 v29, v29, v4
    v_sub_f32 v30, v30, v4
    v_sub_f32 v31, v31, v4
    v_sub_f32 v32, v32, v4
    v_sub_f32 v33, v33, v4
    v_sub_f32 v34, v34, v4
    v_sub_f32 v35, v35, v4
    v_sub_f32 v36, v36, v4
    v_sub_f32 v37, v37, v4
    v_sub_f32 v38, v38, v4
    v_sub_f32 v39, v39, v4
    v_sub_f32 v40, v40, v4
    v_sub_f32 v41, v41, v4
    v_sub_f32 v42, v42, v4
    v_sub_f32 v43, v43, v4
    v_exp_f32 v28, v28
    v_exp_f32 v29, v29
    v_exp_f32 v30, v30
    v_exp_f32 v31, v31
    v_exp_f32 v32, v32
    v_exp_f32 v33, v33
    v_exp_f32 v34, v34
    v_exp_f32 v35, v35
    v_exp_f32 v36, v36
    v_exp_f32 v37, v37
    v_exp_f32 v38, v38
    v_exp_f32 v39, v39
    v_exp_f32 v40, v40
    v_exp_f32 v41, v41
    v_exp_f32 v42, v42
    v_exp_f32 v43, v43
    v_mul_f32 v76, v76, v5
    v_mul_f32 v77, v77, v5
    v_mul_f32 v78, v78, v5
    v_mul_f32 v79, v79, v5
    v_mul_f32 v80, v80, v5
    v_mul_f32 v81, v81, v5
    v_mul_f32 v82, v82, v5
    v_mul_f32 v83, v83, v5
    v_mul_f32 v84, v84, v5
    v_mul_f32 v85, v85, v5
    v_mul_f32 v86, v86, v5
    v_mul_f32 v87, v87, v5
    v_mul_f32 v88, v88, v5
    v_mul_f32 v89, v89, v5
    v_mul_f32 v90, v90, v5
    v_mul_f32 v91, v91, v5
    v_mul_f32 v108, v108, v5
    v_mul_f32 v109, v109, v5
    v_mul_f32 v110, v110, v5
    v_mul_f32 v111, v111, v5
    v_cvt_pk_bf16_f32 v60, v28, v29
    v_cvt_pk_bf16_f32 v61, v30, v31
    v_cvt_pk_bf16_f32 v62, v32, v33
    v_cvt_pk_bf16_f32 v63, v34, v35
    v_cvt_pk_bf16_f32 v64, v36, v37
    v_cvt_pk_bf16_f32 v65, v38, v39
    v_cvt_pk_bf16_f32 v66, v40, v41
    v_cvt_pk_bf16_f32 v67, v42, v43
    s_nop 1
    v_mfma_f32_32x32x16_bf16 v[76:91], v[132:135], v[60:63], v[76:91]
    v_mfma_f32_16x16x32_bf16 v[108:111], v[148:151], v[60:63], v[108:111]
    v_mfma_f32_32x32x16_bf16 v[76:91], v[136:139], v[64:67], v[76:91]
    v_mfma_f32_16x16x32_bf16 v[108:111], v[148:151], v[64:67], v[108:111]
    s_nop 7
    s_nop 4
    v_mfma_f32_32x32x16_bf16 v[44:59], v[116:119], v[20:23], 0
    v_mfma_f32_32x32x16_bf16 v[44:59], v[120:123], v[24:27], v[44:59]
    s_nop 7
    s_nop 4
    v_max_f32 v4, v44, v45
    v_max3_f32 v4, v4, v46, v47
    v_max3_f32 v4, v4, v48, v49
    v_max3_f32 v4, v4, v50, v51
    v_max3_f32 v4, v4, v52, v53
    v_max3_f32 v4, v4, v54, v55
    v_max3_f32 v4, v4, v56, v57
    v_max3_f32 v4, v4, v58, v59
    v_mov_b32 v5, v4
    s_nop 1
    v_permlane32_swap_b32 v4, v5
    v_max3_f32 v4, v4, v5, v153
    v_sub_f32 v5, v153, v4
    v_exp_f32 v5, v5
    v_mov_b32 v153, v4
    v_sub_f32 v44, v44, v4
    v_sub_f32 v45, v45, v4
    v_sub_f32 v46, v46, v4
    v_sub_f32 v47, v47, v4
    v_sub_f32 v48, v48, v4
    v_sub_f32 v49, v49, v4
    v_sub_f32 v50, v50, v4
    v_sub_f32 v51, v51, v4
    v_sub_f32 v52, v52, v4
    v_sub_f32 v53, v53, v4
    v_sub_f32 v54, v54, v4
    v_sub_f32 v55, v55, v4
    v_sub_f32 v56, v56, v4
    v_sub_f32 v57, v57, v4
    v_sub_f32 v58, v58, v4
    v_sub_f32 v59, v59, v4
    v_exp_f32 v44, v44
    v_exp_f32 v45, v45
    v_exp_f32 v46, v46
    v_exp_f32 v47, v47
    v_exp_f32 v48, v48
    v_exp_f32 v49, v49
    v_exp_f32 v50, v50
    v_exp_f32 v51, v51
    v_exp_f32 v52, v52
    v_exp_f32 v53, v53
    v_exp_f32 v54, v54
    v_exp_f32 v55, v55
    v_exp_f32 v56, v56
    v_exp_f32 v57, v57
    v_exp_f32 v58, v58
    v_exp_f32 v59, v59
    v_mul_f32 v92, v92, v5
    v_mul_f32 v93, v93, v5
    v_mul_f32 v94, v94, v5
    v_mul_f32 v95, v95, v5
    v_mul_f32 v96, v96, v5
    v_mul_f32 v97, v97, v5
    v_mul_f32 v98, v98, v5
    v_mul_f32 v99, v99, v5
    v_mul_f32 v100, v100, v5
    v_mul_f32 v101, v101, v5
    v_mul_f32 v102, v102, v5
    v_mul_f32 v103, v103, v5
    v_mul_f32 v104, v104, v5
    v_mul_f32 v105, v105, v5
    v_mul_f32 v106, v106, v5
    v_mul_f32 v107, v107, v5
    v_mul_f32 v112, v112, v5
    v_mul_f32 v113, v113, v5
    v_mul_f32 v114, v114, v5
    v_mul_f32 v115, v115, v5
    v_cvt_pk_bf16_f32 v68, v44, v45
    v_cvt_pk_bf16_f32 v69, v46, v47
    v_cvt_pk_bf16_f32 v70, v48, v49
    v_cvt_pk_bf16_f32 v71, v50, v51
    v_cvt_pk_bf16_f32 v72, v52, v53
    v_cvt_pk_bf16_f32 v73, v54, v55
    v_cvt_pk_bf16_f32 v74, v56, v57
    v_cvt_pk_bf16_f32 v75, v58, v59
    s_nop 1
    v_mfma_f32_32x32x16_bf16 v[92:107], v[132:135], v[68:71], v[92:107]
    v_mfma_f32_16x16x32_bf16 v[112:115], v[148:151], v[68:71], v[112:115]
    v_mfma_f32_32x32x16_bf16 v[92:107], v[136:139], v[72:75], v[92:107]
    v_mfma_f32_16x16x32_bf16 v[112:115], v[148:151], v[72:75], v[112:115]
    s_nop 7
    s_nop 4
    v_add_u32 v10, 4096, v10
    s_sub_u32 s46, s46, 1
    s_cmp_lg_u32 s46, 0
    s_cbranch_scc1 L_k2_attn_kernel_si
    s_cmp_lg_u32 s30, 0
    s_cbranch_scc1 L_k2_attn_kernel_sside
    s_waitcnt vmcnt(8)
    s_barrier
    s_add_u32 m0, s29, s45
    s_add_u32 s46, s28, 0
    buffer_load_dwordx4 v3, s[8:11], s46 offen sc1 lds
    buffer_load_dwordx4 v3, s[8:11], s46 offen offset:1024 sc1 lds
    buffer_load_dwordx4 v3, s[8:11], s46 offen offset:2048 sc1 lds
    buffer_load_dwordx4 v3, s[8:11], s46 offen offset:3072 sc1 lds
    s_add_u32 m0, s29, s45
    s_add_u32 m0, m0, 16384
    s_add_u32 s46, s28, 131072
    buffer_load_dwordx4 v3, s[8:11], s46 offen sc1 lds
    buffer_load_dwordx4 v3, s[8:11], s46 offen offset:1024 sc1 lds
    buffer_load_dwordx4 v3, s[8:11], s46 offen offset:2048 sc1 lds
    buffer_load_dwordx4 v3, s[8:11], s46 offen offset:3072 sc1 lds
    s_add_u32 s28, s28, 16384
    s_add_u32 s45, s45, 32768
    s_and_b32 s45, s45, 131071
    s_branch L_k2_attn_kernel_snext
L_k2_attn_kernel_sside:
    s_barrier
    s_mov_b64 exec, 0xfffffff
    global_load_dword v154, v155, s[84:85]
    s_mov_b64 exec, -1
    v_add_u32 v155, s92, v155
    s_sub_u32 s92, 0, s92
    s_cmp_gt_i32 s92, 0
    s_cselect_b32 s84, s86, s84
    s_cselect_b32 s85, s87, s85
    s_cmp_ge_u32 s44, 2
    s_cbranch_scc1 L_k2_attn_kernel_js
L_k2_attn_kernel_gos:
L_k2_attn_kernel_snext:
    v_add_u32 v1, 32768, v1
    v_and_b32 v1, 131071, v1
    s_sub_u32 s44, s44, 1
    s_cmp_lg_u32 s44, 0
    s_cbranch_scc1 L_k2_attn_kernel_so
    s_branch L_k2_attn_kernel_sdone
L_k2_attn_kernel_js:
    s_cmp_lg_u32 s44, 8
    s_cbranch_scc1 L_k2_attn_kernel_n8s
    s_add_u32 s34, s93, 0
    s_mul_i32 s35, s34, 9363
    s_lshr_b32 s35, s35, 22
    s_mul_i32 s36, s35, 448
    s_sub_u32 s34, s34, s36
    s_lshr_b32 s36, s34, 2
    s_and_b32 s34, s34, 3
    s_cmp_ge_u32 s36, 56
    s_cselect_b32 s37, 56, 0
    s_sub_u32 s36, s36, s37
    s_lshr_b32 s46, s36, 2
    s_and_b32 s47, s36, 3
    s_sub_u32 s62, s36, 32
    s_mul_i32 s63, s62, 43
    s_lshr_b32 s63, s63, 7
    s_mul_i32 s90, s63, 3
    s_sub_u32 s62, s62, s90
    s_add_u32 s90, s62, 2
    s_cmp_lt_u32 s36, 32
    s_cselect_b32 s46, s46, s63
    s_cselect_b32 s90, s47, s90
    s_cselect_b32 s47, s47, s62
    s_lshr_b32 s47, s47, 1
    s_lshl_b32 s47, s47, 1
    s_add_u32 s90, s90, s47
    s_mul_i32 s46, s46, 7
    s_add_u32 s46, s46, s90
    s_add_u32 s46, s46, s37
    s_lshl_b32 s46, s46, 2
    s_add_u32 s34, s34, s46
    s_lshl_b32 s34, s34, 14
    s_lshl_b32 s35, s35, 7
    s_add_u32 s35, s35, s34
    buffer_load_dwordx4 v[156:159], v184, s[48:51], s35 offen
    s_add_u32 s34, s93, 1024
    s_mul_i32 s35, s34, 9363
    s_lshr_b32 s35, s35, 22
    s_mul_i32 s36, s35, 448
    s_sub_u32 s34, s34, s36
    s_lshr_b32 s36, s34, 2
    s_and_b32 s34, s34, 3
    s_cmp_ge_u32 s36, 56
    s_cselect_b32 s37, 56, 0
    s_sub_u32 s36, s36, s37
    s_lshr_b32 s46, s36, 2
    s_and_b32 s47, s36, 3
    s_sub_u32 s62, s36, 32
    s_mul_i32 s63, s62, 43
    s_lshr_b32 s63, s63, 7
    s_mul_i32 s90, s63, 3
    s_sub_u32 s62, s62, s90
    s_add_u32 s90, s62, 2
    s_cmp_lt_u32 s36, 32
    s_cselect_b32 s46, s46, s63
    s_cselect_b32 s90, s47, s90
    s_cselect_b32 s47, s47, s62
    s_lshr_b32 s47, s47, 1
    s_lshl_b32 s47, s47, 1
    s_add_u32 s90, s90, s47
    s_mul_i32 s46, s46, 7
    s_add_u32 s46, s46, s90
    s_add_u32 s46, s46, s37
    s_lshl_b32 s46, s46, 2
    s_add_u32 s34, s34, s46
    s_lshl_b32 s34, s34, 14
    s_lshl_b32 s35, s35, 7
    s_add_u32 s35, s35, s34
    buffer_load_dwordx4 v[160:163], v184, s[48:51], s35 offen
    s_branch L_k2_attn_kernel_gos
L_k2_attn_kernel_n8s:
    s_cmp_lg_u32 s44, 7
    s_cbranch_scc1 L_k2_attn_kernel_n7s
    s_add_u32 s34, s93, 2048
    s_mul_i32 s35, s34, 9363
    s_lshr_b32 s35, s35, 22
    s_mul_i32 s36, s35, 448
    s_sub_u32 s34, s34, s36
    s_lshr_b32 s36, s34, 2
    s_and_b32 s34, s34, 3
    s_cmp_ge_u32 s36, 56
    s_cselect_b32 s37, 56, 0
    s_sub_u32 s36, s36, s37
    s_lshr_b32 s46, s36, 2
    s_and_b32 s47, s36, 3
    s_sub_u32 s62, s36, 32
    s_mul_i32 s63, s62, 43
    s_lshr_b32 s63, s63, 7
    s_mul_i32 s90, s63, 3
    s_sub_u32 s62, s62, s90
    s_add_u32 s90, s62, 2
    s_cmp_lt_u32 s36, 32
    s_cselect_b32 s46, s46, s63
    s_cselect_b32 s90, s47, s90
    s_cselect_b32 s47, s47, s62
    s_lshr_b32 s47, s47, 1
    s_lshl_b32 s47, s47, 1
    s_add_u32 s90, s90, s47
    s_mul_i32 s46, s46, 7
    s_add_u32 s46, s46, s90
    s_add_u32 s46, s46, s37
    s_lshl_b32 s46, s46, 2
    s_add_u32 s34, s34, s46
    s_lshl_b32 s34, s34, 14
    s_lshl_b32 s35, s35, 7
    s_add_u32 s35, s35, s34
    buffer_load_dwordx4 v[164:167], v184, s[48:51], s35 offen
    s_add_u32 s34, s93, 3072
    s_mul_i32 s35, s34, 9363
    s_lshr_b32 s35, s35, 22
    s_mul_i32 s36, s35, 448
    s_sub_u32 s34, s34, s36
    s_lshr_b32 s36, s34, 2
    s_and_b32 s34, s34, 3
    s_cmp_ge_u32 s36, 56
    s_cselect_b32 s37, 56, 0
    s_sub_u32 s36, s36, s37
    s_lshr_b32 s46, s36, 2
    s_and_b32 s47, s36, 3
    s_sub_u32 s62, s36, 32
    s_mul_i32 s63, s62, 43
    s_lshr_b32 s63, s63, 7
    s_mul_i32 s90, s63, 3
    s_sub_u32 s62, s62, s90
    s_add_u32 s90, s62, 2
    s_cmp_lt_u32 s36, 32
    s_cselect_b32 s46, s46, s63
    s_cselect_b32 s90, s47, s90
    s_cselect_b32 s47, s47, s62
    s_lshr_b32 s47, s47, 1
    s_lshl_b32 s47, s47, 1
    s_add_u32 s90, s90, s47
    s_mul_i32 s46, s46, 7
    s_add_u32 s46, s46, s90
    s_add_u32 s46, s46, s37
    s_lshl_b32 s46, s46, 2
    s_add_u32 s34, s34, s46
    s_lshl_b32 s34, s34, 14
    s_lshl_b32 s35, s35, 7
    s_add_u32 s35, s35, s34
    buffer_load_dwordx4 v[168:171], v184, s[48:51], s35 offen
    s_branch L_k2_attn_kernel_gos
L_k2_attn_kernel_n7s:
    s_cmp_lg_u32 s44, 6
    s_cbranch_scc1 L_k2_attn_kernel_n6s
    s_add_u32 s34, s93, 4096
    s_mul_i32 s35, s34, 9363
    s_lshr_b32 s35, s35, 22
    s_mul_i32 s36, s35, 448
    s_sub_u32 s34, s34, s36
    s_lshr_b32 s36, s34, 2
    s_and_b32 s34, s34, 3
    s_cmp_ge_u32 s36, 56
    s_cselect_b32 s37, 56, 0
    s_sub_u32 s36, s36, s37
    s_lshr_b32 s46, s36, 2
    s_and_b32 s47, s36, 3
    s_sub_u32 s62, s36, 32
    s_mul_i32 s63, s62, 43
    s_lshr_b32 s63, s63, 7
    s_mul_i32 s90, s63, 3
    s_sub_u32 s62, s62, s90
    s_add_u32 s90, s62, 2
    s_cmp_lt_u32 s36, 32
    s_cselect_b32 s46, s46, s63
    s_cselect_b32 s90, s47, s90
    s_cselect_b32 s47, s47, s62
    s_lshr_b32 s47, s47, 1
    s_lshl_b32 s47, s47, 1
    s_add_u32 s90, s90, s47
    s_mul_i32 s46, s46, 7
    s_add_u32 s46, s46, s90
    s_add_u32 s46, s46, s37
    s_lshl_b32 s46, s46, 2
    s_add_u32 s34, s34, s46
    s_lshl_b32 s34, s34, 14
    s_lshl_b32 s35, s35, 7
    s_add_u32 s35, s35, s34
    buffer_load_dwordx4 v[172:175], v184, s[48:51], s35 offen
    s_branch L_k2_attn_kernel_gos
L_k2_attn_kernel_n6s:
    s_cmp_lg_u32 s44, 5
    s_cbranch_scc1 L_k2_attn_kernel_n5s
    s_waitcnt vmcnt(6)
    s_add_u32 s35, s93, 0
    s_lshl_b32 s35, s35, 10
    buffer_store_dwordx4 v[156:159], v185, s[52:55], s35 offen sc1
    s_add_u32 s35, s93, 1024
    s_lshl_b32 s35, s35, 10
    buffer_store_dwordx4 v[160:163], v185, s[52:55], s35 offen sc1
    s_add_u32 s34, s93, 5120
    s_mul_i32 s35, s34, 9363
    s_lshr_b32 s35, s35, 22
    s_mul_i32 s36, s35, 448
    s_sub_u32 s34, s34, s36
    s_lshr_b32 s36, s34, 2
    s_and_b32 s34, s34, 3
    s_cmp_ge_u32 s36, 56
    s_cselect_b32 s37, 56, 0
    s_sub_u32 s36, s36, s37
    s_lshr_b32 s46, s36, 2
    s_and_b32 s47, s36, 3
    s_sub_u32 s62, s36, 32
    s_mul_i32 s63, s62, 43
    s_lshr_b32 s63, s63, 7
    s_mul_i32 s90, s63, 3
    s_sub_u32 s62, s62, s90
    s_add_u32 s90, s62, 2
    s_cmp_lt_u32 s36, 32
    s_cselect_b32 s46, s46, s63
    s_cselect_b32 s90, s47, s90
    s_cselect_b32 s47, s47, s62
    s_lshr_b32 s47, s47, 1
    s_lshl_b32 s47, s47, 1
    s_add_u32 s90, s90, s47
    s_mul_i32 s46, s46, 7
    s_add_u32 s46, s46, s90
    s_add_u32 s46, s46, s37
    s_lshl_b32 s46, s46, 2
    s_add_u32 s34, s34, s46
    s_lshl_b32 s34, s34, 14
    s_lshl_b32 s35, s35, 7
    s_add_u32 s35, s35, s34
    buffer_load_dwordx4 v[176:179], v184, s[48:51], s35 offen
    s_branch L_k2_attn_kernel_gos
L_k2_attn_kernel_n5s:
    s_cmp_lg_u32 s44, 4
    s_cbranch_scc1 L_k2_attn_kernel_n4s
    s_waitcnt vmcnt(7)
    s_add_u32 s35, s93, 2048
    s_lshl_b32 s35, s35, 10
    buffer_store_dwordx4 v[164:167], v185, s[52:55], s35 offen sc1
    s_add_u32 s35, s93, 3072
    s_lshl_b32 s35, s35, 10
    buffer_store_dwordx4 v[168:171], v185, s[52:55], s35 offen sc1
    s_add_u32 s34, s93, 6144
    s_mul_i32 s35, s34, 9363
    s_lshr_b32 s35, s35, 22
    s_mul_i32 s36, s35, 448
    s_sub_u32 s34, s34, s36
    s_lshr_b32 s36, s34, 2
    s_and_b32 s34, s34, 3
    s_cmp_ge_u32 s36, 56
    s_cselect_b32 s37, 56, 0
    s_sub_u32 s36, s36, s37
    s_lshr_b32 s46, s36, 2
    s_and_b32 s47, s36, 3
    s_sub_u32 s62, s36, 32
    s_mul_i32 s63, s62, 43
    s_lshr_b32 s63, s63, 7
    s_mul_i32 s90, s63, 3
    s_sub_u32 s62, s62, s90
    s_add_u32 s90, s62, 2
    s_cmp_lt_u32 s36, 32
    s_cselect_b32 s46, s46, s63
    s_cselect_b32 s90, s47, s90
    s_cselect_b32 s47, s47, s62
    s_lshr_b32 s47, s47, 1
    s_lshl_b32 s47, s47, 1
    s_add_u32 s90, s90, s47
    s_mul_i32 s46, s46, 7
    s_add_u32 s46, s46, s90
    s_add_u32 s46, s46, s37
    s_lshl_b32 s46, s46, 2
    s_add_u32 s34, s34, s46
    s_lshl_b32 s34, s34, 14
    s_lshl_b32 s35, s35, 7
    s_add_u32 s35, s35, s34
    buffer_load_dwordx4 v[180:183], v184, s[48:51], s35 offen
    s_branch L_k2_attn_kernel_gos
L_k2_attn_kernel_n4s:
    s_cmp_lg_u32 s44, 3
    s_cbranch_scc1 L_k2_attn_kernel_n3s
    s_waitcnt vmcnt(5)
    s_add_u32 s35, s93, 4096
    s_lshl_b32 s35, s35, 10
    buffer_store_dwordx4 v[172:175], v185, s[52:55], s35 offen sc1
    s_add_u32 s35, s93, 5120
    s_lshl_b32 s35, s35, 10
    buffer_store_dwordx4 v[176:179], v185, s[52:55], s35 offen sc1
    s_lshr_b32 s33, s2, 3
    s_lshl_b32 s33, s33, 2
    s_and_b32 s34, s24, 3
    s_add_u32 s33, s33, s34
    s_lshl_b32 s34, s33, 13
    v_lshlrev_b32 v4, 7, v0
    v_add_u32 v5, s34, v4
    global_load_dword v154, v5, s[80:81]
    s_branch L_k2_attn_kernel_gos
L_k2_attn_kernel_n3s:
    s_waitcnt vmcnt(5)
    s_add_u32 s35, s93, 6144
    s_lshl_b32 s35, s35, 10
    buffer_store_dwordx4 v[180:183], v185, s[52:55], s35 offen sc1
    s_lshr_b32 s33, s2, 3
    s_lshl_b32 s33, s33, 2
    s_and_b32 s34, s24, 3
    s_add_u32 s33, s33, s34
    s_lshl_b32 s34, s33, 13
    s_add_u32 s34, s34, 0x100000
    v_lshlrev_b32 v4, 7, v0
    v_add_u32 v5, s34, v4
    global_load_dword v154, v5, s[80:81]
    s_lshl_b32 s34, s33, 12
    s_and_b32 s35, s2, 7
    s_lshl_b32 s35, s35, 19
    s_add_u32 s34, s34, s35
    v_add_u32 v5, s34, v4
    s_mov_b32 exec_lo, -1
    s_mov_b32 exec_hi, 0
    global_load_dword v154, v5, s[98:99]
    s_mov_b64 exec, -1
    s_branch L_k2_attn_kernel_gos
L_k2_attn_kernel_sdone:
    v_lshlrev_b32 v4, 3, v0
    s_lshl_b32 s33, s24, 9
    s_add_u32 s33, s33, 131136
    v_add_u32 v5, s33, v4
    ds_write_b64 v5, v[152:153]
    s_xor_b32 s34, s24, 4
    s_lshl_b32 s34, s34, 9
    s_add_u32 s34, s34, 131136
    v_add_u32 v5, s34, v4
    s_waitcnt lgkmcnt(0)
    s_barrier
    ds_read_b64 v[6:7], v5
    s_waitcnt lgkmcnt(0)
    v_max_f32 v6, v6, v152
    v_sub_f32 v6, v152, v6
    v_exp_f32 v6, v6
    s_nop 0
    v_mul_f32 v76, v76, v6
    v_mul_f32 v77, v77, v6
    v_mul_f32 v78, v78, v6
    v_mul_f32 v79, v79, v6
    v_mul_f32 v80, v80, v6
    v_mul_f32 v81, v81, v6
    v_mul_f32 v82, v82, v6
    v_mul_f32 v83, v83, v6
    v_mul_f32 v84, v84, v6
    v_mul_f32 v85, v85, v6
    v_mul_f32 v86, v86, v6
    v_mul_f32 v87, v87, v6
    v_mul_f32 v88, v88, v6
    v_mul_f32 v89, v89, v6
    v_mul_f32 v90, v90, v6
    v_mul_f32 v91, v91, v6
    v_mul_f32 v108, v108, v6
    v_max_f32 v7, v7, v153
    v_sub_f32 v7, v153, v7
    v_exp_f32 v7, v7
    s_nop 0
    v_mul_f32 v92, v92, v7
    v_mul_f32 v93, v93, v7
    v_mul_f32 v94, v94, v7
    v_mul_f32 v95, v95, v7
    v_mul_f32 v96, v96, v7
    v_mul_f32 v97, v97, v7
    v_mul_f32 v98, v98, v7
    v_mul_f32 v99, v99, v7
    v_mul_f32 v100, v100, v7
    v_mul_f32 v101, v101, v7
    v_mul_f32 v102, v102, v7
    v_mul_f32 v103, v103, v7
    v_mul_f32 v104, v104, v7
    v_mul_f32 v105, v105, v7
    v_mul_f32 v106, v106, v7
    v_mul_f32 v107, v107, v7
    v_mul_f32 v112, v112, v7
L_k2_attn_kernel_fin:
    s_cmp_lg_u32 s24, 0
    s_cbranch_scc1 L_cpf_k2_attn_kernel
    s_getpc_b64 s[46:47]
L_cpfpc_k2_attn_kernel:
    s_add_u32 s46, s46, k3_ffn_kernel-L_cpfpc_k2_attn_kernel
    s_addc_u32 s47, s47, 0
    v_lshlrev_b32 v8, 7, v0
    s_mov_b32 exec_lo, 0xffffffff
    s_mov_b32 exec_hi, 0xff
    global_load_dword v9, v8, s[46:47]
    s_mov_b64 exec, -1
L_cpf_k2_attn_kernel:
    v_lshlrev_b32 v4, 4, v0
    s_lshl_b32 s33, s24, 12
    v_add_u32 v5, s33, v4
    s_xor_b32 s34, s24, 4
    s_lshl_b32 s35, s34, 12
    v_add_u32 v6, s35, v4
    v_lshlrev_b32 v4, 2, v0
    s_lshl_b32 s33, s24, 8
    s_add_u32 s33, s33, 135424
    v_add_u32 v7, s33, v4
    s_lshl_b32 s34, s34, 8
    s_add_u32 s34, s34, 135424
    v_add_u32 v8, s34, v4
    s_nop 3
    s_cmp_lg_u32 s30, 0
    s_cbranch_scc1 L_k2_attn_kernel_keepb
    ds_write_b128 v5, v[92:95] offset:0
    ds_write_b128 v5, v[96:99] offset:1024
    ds_write_b128 v5, v[100:103] offset:2048
    ds_write_b128 v5, v[104:107] offset:3072
    ds_write_b32 v7, v112
    s_branch L_k2_attn_kernel_join
L_k2_attn_kernel_keepb:
    ds_write_b128 v5, v[76:79] offset:0
    ds_write_b128 v5, v[80:83] offset:1024
    ds_write_b128 v5, v[84:87] offset:2048
    ds_write_b128 v5, v[88:91] offset:3072
    ds_write_b32 v7, v108
    s_waitcnt lgkmcnt(0)
    v_mov_b64 v[76:77], v[92:93]
    v_mov_b64 v[78:79], v[94:95]
    v_mov_b64 v[80:81], v[96:97]
    v_mov_b64 v[82:83], v[98:99]
    v_mov_b64 v[84:85], v[100:101]
    v_mov_b64 v[86:87], v[102:103]
    v_mov_b64 v[88:89], v[104:105]
    v_mov_b64 v[90:91], v[106:107]
    v_mov_b32 v108, v112
L_k2_attn_kernel_join:
    s_waitcnt lgkmcnt(0)
    s_barrier
    ds_read_b128 v[92:95], v6 offset:0
    ds_read_b128 v[96:99], v6 offset:1024
    ds_read_b128 v[100:103], v6 offset:2048
    ds_read_b128 v[104:107], v6 offset:3072
    ds_read_b32 v112, v8
    v_bfe_u32 v4, v0, 4, 1
    v_lshlrev_b32 v5, 11, v4
    v_lshrrev_b32 v4, 5, v0
    v_lshl_add_u32 v5, v4, 8, v5
    v_and_b32 v4, 15, v0
    v_lshl_add_u32 v5, v4, 4, v5
    s_lshr_b32 s33, s27, 1
    s_lshl_b32 s33, s33, 18
    s_and_b32 s34, s27, 1
    s_lshl_b32 s34, s34, 10
    s_add_u32 s33, s33, s34
    s_lshl_b32 s34, s25, 13
    s_add_u32 s33, s33, s34
    s_lshl_b32 s34, s30, 12
    s_add_u32 s33, s33, s34
    s_waitcnt lgkmcnt(0)
    v_add_f32 v108, v108, v112
    v_rcp_f32 v6, v108
    v_add_f32 v76, v76, v92
    v_add_f32 v77, v77, v93
    v_add_f32 v78, v78, v94
    v_add_f32 v79, v79, v95
    v_add_f32 v80, v80, v96
    v_add_f32 v81, v81, v97
    v_add_f32 v82, v82, v98
    v_add_f32 v83, v83, v99
    v_add_f32 v84, v84, v100
    v_add_f32 v85, v85, v101
    v_add_f32 v86, v86, v102
    v_add_f32 v87, v87, v103
    v_add_f32 v88, v88, v104
    v_add_f32 v89, v89, v105
    v_add_f32 v90, v90, v106
    v_add_f32 v91, v91, v107
    v_mul_f32 v76, v76, v6
    v_mul_f32 v77, v77, v6
    v_mul_f32 v78, v78, v6
    v_mul_f32 v79, v79, v6
    v_mul_f32 v80, v80, v6
    v_mul_f32 v81, v81, v6
    v_mul_f32 v82, v82, v6
    v_mul_f32 v83, v83, v6
    v_mul_f32 v84, v84, v6
    v_mul_f32 v85, v85, v6
    v_mul_f32 v86, v86, v6
    v_mul_f32 v87, v87, v6
    v_mul_f32 v88, v88, v6
    v_mul_f32 v89, v89, v6
    v_mul_f32 v90, v90, v6
    v_mul_f32 v91, v91, v6
    v_cvt_pk_bf16_f32 v60, v76, v77
    v_cvt_pk_bf16_f32 v61, v78, v79
    v_cvt_pk_bf16_f32 v62, v80, v81
    v_cvt_pk_bf16_f32 v63, v82, v83
    v_cvt_pk_bf16_f32 v64, v84, v85
    v_cvt_pk_bf16_f32 v65, v86, v87
    v_cvt_pk_bf16_f32 v66, v88, v89
    v_cvt_pk_bf16_f32 v67, v90, v91
    buffer_store_dwordx4 v[60:63], v5, s[16:19], s33 offen offset:0
    buffer_store_dwordx4 v[64:67], v5, s[16:19], s33 offen offset:512
L_k2_attn_kernel_end:
    s_endpgm
.globl k3_ffn_kernel
.p2align 8
.type k3_ffn_kernel,@function
k3_ffn_kernel:
    s_cmp_ge_u32 s2, 256
    s_cbranch_scc1 L_k3_ffn_kernel_end
    s_load_dwordx2 s[4:5], s[0:1], 88
    s_load_dwordx2 s[80:81], s[0:1], 32
    s_load_dwordx2 s[82:83], s[0:1], 0
    s_load_dwordx4 s[84:87], s[0:1], 48
    s_load_dwordx2 s[88:89], s[0:1], 72
    v_lshrrev_b32 v10, 6, v0
    v_and_b32 v0, 63, v0
    s_nop 0
    v_readfirstlane_b32 s24, v10
    s_waitcnt lgkmcnt(0)
    s_mov_b64 s[40:41], s[80:81]
    s_mov_b64 s[42:43], s[82:83]
    s_mov_b64 s[48:49], s[84:85]
    s_mov_b64 s[50:51], s[86:87]
    s_and_b32 s3, s2, 7
    s_lshr_b32 s30, s2, 3
    s_lshr_b32 s25, s3, 1
    s_lshl_b32 s25, s25, 2
    s_and_b32 s33, s30, 3
    s_add_u32 s25, s25, s33
    s_and_b32 s26, s3, 1
    s_lshl_b32 s26, s26, 3
    s_lshr_b32 s33, s30, 2
    s_add_u32 s26, s26, s33
    s_lshl_b32 s25, s3, 1
    s_and_b32 s33, s30, 1
    s_add_u32 s25, s25, s33
    s_lshr_b32 s26, s30, 1
    s_lshl_b32 s33, s25, 2
    s_add_u32 s33, s33, s24
    s_lshl_b32 s33, s33, 12
    v_lshlrev_b32 v1, 4, v0
    v_add_u32 v1, s33, v1
    v_lshrrev_b32 v10, 3, v0
    s_lshl_b32 s33, s24, 4
    v_add_u32 v10, s33, v10
    s_mov_b32 s34, 2048
    v_mul_lo_u32 v10, v10, s34
    s_lshl_b32 s33, s26, 7
    v_add_u32 v10, s33, v10
    v_and_b32 v11, 7, v0
    v_bfe_u32 v12, v0, 4, 2
    v_lshlrev_b32 v12, 1, v12
    v_xor_b32 v11, v11, v12
    v_lshl_add_u32 v3, v11, 4, v10
    v_add_u32 v4, 15360, v3
    s_lshl_b32 s29, s24, 11
    v_lshrrev_b32 v10, 4, v0
    v_bfe_u32 v11, v0, 2, 2
    v_lshrrev_b32 v12, 1, v10
    v_lshlrev_b32 v12, 4, v12
    v_and_b32 v13, 1, v10
    v_lshl_add_u32 v12, v13, 2, v12
    v_add_u32 v12, v12, v11
    v_lshlrev_b32 v12, 7, v12
    v_and_b32 v13, 3, v0
    v_lshl_add_u32 v12, v13, 3, v12
    v_lshrrev_b32 v11, 1, v11
    v_and_b32 v10, 1, v10
    v_lshl_or_b32 v10, v10, 1, v11
    v_lshl_or_b32 v6, v10, 5, v12
    v_xor_b32 v7, 32, v6
    v_xor_b32 v8, 64, v6
    v_xor_b32 v9, 96, v6
    s_waitcnt lgkmcnt(0)
    s_add_u32 s8, s4, 5242880
    s_addc_u32 s9, s5, 0
    s_and_b32 s9, s9, 0xffff
    s_mov_b32 s10, 4194304
    s_mov_b32 s11, 0x20000
    s_mov_b32 s12, s40
    s_and_b32 s13, s41, 0xffff
    s_mov_b32 s14, 2097152
    s_mov_b32 s15, 0x20000
    s_mov_b32 s20, s42
    s_and_b32 s21, s43, 0xffff
    s_mov_b32 s22, 4194304
    s_mov_b32 s23, 0x20000
    s_add_u32 s16, s4, 4476928
    s_addc_u32 s17, s5, 0
    s_and_b32 s17, s17, 0xffff
    s_mov_b32 s18, 4096
    s_mov_b32 s19, 0x20000
    v_lshlrev_b32 v10, 4, v0
    s_lshl_b32 s33, s24, 10
    s_add_u32 m0, s33, 32768
    s_nop 0
    buffer_load_dwordx4 v10, s[16:19], s33 offen lds
    v_and_b32 v10, 1, v0
    v_lshlrev_b32 v10, 6, v10
    v_lshrrev_b32 v11, 4, v0
    v_lshl_add_u32 v138, v11, 4, v10
    v_add_u32 v138, 32768, v138
    s_mov_b32 s27, 0
    s_mov_b32 s28, 0
    s_add_u32 m0, s29, 0
    s_nop 0
    buffer_load_dwordx4 v3, s[12:15], s28 offen lds
    buffer_load_dwordx4 v4, s[12:15], s28 offen offset:1024 lds
    s_add_u32 s28, s28, 131072
    s_add_u32 m0, s29, 8192
    s_nop 0
    buffer_load_dwordx4 v3, s[12:15], s28 offen lds
    buffer_load_dwordx4 v4, s[12:15], s28 offen offset:1024 lds
    s_add_u32 s28, s28, 131072
    buffer_load_dwordx4 a[0:3], v1, s[8:11], s27 offen offset:0
    buffer_load_dwordx4 a[8:11], v1, s[8:11], s27 offen offset:1024
    buffer_load_dwordx4 a[4:7], v1, s[8:11], s27 offen offset:2048
    buffer_load_dwordx4 a[12:15], v1, s[8:11], s27 offen offset:3072
    s_add_u32 s27, s27, 262144
    s_add_u32 m0, s29, 16384
    s_nop 0
    buffer_load_dwordx4 v3, s[12:15], s28 offen lds
    buffer_load_dwordx4 v4, s[12:15], s28 offen offset:1024 lds
    s_add_u32 s28, s28, 131072
    buffer_load_dwordx4 a[16:19], v1, s[8:11], s27 offen offset:0
    buffer_load_dwordx4 a[24:27], v1, s[8:11], s27 offen offset:1024
    buffer_load_dwordx4 a[20:23], v1, s[8:11], s27 offen offset:2048
    buffer_load_dwordx4 a[28:31], v1, s[8:11], s27 offen offset:3072
    s_add_u32 s27, s27, 262144
    s_add_u32 m0, s29, 24576
    s_nop 0
    buffer_load_dwordx4 v3, s[12:15], s28 offen lds
    buffer_load_dwordx4 v4, s[12:15], s28 offen offset:1024 lds
    s_add_u32 s28, s28, 131072
    buffer_load_dwordx4 a[32:35], v1, s[8:11], s27 offen offset:0
    buffer_load_dwordx4 a[40:43], v1, s[8:11], s27 offen offset:1024
    buffer_load_dwordx4 a[36:39], v1, s[8:11], s27 offen offset:2048
    buffer_load_dwordx4 a[44:47], v1, s[8:11], s27 offen offset:3072
    s_add_u32 s27, s27, 262144
    s_lshl_b32 s33, s25, 2
    s_add_u32 s33, s33, s24
    s_lshl_b32 s33, s33, 16
    s_lshl_b32 s34, s26, 7
    s_add_u32 s33, s33, s34
    v_lshrrev_b32 v10, 3, v0
    v_lshlrev_b32 v10, 11, v10
    v_add_u32 v10, s33, v10
    v_and_b32 v11, 7, v0
    v_lshrrev_b32 v12, 4, v0
    v_xor_b32 v11, v11, v12
    v_lshl_add_u32 v140, v11, 4, v10
    v_xor_b32 v11, 4, v11
    v_lshl_add_u32 v141, v11, 4, v10
    v_add_u32 v142, 32768, v140
    v_add_u32 v143, 49152, v141
    v_add_u32 v141, 16384, v141
    s_lshl_b32 s37, s24, 12
    s_add_u32 s37, s37, 37120
    s_add_u32 m0, s37, 0
    s_nop 0
    buffer_load_dwordx4 v140, s[20:23], 0 offen lds
    s_add_u32 m0, s37, 1024
    s_nop 0
    buffer_load_dwordx4 v141, s[20:23], 0 offen lds
    s_add_u32 m0, s37, 2048
    s_nop 0
    buffer_load_dwordx4 v142, s[20:23], 0 offen lds
    s_add_u32 m0, s37, 3072
    s_nop 0
    buffer_load_dwordx4 v143, s[20:23], 0 offen lds
    s_add_u32 s20, s4, 4460544
    s_addc_u32 s21, s5, 0
    s_and_b32 s21, s21, 0xffff
    s_mov_b32 s22, 16384
    s_mov_b32 s23, 0x20000
    v_and_b32 v10, 15, v0
    s_lshl_b32 s33, s25, 2
    s_add_u32 s33, s33, s24
    s_lshl_b32 s33, s33, 5
    v_add_u32 v10, s33, v10
    v_lshlrev_b32 v10, 3, v10
    buffer_load_dword v136, v10, s[20:23], 0 offen offset:0
    buffer_load_dword v137, v10, s[20:23], 0 offen offset:128
    v_mov_b32 v112, 0
    v_mov_b32 v113, 0
    v_mov_b32 v114, 0
    v_mov_b32 v115, 0
    v_mov_b32 v116, 0
    v_mov_b32 v117, 0
    v_mov_b32 v118, 0
    v_mov_b32 v119, 0
    v_mov_b64 v[16:17], 0
    v_mov_b64 v[18:19], 0
    v_mov_b64 v[20:21], 0
    v_mov_b64 v[22:23], 0
    v_mov_b64 v[24:25], 0
    v_mov_b64 v[26:27], 0
    v_mov_b64 v[28:29], 0
    v_mov_b64 v[30:31], 0
    v_mov_b64 v[32:33], 0
    v_mov_b64 v[34:35], 0
    v_mov_b64 v[36:37], 0
    v_mov_b64 v[38:39], 0
    v_mov_b64 v[40:41], 0
    v_mov_b64 v[42:43], 0
    v_mov_b64 v[44:45], 0
    v_mov_b64 v[46:47], 0
    s_waitcnt vmcnt(24)
    s_barrier
    ds_read_b64_tr_b16 v[48:49], v6 offset:0
    ds_read_b64_tr_b16 v[50:51], v6 offset:1024
    ds_read_b64_tr_b16 v[52:53], v7 offset:0
    ds_read_b64_tr_b16 v[54:55], v7 offset:1024
    ds_read_b64_tr_b16 v[56:57], v8 offset:0
    ds_read_b64_tr_b16 v[58:59], v8 offset:1024
    ds_read_b64_tr_b16 v[60:61], v9 offset:0
    ds_read_b64_tr_b16 v[62:63], v9 offset:1024
    ds_read_b64_tr_b16 v[64:65], v6 offset:4096
    ds_read_b64_tr_b16 v[66:67], v6 offset:5120
    ds_read_b64_tr_b16 v[68:69], v7 offset:4096
    ds_read_b64_tr_b16 v[70:71], v7 offset:5120
    ds_read_b64_tr_b16 v[72:73], v8 offset:4096
    ds_read_b64_tr_b16 v[74:75], v8 offset:5120
    ds_read_b64_tr_b16 v[76:77], v9 offset:4096
    ds_read_b64_tr_b16 v[78:79], v9 offset:5120
    ds_read_b128 v[120:123], v138 offset:0
    ds_read_b128 v[124:127], v138 offset:128
    s_mov_b32 s44, 4
L_k3_ffn_kernel_3_loop:
    s_waitcnt vmcnt(12) lgkmcnt(0)
    s_barrier
    s_add_u32 m0, s29, 0
    s_nop 0
    buffer_load_dwordx4 v3, s[12:15], s28 offen lds
    v_mfma_f32_16x16x32_bf16 v[16:19], v[48:51], a[0:3], v[16:19]
    buffer_load_dwordx4 v4, s[12:15], s28 offen offset:1024 lds
    s_add_u32 s28, s28, 131072
    ds_read_b128 v[128:131], v138 offset:256
    ds_read_b128 v[132:135], v138 offset:384
    v_mfma_f32_16x16x32_bf16 v[20:23], v[48:51], a[4:7], v[20:23]
    ds_read_b64_tr_b16 v[80:81], v6 offset:8192
    v_mfma_f32_16x16x32_bf16 v[24:27], v[52:55], a[0:3], v[24:27]
    buffer_load_dwordx4 a[48:51], v1, s[8:11], s27 offen offset:0
    ds_read_b64_tr_b16 v[82:83], v6 offset:9216
    v_mfma_f32_16x16x32_bf16 v[28:31], v[52:55], a[4:7], v[28:31]
    ds_read_b64_tr_b16 v[84:85], v7 offset:8192
    v_mfma_f32_16x16x32_bf16 v[32:35], v[56:59], a[0:3], v[32:35]
    buffer_load_dwordx4 a[56:59], v1, s[8:11], s27 offen offset:1024
    ds_read_b64_tr_b16 v[86:87], v7 offset:9216
    v_mfma_f32_16x16x32_bf16 v[36:39], v[56:59], a[4:7], v[36:39]
    ds_read_b64_tr_b16 v[88:89], v8 offset:8192
    v_mfma_f32_16x16x32_bf16 v[40:43], v[60:63], a[0:3], v[40:43]
    buffer_load_dwordx4 a[52:55], v1, s[8:11], s27 offen offset:2048
    ds_read_b64_tr_b16 v[90:91], v8 offset:9216
    v_mfma_f32_16x16x32_bf16 v[44:47], v[60:63], a[4:7], v[44:47]
    ds_read_b64_tr_b16 v[92:93], v9 offset:8192
    v_mfma_f32_16x16x32_bf16 v[112:115], v[120:123], a[0:3], v[112:115]
    buffer_load_dwordx4 a[60:63], v1, s[8:11], s27 offen offset:3072
    s_add_u32 s27, s27, 262144
    ds_read_b64_tr_b16 v[94:95], v9 offset:9216
    ds_read_b64_tr_b16 v[96:97], v6 offset:12288
    v_mfma_f32_16x16x32_bf16 v[116:119], v[120:123], a[4:7], v[116:119]
    ds_read_b64_tr_b16 v[98:99], v6 offset:13312
    v_mfma_f32_16x16x32_bf16 v[16:19], v[64:67], a[8:11], v[16:19]
    ds_read_b64_tr_b16 v[100:101], v7 offset:12288
    v_mfma_f32_16x16x32_bf16 v[20:23], v[64:67], a[12:15], v[20:23]
    ds_read_b64_tr_b16 v[102:103], v7 offset:13312
    v_mfma_f32_16x16x32_bf16 v[24:27], v[68:71], a[8:11], v[24:27]
    ds_read_b64_tr_b16 v[104:105], v8 offset:12288
    v_mfma_f32_16x16x32_bf16 v[28:31], v[68:71], a[12:15], v[28:31]
    ds_read_b64_tr_b16 v[106:107], v8 offset:13312
    v_mfma_f32_16x16x32_bf16 v[32:35], v[72:75], a[8:11], v[32:35]
    ds_read_b64_tr_b16 v[108:109], v9 offset:12288
    v_mfma_f32_16x16x32_bf16 v[36:39], v[72:75], a[12:15], v[36:39]
    ds_read_b64_tr_b16 v[110:111], v9 offset:13312
    v_mfma_f32_16x16x32_bf16 v[40:43], v[76:79], a[8:11], v[40:43]
    v_mfma_f32_16x16x32_bf16 v[44:47], v[76:79], a[12:15], v[44:47]
    v_mfma_f32_16x16x32_bf16 v[112:115], v[124:127], a[8:11], v[112:115]
    v_mfma_f32_16x16x32_bf16 v[116:119], v[124:127], a[12:15], v[116:119]
    s_waitcnt vmcnt(12) lgkmcnt(0)
    s_barrier
    s_add_u32 m0, s29, 8192
    s_nop 0
    buffer_load_dwordx4 v3, s[12:15], s28 offen lds
    v_mfma_f32_16x16x32_bf16 v[16:19], v[80:83], a[16:19], v[16:19]
    buffer_load_dwordx4 v4, s[12:15], s28 offen offset:1024 lds
    s_add_u32 s28, s28, 131072
    ds_read_b128 v[120:123], v138 offset:512
    ds_read_b128 v[124:127], v138 offset:640
    v_mfma_f32_16x16x32_bf16 v[20:23], v[80:83], a[20:23], v[20:23]
    ds_read_b64_tr_b16 v[48:49], v6 offset:16384
    v_mfma_f32_16x16x32_bf16 v[24:27], v[84:87], a[16:19], v[24:27]
    buffer_load_dwordx4 a[0:3], v1, s[8:11], s27 offen offset:0
    ds_read_b64_tr_b16 v[50:51], v6 offset:17408
    v_mfma_f32_16x16x32_bf16 v[28:31], v[84:87], a[20:23], v[28:31]
    ds_read_b64_tr_b16 v[52:53], v7 offset:16384
    v_mfma_f32_16x16x32_bf16 v[32:35], v[88:91], a[16:19], v[32:35]
    buffer_load_dwordx4 a[8:11], v1, s[8:11], s27 offen offset:1024
    ds_read_b64_tr_b16 v[54:55], v7 offset:17408
    v_mfma_f32_16x16x32_bf16 v[36:39], v[88:91], a[20:23], v[36:39]
    ds_read_b64_tr_b16 v[56:57], v8 offset:16384
    v_mfma_f32_16x16x32_bf16 v[40:43], v[92:95], a[16:19], v[40:43]
    buffer_load_dwordx4 a[4:7], v1, s[8:11], s27 offen offset:2048
    ds_read_b64_tr_b16 v[58:59], v8 offset:17408
    v_mfma_f32_16x16x32_bf16 v[44:47], v[92:95], a[20:23], v[44:47]
    ds_read_b64_tr_b16 v[60:61], v9 offset:16384
    v_mfma_f32_16x16x32_bf16 v[112:115], v[128:131], a[16:19], v[112:115]
    buffer_load_dwordx4 a[12:15], v1, s[8:11], s27 offen offset:3072
    s_add_u32 s27, s27, 262144
    ds_read_b64_tr_b16 v[62:63], v9 offset:17408
    ds_read_b64_tr_b16 v[64:65], v6 offset:20480
    v_mfma_f32_16x16x32_bf16 v[116:119], v[128:131], a[20:23], v[116:119]
    ds_read_b64_tr_b16 v[66:67], v6 offset:21504
    v_mfma_f32_16x16x32_bf16 v[16:19], v[96:99], a[24:27], v[16:19]
    ds_read_b64_tr_b16 v[68:69], v7 offset:20480
    v_mfma_f32_16x16x32_bf16 v[20:23], v[96:99], a[28:31], v[20:23]
    ds_read_b64_tr_b16 v[70:71], v7 offset:21504
    v_mfma_f32_16x16x32_bf16 v[24:27], v[100:103], a[24:27], v[24:27]
    ds_read_b64_tr_b16 v[72:73], v8 offset:20480
    v_mfma_f32_16x16x32_bf16 v[28:31], v[100:103], a[28:31], v[28:31]
    ds_read_b64_tr_b16 v[74:75], v8 offset:21504
    v_mfma_f32_16x16x32_bf16 v[32:35], v[104:107], a[24:27], v[32:35]
    ds_read_b64_tr_b16 v[76:77], v9 offset:20480
    v_mfma_f32_16x16x32_bf16 v[36:39], v[104:107], a[28:31], v[36:39]
    ds_read_b64_tr_b16 v[78:79], v9 offset:21504
    v_mfma_f32_16x16x32_bf16 v[40:43], v[108:111], a[24:27], v[40:43]
    v_mfma_f32_16x16x32_bf16 v[44:47], v[108:111], a[28:31], v[44:47]
    v_mfma_f32_16x16x32_bf16 v[112:115], v[132:135], a[24:27], v[112:115]
    v_mfma_f32_16x16x32_bf16 v[116:119], v[132:135], a[28:31], v[116:119]
    s_waitcnt vmcnt(12) lgkmcnt(0)
    s_barrier
    s_add_u32 m0, s29, 16384
    s_nop 0
    buffer_load_dwordx4 v3, s[12:15], s28 offen lds
    v_mfma_f32_16x16x32_bf16 v[16:19], v[48:51], a[32:35], v[16:19]
    buffer_load_dwordx4 v4, s[12:15], s28 offen offset:1024 lds
    s_add_u32 s28, s28, 131072
    ds_read_b128 v[128:131], v138 offset:768
    ds_read_b128 v[132:135], v138 offset:896
    v_mfma_f32_16x16x32_bf16 v[20:23], v[48:51], a[36:39], v[20:23]
    ds_read_b64_tr_b16 v[80:81], v6 offset:24576
    v_mfma_f32_16x16x32_bf16 v[24:27], v[52:55], a[32:35], v[24:27]
    buffer_load_dwordx4 a[16:19], v1, s[8:11], s27 offen offset:0
    ds_read_b64_tr_b16 v[82:83], v6 offset:25600
    v_mfma_f32_16x16x32_bf16 v[28:31], v[52:55], a[36:39], v[28:31]
    ds_read_b64_tr_b16 v[84:85], v7 offset:24576
    v_mfma_f32_16x16x32_bf16 v[32:35], v[56:59], a[32:35], v[32:35]
    buffer_load_dwordx4 a[24:27], v1, s[8:11], s27 offen offset:1024
    ds_read_b64_tr_b16 v[86:87], v7 offset:25600
    v_mfma_f32_16x16x32_bf16 v[36:39], v[56:59], a[36:39], v[36:39]
    ds_read_b64_tr_b16 v[88:89], v8 offset:24576
    v_mfma_f32_16x16x32_bf16 v[40:43], v[60:63], a[32:35], v[40:43]
    buffer_load_dwordx4 a[20:23], v1, s[8:11], s27 offen offset:2048
    ds_read_b64_tr_b16 v[90:91], v8 offset:25600
    v_mfma_f32_16x16x32_bf16 v[44:47], v[60:63], a[36:39], v[44:47]
    ds_read_b64_tr_b16 v[92:93], v9 offset:24576
    v_mfma_f32_16x16x32_bf16 v[112:115], v[120:123], a[32:35], v[112:115]
    buffer_load_dwordx4 a[28:31], v1, s[8:11], s27 offen offset:3072
    s_add_u32 s27, s27, 262144
    ds_read_b64_tr_b16 v[94:95], v9 offset:25600
    ds_read_b64_tr_b16 v[96:97], v6 offset:28672
    v_mfma_f32_16x16x32_bf16 v[116:119], v[120:123], a[36:39], v[116:119]
    ds_read_b64_tr_b16 v[98:99], v6 offset:29696
    v_mfma_f32_16x16x32_bf16 v[16:19], v[64:67], a[40:43], v[16:19]
    ds_read_b64_tr_b16 v[100:101], v7 offset:28672
    v_mfma_f32_16x16x32_bf16 v[20:23], v[64:67], a[44:47], v[20:23]
    ds_read_b64_tr_b16 v[102:103], v7 offset:29696
    v_mfma_f32_16x16x32_bf16 v[24:27], v[68:71], a[40:43], v[24:27]
    ds_read_b64_tr_b16 v[104:105], v8 offset:28672
    v_mfma_f32_16x16x32_bf16 v[28:31], v[68:71], a[44:47], v[28:31]
    ds_read_b64_tr_b16 v[106:107], v8 offset:29696
    v_mfma_f32_16x16x32_bf16 v[32:35], v[72:75], a[40:43], v[32:35]
    ds_read_b64_tr_b16 v[108:109], v9 offset:28672
    v_mfma_f32_16x16x32_bf16 v[36:39], v[72:75], a[44:47], v[36:39]
    ds_read_b64_tr_b16 v[110:111], v9 offset:29696
    v_mfma_f32_16x16x32_bf16 v[40:43], v[76:79], a[40:43], v[40:43]
    v_mfma_f32_16x16x32_bf16 v[44:47], v[76:79], a[44:47], v[44:47]
    v_mfma_f32_16x16x32_bf16 v[112:115], v[124:127], a[40:43], v[112:115]
    v_mfma_f32_16x16x32_bf16 v[116:119], v[124:127], a[44:47], v[116:119]
    s_waitcnt vmcnt(12) lgkmcnt(0)
    s_barrier
    s_add_u32 m0, s29, 24576
    s_nop 0
    buffer_load_dwordx4 v3, s[12:15], s28 offen lds
    v_mfma_f32_16x16x32_bf16 v[16:19], v[80:83], a[48:51], v[16:19]
    buffer_load_dwordx4 v4, s[12:15], s28 offen offset:1024 lds
    s_add_u32 s28, s28, 131072
    ds_read_b128 v[120:123], v138 offset:1024
    ds_read_b128 v[124:127], v138 offset:1152
    v_mfma_f32_16x16x32_bf16 v[20:23], v[80:83], a[52:55], v[20:23]
    ds_read_b64_tr_b16 v[48:49], v6 offset:0
    v_mfma_f32_16x16x32_bf16 v[24:27], v[84:87], a[48:51], v[24:27]
    buffer_load_dwordx4 a[32:35], v1, s[8:11], s27 offen offset:0
    ds_read_b64_tr_b16 v[50:51], v6 offset:1024
    v_mfma_f32_16x16x32_bf16 v[28:31], v[84:87], a[52:55], v[28:31]
    ds_read_b64_tr_b16 v[52:53], v7 offset:0
    v_mfma_f32_16x16x32_bf16 v[32:35], v[88:91], a[48:51], v[32:35]
    buffer_load_dwordx4 a[40:43], v1, s[8:11], s27 offen offset:1024
    ds_read_b64_tr_b16 v[54:55], v7 offset:1024
    v_mfma_f32_16x16x32_bf16 v[36:39], v[88:91], a[52:55], v[36:39]
    ds_read_b64_tr_b16 v[56:57], v8 offset:0
    v_mfma_f32_16x16x32_bf16 v[40:43], v[92:95], a[48:51], v[40:43]
    buffer_load_dwordx4 a[36:39], v1, s[8:11], s27 offen offset:2048
    ds_read_b64_tr_b16 v[58:59], v8 offset:1024
    v_mfma_f32_16x16x32_bf16 v[44:47], v[92:95], a[52:55], v[44:47]
    ds_read_b64_tr_b16 v[60:61], v9 offset:0
    v_mfma_f32_16x16x32_bf16 v[112:115], v[128:131], a[48:51], v[112:115]
    buffer_load_dwordx4 a[44:47], v1, s[8:11], s27 offen offset:3072
    s_add_u32 s27, s27, 262144
    ds_read_b64_tr_b16 v[62:63], v9 offset:1024
    ds_read_b64_tr_b16 v[64:65], v6 offset:4096
    v_mfma_f32_16x16x32_bf16 v[116:119], v[128:131], a[52:55], v[116:119]
    ds_read_b64_tr_b16 v[66:67], v6 offset:5120
    v_mfma_f32_16x16x32_bf16 v[16:19], v[96:99], a[56:59], v[16:19]
    ds_read_b64_tr_b16 v[68:69], v7 offset:4096
    v_mfma_f32_16x16x32_bf16 v[20:23], v[96:99], a[60:63], v[20:23]
    ds_read_b64_tr_b16 v[70:71], v7 offset:5120
    v_mfma_f32_16x16x32_bf16 v[24:27], v[100:103], a[56:59], v[24:27]
    ds_read_b64_tr_b16 v[72:73], v8 offset:4096
    v_mfma_f32_16x16x32_bf16 v[28:31], v[100:103], a[60:63], v[28:31]
    ds_read_b64_tr_b16 v[74:75], v8 offset:5120
    v_mfma_f32_16x16x32_bf16 v[32:35], v[104:107], a[56:59], v[32:35]
    ds_read_b64_tr_b16 v[76:77], v9 offset:4096
    v_mfma_f32_16x16x32_bf16 v[36:39], v[104:107], a[60:63], v[36:39]
    ds_read_b64_tr_b16 v[78:79], v9 offset:5120
    v_mfma_f32_16x16x32_bf16 v[40:43], v[108:111], a[56:59], v[40:43]
    v_mfma_f32_16x16x32_bf16 v[44:47], v[108:111], a[60:63], v[44:47]
    v_mfma_f32_16x16x32_bf16 v[112:115], v[132:135], a[56:59], v[112:115]
    v_mfma_f32_16x16x32_bf16 v[116:119], v[132:135], a[60:63], v[116:119]
    v_add_u32 v138, 1024, v138
    s_sub_u32 s44, s44, 1
    s_cmp_lg_u32 s44, 0
    s_cbranch_scc1 L_k3_ffn_kernel_3_loop
    s_cmp_lg_u32 s24, 0
    s_cbranch_scc1 L_cpf_k3_ffn_kernel_3
    s_getpc_b64 s[46:47]
L_cpfpc_k3_ffn_kernel_3:
    s_add_u32 s46, s46, L_k3_ffn_kernel_k4-L_cpfpc_k3_ffn_kernel_3
    s_addc_u32 s47, s47, 0
    v_lshlrev_b32 v14, 7, v0
    global_load_dword v15, v14, s[46:47]
    v_add_u32 v14, 0x2000, v14
    s_mov_b32 exec_lo, 0xffff
    s_mov_b32 exec_hi, 0x0
    global_load_dword v15, v14, s[46:47]
    s_mov_b64 exec, -1
L_cpf_k3_ffn_kernel_3:
    s_waitcnt vmcnt(0) lgkmcnt(0)
    v_and_b32 v10, 15, v0
    v_lshrrev_b32 v11, 1, v10
    v_lshrrev_b32 v12, 5, v0
    v_xor_b32 v11, v11, v12
    v_lshlrev_b32 v11, 4, v11
    v_lshl_add_u32 v11, v10, 7, v11
    v_bfe_u32 v12, v0, 4, 1
    v_lshl_add_u32 v11, v12, 3, v11
    v_add_u32 v140, s37, v11
    v_xor_b32 v141, 32, v140
    v_xor_b32 v142, 64, v140
    v_xor_b32 v143, 96, v140
    ds_read_b64 v[160:161], v140 offset:0
    ds_read_b64 v[162:163], v141 offset:0
    ds_read_b64 v[164:165], v142 offset:0
    ds_read_b64 v[166:167], v143 offset:0
    ds_read_b64 v[168:169], v140 offset:2048
    ds_read_b64 v[170:171], v141 offset:2048
    ds_read_b64 v[172:173], v142 offset:2048
    ds_read_b64 v[174:175], v143 offset:2048
    s_add_u32 s16, s4, 4616192
    s_addc_u32 s17, s5, 0
    s_and_b32 s17, s17, 0xffff
    s_mov_b32 s18, 8192
    s_mov_b32 s19, 0x20000
    s_add_u32 s8, s4, 13631488
    s_addc_u32 s9, s5, 0
    s_and_b32 s9, s9, 0xffff
    s_mov_b32 s10, 4194304
    s_mov_b32 s11, 0x20000
    s_add_u32 s20, s4, 4481024
    s_addc_u32 s21, s5, 0
    s_and_b32 s21, s21, 0xffff
    s_mov_b32 s22, 131072
    s_mov_b32 s23, 0x20000
    s_lshl_b32 s34, s26, 18
    v_and_b32 v144, 15, v0
    s_lshl_b32 s33, s25, 2
    s_add_u32 s33, s33, s24
    s_lshl_b32 s33, s33, 5
    v_add_u32 v144, s33, v144
    v_lshlrev_b32 v144, 6, v144
    v_lshrrev_b32 v145, 4, v144
    s_cmp_eq_u32 s26, 0
    s_cselect_b32 s36, 0, 0x7ff00000
    s_lshl_b32 s35, s26, 2
    s_waitcnt lgkmcnt(0)
    v_add_f32 v136, v136, v112
    v_add_f32 v136, v136, v113
    v_mov_b32 v13, 0
    v_lshlrev_b32 v10, 16, v160
    v_and_b32 v11, 0xffff0000, v160
    v_add_f32 v16, v16, v10
    v_add_f32 v17, v17, v11
    v_sub_f32 v16, v16, v136
    v_sub_f32 v17, v17, v136
    v_fmac_f32 v13, v16, v16
    v_fmac_f32 v13, v17, v17
    v_cvt_pk_bf16_f32 v80, v16, v17
    v_lshlrev_b32 v10, 16, v161
    v_and_b32 v11, 0xffff0000, v161
    v_add_f32 v18, v18, v10
    v_add_f32 v19, v19, v11
    v_sub_f32 v18, v18, v136
    v_sub_f32 v19, v19, v136
    v_fmac_f32 v13, v18, v18
    v_fmac_f32 v13, v19, v19
    v_cvt_pk_bf16_f32 v81, v18, v19
    v_lshlrev_b32 v10, 16, v162
    v_and_b32 v11, 0xffff0000, v162
    v_add_f32 v24, v24, v10
    v_add_f32 v25, v25, v11
    v_sub_f32 v24, v24, v136
    v_sub_f32 v25, v25, v136
    v_fmac_f32 v13, v24, v24
    v_fmac_f32 v13, v25, v25
    v_cvt_pk_bf16_f32 v82, v24, v25
    v_lshlrev_b32 v10, 16, v163
    v_and_b32 v11, 0xffff0000, v163
    v_add_f32 v26, v26, v10
    v_add_f32 v27, v27, v11
    v_sub_f32 v26, v26, v136
    v_sub_f32 v27, v27, v136
    v_fmac_f32 v13, v26, v26
    v_fmac_f32 v13, v27, v27
    v_cvt_pk_bf16_f32 v83, v26, v27
    v_lshlrev_b32 v10, 16, v164
    v_and_b32 v11, 0xffff0000, v164
    v_add_f32 v32, v32, v10
    v_add_f32 v33, v33, v11
    v_sub_f32 v32, v32, v136
    v_sub_f32 v33, v33, v136
    v_fmac_f32 v13, v32, v32
    v_fmac_f32 v13, v33, v33
    v_cvt_pk_bf16_f32 v84, v32, v33
    v_lshlrev_b32 v10, 16, v165
    v_and_b32 v11, 0xffff0000, v165
    v_add_f32 v34, v34, v10
    v_add_f32 v35, v35, v11
    v_sub_f32 v34, v34, v136
    v_sub_f32 v35, v35, v136
    v_fmac_f32 v13, v34, v34
    v_fmac_f32 v13, v35, v35
    v_cvt_pk_bf16_f32 v85, v34, v35
    v_lshlrev_b32 v10, 16, v166
    v_and_b32 v11, 0xffff0000, v166
    v_add_f32 v40, v40, v10
    v_add_f32 v41, v41, v11
    v_sub_f32 v40, v40, v136
    v_sub_f32 v41, v41, v136
    v_fmac_f32 v13, v40, v40
    v_fmac_f32 v13, v41, v41
    v_cvt_pk_bf16_f32 v86, v40, v41
    v_lshlrev_b32 v10, 16, v167
    v_and_b32 v11, 0xffff0000, v167
    v_add_f32 v42, v42, v10
    v_add_f32 v43, v43, v11
    v_sub_f32 v42, v42, v136
    v_sub_f32 v43, v43, v136
    v_fmac_f32 v13, v42, v42
    v_fmac_f32 v13, v43, v43
    v_cvt_pk_bf16_f32 v87, v42, v43
    buffer_store_dwordx4 v[80:83], v1, s[8:11], s34 offen offset:0 sc1
    buffer_store_dwordx4 v[84:87], v1, s[8:11], s34 offen offset:1024 sc1
    v_mov_b32 v14, v13
    s_nop 1
    v_permlane16_swap_b32 v13, v14
    v_add_f32 v13, v13, v14
    v_mov_b32 v14, v13
    s_nop 1
    v_permlane32_swap_b32 v13, v14
    v_add_f32 v13, v13, v14
    s_mov_b64 exec, 0xffff
    buffer_store_dword v13, v144, s[20:23], s35 offen offset:0 sc1
    buffer_store_dword v136, v145, s[16:19], s36 offen offset:0 sc1
    s_mov_b64 exec, -1
    s_nop 1
    v_add_f32 v137, v137, v116
    v_add_f32 v137, v137, v117
    v_mov_b32 v13, 0
    v_lshlrev_b32 v10, 16, v168
    v_and_b32 v11, 0xffff0000, v168
    v_add_f32 v20, v20, v10
    v_add_f32 v21, v21, v11
    v_sub_f32 v20, v20, v137
    v_sub_f32 v21, v21, v137
    v_fmac_f32 v13, v20, v20
    v_fmac_f32 v13, v21, v21
    v_cvt_pk_bf16_f32 v88, v20, v21
    v_lshlrev_b32 v10, 16, v169
    v_and_b32 v11, 0xffff0000, v169
    v_add_f32 v22, v22, v10
    v_add_f32 v23, v23, v11
    v_sub_f32 v22, v22, v137
    v_sub_f32 v23, v23, v137
    v_fmac_f32 v13, v22, v22
    v_fmac_f32 v13, v23, v23
    v_cvt_pk_bf16_f32 v89, v22, v23
    v_lshlrev_b32 v10, 16, v170
    v_and_b32 v11, 0xffff0000, v170
    v_add_f32 v28, v28, v10
    v_add_f32 v29, v29, v11
    v_sub_f32 v28, v28, v137
    v_sub_f32 v29, v29, v137
    v_fmac_f32 v13, v28, v28
    v_fmac_f32 v13, v29, v29
    v_cvt_pk_bf16_f32 v90, v28, v29
    v_lshlrev_b32 v10, 16, v171
    v_and_b32 v11, 0xffff0000, v171
    v_add_f32 v30, v30, v10
    v_add_f32 v31, v31, v11
    v_sub_f32 v30, v30, v137
    v_sub_f32 v31, v31, v137
    v_fmac_f32 v13, v30, v30
    v_fmac_f32 v13, v31, v31
    v_cvt_pk_bf16_f32 v91, v30, v31
    v_lshlrev_b32 v10, 16, v172
    v_and_b32 v11, 0xffff0000, v172
    v_add_f32 v36, v36, v10
    v_add_f32 v37, v37, v11
    v_sub_f32 v36, v36, v137
    v_sub_f32 v37, v37, v137
    v_fmac_f32 v13, v36, v36
    v_fmac_f32 v13, v37, v37
    v_cvt_pk_bf16_f32 v92, v36, v37
    v_lshlrev_b32 v10, 16, v173
    v_and_b32 v11, 0xffff0000, v173
    v_add_f32 v38, v38, v10
    v_add_f32 v39, v39, v11
    v_sub_f32 v38, v38, v137
    v_sub_f32 v39, v39, v137
    v_fmac_f32 v13, v38, v38
    v_fmac_f32 v13, v39, v39
    v_cvt_pk_bf16_f32 v93, v38, v39
    v_lshlrev_b32 v10, 16, v174
    v_and_b32 v11, 0xffff0000, v174
    v_add_f32 v44, v44, v10
    v_add_f32 v45, v45, v11
    v_sub_f32 v44, v44, v137
    v_sub_f32 v45, v45, v137
    v_fmac_f32 v13, v44, v44
    v_fmac_f32 v13, v45, v45
    v_cvt_pk_bf16_f32 v94, v44, v45
    v_lshlrev_b32 v10, 16, v175
    v_and_b32 v11, 0xffff0000, v175
    v_add_f32 v46, v46, v10
    v_add_f32 v47, v47, v11
    v_sub_f32 v46, v46, v137
    v_sub_f32 v47, v47, v137
    v_fmac_f32 v13, v46, v46
    v_fmac_f32 v13, v47, v47
    v_cvt_pk_bf16_f32 v95, v46, v47
    buffer_store_dwordx4 v[88:91], v1, s[8:11], s34 offen offset:2048 sc1
    buffer_store_dwordx4 v[92:95], v1, s[8:11], s34 offen offset:3072 sc1
    v_mov_b32 v14, v13
    s_nop 1
    v_permlane16_swap_b32 v13, v14
    v_add_f32 v13, v13, v14
    v_mov_b32 v14, v13
    s_nop 1
    v_permlane32_swap_b32 v13, v14
    v_add_f32 v13, v13, v14
    s_mov_b64 exec, 0xffff
    buffer_store_dword v13, v144, s[20:23], s35 offen offset:1024 sc1
    buffer_store_dword v137, v145, s[16:19], s36 offen offset:64 sc1
    s_mov_b64 exec, -1
    s_nop 1
    s_lshl_b32 s90, s25, 4
    s_add_u32 s90, s90, s26
    s_lshl_b32 s90, s90, 7
L_k3_ffn_kernel_k4:
    s_mov_b64 s[40:41], s[84:85]
    s_mov_b64 s[42:43], s[86:87]
    s_and_b32 s3, s2, 7
    s_lshr_b32 s30, s2, 3
    s_and_b32 s25, s3, 1
    s_lshl_b32 s25, s25, 2
    s_and_b32 s33, s30, 3
    s_add_u32 s25, s25, s33
    s_lshr_b32 s26, s3, 1
    s_lshl_b32 s26, s26, 3
    s_lshr_b32 s33, s30, 2
    s_add_u32 s26, s26, s33
    s_lshl_b32 s33, s25, 2
    s_add_u32 s33, s33, s24
    s_lshl_b32 s33, s33, 13
    v_lshlrev_b32 v1, 4, v0
    v_add_u32 v1, s33, v1
    v_add_u32 v2, 0x1000, v1
    s_waitcnt lgkmcnt(0)
    s_add_u32 s8, s4, 13631488
    s_addc_u32 s9, s5, 0
    s_and_b32 s9, s9, 0xffff
    s_mov_b32 s10, 4194304
    s_mov_b32 s11, 0x20000
    s_add_u32 s20, s4, 4481024
    s_addc_u32 s21, s5, 0
    s_and_b32 s21, s21, 0xffff
    s_mov_b32 s22, 131072
    s_mov_b32 s23, 0x20000
    s_cmp_lt_u32 s24, 2
    s_cselect_b32 s6, s40, s42
    s_cselect_b32 s7, s41, s43
    s_mov_b32 s12, s6
    s_and_b32 s13, s7, 0xffff
    s_mov_b32 s14, 7340032
    s_mov_b32 s15, 0x20000
    s_add_u32 s16, s4, 17825792
    s_addc_u32 s17, s5, 0
    s_and_b32 s17, s17, 0xffff
    s_mov_b32 s18, 14680064
    s_mov_b32 s19, 0x20000
    s_and_b32 s34, s26, 1
    s_lshl_b32 s34, s34, 1
    s_mul_i32 s35, s26, 224
    s_and_b32 s36, s24, 1
    s_mul_i32 s36, s36, 229376
    s_add_u32 s35, s35, s36
    s_movk_i32 s37, 4682
    s_movk_i32 s38, 7168
    s_mul_i32 s31, s24, 7168
    s_add_u32 s31, s31, 65536
    s_mov_b32 s28, 0
    v_add_u32 v36, 0, v0
    v_mul_u32_u24 v37, s37, v36
    v_lshrrev_b32 v37, 16, v37
    v_mul_u32_u24 v38, 14, v37
    v_sub_u32 v36, v36, v38
    v_add_u32 v36, s34, v36
    v_subrev_u32 v38, 14, v36
    v_min_u32 v36, v36, v38
    v_mul_u32_u24 v37, s38, v37
    v_lshl_add_u32 v3, v36, 4, v37
    s_sub_u32 s39, s35, 0
    v_add_u32 v3, s39, v3
    v_add_u32 v36, 64, v0
    v_mul_u32_u24 v37, s37, v36
    v_lshrrev_b32 v37, 16, v37
    v_mul_u32_u24 v38, 14, v37
    v_sub_u32 v36, v36, v38
    v_add_u32 v36, s34, v36
    v_subrev_u32 v38, 14, v36
    v_min_u32 v36, v36, v38
    v_mul_u32_u24 v37, s38, v37
    v_lshl_add_u32 v4, v36, 4, v37
    s_sub_u32 s39, s35, 1024
    v_add_u32 v4, s39, v4
    v_add_u32 v36, 128, v0
    v_mul_u32_u24 v37, s37, v36
    v_lshrrev_b32 v37, 16, v37
    v_mul_u32_u24 v38, 14, v37
    v_sub_u32 v36, v36, v38
    v_add_u32 v36, s34, v36
    v_subrev_u32 v38, 14, v36
    v_min_u32 v36, v36, v38
    v_mul_u32_u24 v37, s38, v37
    v_lshl_add_u32 v5, v36, 4, v37
    s_sub_u32 s39, s35, 2048
    v_add_u32 v5, s39, v5
    v_add_u32 v36, 192, v0
    v_mul_u32_u24 v37, s37, v36
    v_lshrrev_b32 v37, 16, v37
    v_mul_u32_u24 v38, 14, v37
    v_sub_u32 v36, v36, v38
    v_add_u32 v36, s34, v36
    v_subrev_u32 v38, 14, v36
    v_min_u32 v36, v36, v38
    v_mul_u32_u24 v37, s38, v37
    v_lshl_add_u32 v6, v36, 4, v37
    s_sub_u32 s39, s35, 3072
    v_add_u32 v6, s39, v6
    v_add_u32 v36, 256, v0
    v_mul_u32_u24 v37, s37, v36
    v_lshrrev_b32 v37, 16, v37
    v_mul_u32_u24 v38, 14, v37
    v_sub_u32 v36, v36, v38
    v_add_u32 v36, s34, v36
    v_subrev_u32 v38, 14, v36
    v_min_u32 v36, v36, v38
    v_mul_u32_u24 v37, s38, v37
    v_lshl_add_u32 v7, v36, 4, v37
    s_sub_u32 s39, s35, 0
    v_add_u32 v7, s39, v7
    v_add_u32 v36, 320, v0
    v_mul_u32_u24 v37, s37, v36
    v_lshrrev_b32 v37, 16, v37
    v_mul_u32_u24 v38, 14, v37
    v_sub_u32 v36, v36, v38
    v_add_u32 v36, s34, v36
    v_subrev_u32 v38, 14, v36
    v_min_u32 v36, v36, v38
    v_mul_u32_u24 v37, s38, v37
    v_lshl_add_u32 v8, v36, 4, v37
    s_sub_u32 s39, s35, 1024
    v_add_u32 v8, s39, v8
    v_add_u32 v36, 384, v0
    v_mul_u32_u24 v37, s37, v36
    v_lshrrev_b32 v37, 16, v37
    v_mul_u32_u24 v38, 14, v37
    v_sub_u32 v36, v36, v38
    v_add_u32 v36, s34, v36
    v_subrev_u32 v38, 14, v36
    v_min_u32 v36, v36, v38
    v_mul_u32_u24 v37, s38, v37
    v_lshl_add_u32 v9, v36, 4, v37
    s_sub_u32 s39, s35, 2048
    v_add_u32 v9, s39, v9
    s_waitcnt vmcnt(0)
    s_barrier
    s_cmp_lg_u32 s24, 0
    s_cbranch_scc1 L_k3_ffn_kernel_pub4
    s_add_u32 s46, s4, 61865984
    s_addc_u32 s47, s5, 0
    v_mov_b32 v13, 1
    v_mov_b32 v12, s90
    global_store_dword v12, v13, s[46:47] sc1
L_k3_ffn_kernel_pub4:
    s_add_u32 m0, s31, 0
    s_nop 0
    buffer_load_dwordx4 v3, s[12:15], s28 offen offset:0 lds
    buffer_load_dwordx4 v4, s[12:15], s28 offen offset:1024 lds
    buffer_load_dwordx4 v5, s[12:15], s28 offen offset:2048 lds
    buffer_load_dwordx4 v6, s[12:15], s28 offen offset:3072 lds
    s_add_u32 m0, s31, 4096
    s_nop 0
    buffer_load_dwordx4 v7, s[12:15], s28 offen offset:0 lds
    buffer_load_dwordx4 v8, s[12:15], s28 offen offset:1024 lds
    buffer_load_dwordx4 v9, s[12:15], s28 offen offset:2048 lds
    s_add_u32 s28, s28, 458752
    s_add_u32 m0, s31, 28672
    s_nop 0
    buffer_load_dwordx4 v3, s[12:15], s28 offen offset:0 lds
    buffer_load_dwordx4 v4, s[12:15], s28 offen offset:1024 lds
    buffer_load_dwordx4 v5, s[12:15], s28 offen offset:2048 lds
    buffer_load_dwordx4 v6, s[12:15], s28 offen offset:3072 lds
    s_add_u32 m0, s31, 32768
    s_nop 0
    buffer_load_dwordx4 v7, s[12:15], s28 offen offset:0 lds
    buffer_load_dwordx4 v8, s[12:15], s28 offen offset:1024 lds
    buffer_load_dwordx4 v9, s[12:15], s28 offen offset:2048 lds
    s_add_u32 s28, s28, 458752
    v_mov_b64 v[32:33], 0
    v_mov_b64 v[34:35], 0
    v_mov_b64 v[36:37], 0
    v_mov_b64 v[38:39], 0
    v_mov_b64 v[40:41], 0
    v_mov_b64 v[42:43], 0
    v_mov_b64 v[44:45], 0
    v_mov_b64 v[46:47], 0
    v_mov_b64 v[48:49], 0
    v_mov_b64 v[50:51], 0
    v_mov_b64 v[52:53], 0
    v_mov_b64 v[54:55], 0
    v_mov_b64 v[56:57], 0
    v_mov_b64 v[58:59], 0
    v_mov_b64 v[60:61], 0
    v_mov_b64 v[62:63], 0
    v_mov_b64 v[64:65], 0
    v_mov_b64 v[66:67], 0
    v_mov_b64 v[68:69], 0
    v_mov_b64 v[70:71], 0
    v_mov_b64 v[72:73], 0
    v_mov_b64 v[74:75], 0
    v_mov_b64 v[76:77], 0
    v_mov_b64 v[78:79], 0
    v_mov_b64 v[80:81], 0
    v_mov_b64 v[82:83], 0
    v_mov_b64 v[84:85], 0
    v_mov_b64 v[86:87], 0
    v_mov_b64 v[88:89], 0
    v_mov_b64 v[90:91], 0
    v_mov_b64 v[92:93], 0
    v_mov_b64 v[94:95], 0
    v_mov_b64 v[96:97], 0
    v_mov_b64 v[98:99], 0
    v_mov_b64 v[100:101], 0
    v_mov_b64 v[102:103], 0
    v_mov_b64 v[104:105], 0
    v_mov_b64 v[106:107], 0
    v_mov_b64 v[108:109], 0
    v_mov_b64 v[110:111], 0
    v_mov_b64 v[112:113], 0
    v_mov_b64 v[114:115], 0
    v_mov_b64 v[116:117], 0
    v_mov_b64 v[118:119], 0
    v_mov_b64 v[120:121], 0
    v_mov_b64 v[122:123], 0
    v_mov_b64 v[124:125], 0
    v_mov_b64 v[126:127], 0
    v_mov_b64 v[128:129], 0
    v_mov_b64 v[130:131], 0
    v_mov_b64 v[132:133], 0
    v_mov_b64 v[134:135], 0
    v_mov_b64 v[136:137], 0
    v_mov_b64 v[138:139], 0
    v_mov_b64 v[140:141], 0
    v_mov_b64 v[142:143], 0
    v_mov_b64 v[144:145], 0
    v_mov_b64 v[146:147], 0
    v_mov_b64 v[148:149], 0
    v_mov_b64 v[150:151], 0
    v_mov_b64 v[152:153], 0
    v_mov_b64 v[154:155], 0
    v_mov_b64 v[156:157], 0
    v_mov_b64 v[158:159], 0
    v_mov_b64 v[160:161], 0
    v_mov_b64 v[162:163], 0
    v_mov_b64 v[164:165], 0
    v_mov_b64 v[166:167], 0
    v_mov_b64 v[168:169], 0
    v_mov_b64 v[170:171], 0
    v_mov_b64 v[172:173], 0
    v_mov_b64 v[174:175], 0
    v_mov_b64 v[176:177], 0
    v_mov_b64 v[178:179], 0
    v_mov_b64 v[180:181], 0
    v_mov_b64 v[182:183], 0
    v_mov_b64 v[184:185], 0
    v_mov_b64 v[186:187], 0
    v_mov_b64 v[188:189], 0
    v_mov_b64 v[190:191], 0
    v_mov_b64 v[192:193], 0
    v_mov_b64 v[194:195], 0
    v_mov_b64 v[196:197], 0
    v_mov_b64 v[198:199], 0
    v_mov_b64 v[200:201], 0
    v_mov_b64 v[202:203], 0
    v_mov_b64 v[204:205], 0
    v_mov_b64 v[206:207], 0
    v_mov_b64 v[208:209], 0
    v_mov_b64 v[210:211], 0
    v_mov_b64 v[212:213], 0
    v_mov_b64 v[214:215], 0
    v_mov_b64 v[216:217], 0
    v_mov_b64 v[218:219], 0
    v_mov_b64 v[220:221], 0
    v_mov_b64 v[222:223], 0
    v_mov_b64 v[224:225], 0
    v_mov_b64 v[226:227], 0
    v_mov_b64 v[228:229], 0
    v_mov_b64 v[230:231], 0
    v_mov_b64 v[232:233], 0
    v_mov_b64 v[234:235], 0
    v_mov_b64 v[236:237], 0
    v_mov_b64 v[238:239], 0
    v_mov_b64 v[240:241], 0
    v_mov_b64 v[242:243], 0
    v_mov_b64 v[244:245], 0
    v_mov_b64 v[246:247], 0
    v_mov_b64 v[248:249], 0
    v_mov_b64 v[250:251], 0
    v_mov_b64 v[252:253], 0
    v_mov_b64 v[254:255], 0
    s_cmp_lg_u32 s24, 0
    s_cbranch_scc1 L_k3_ffn_kernel_h4
    s_lshl_b32 s33, s25, 12
    s_add_u32 s46, s4, 61865984
    s_addc_u32 s47, s5, 0
    s_mov_b32 s37, 0x8000
    v_lshlrev_b32 v12, 7, v0
    v_add_u32 v12, s33, v12
L_k3_ffn_kernel_p4:
    s_mov_b32 exec_lo, 0xffffffff
    s_mov_b32 exec_hi, 0
    global_load_dword v13, v12, s[46:47] sc1
    s_waitcnt vmcnt(0)
    v_cmp_ne_u32 vcc, 1, v13
    s_mov_b64 exec, -1
    s_sub_u32 s37, s37, 1
    s_cmp_eq_u32 s37, 0
    s_cbranch_scc1 L_k3_ffn_kernel_g4
    s_nop 3
    s_cbranch_vccnz L_k3_ffn_kernel_p4
L_k3_ffn_kernel_g4:
L_k3_ffn_kernel_h4:
    s_waitcnt vmcnt(0)
    s_barrier
    s_lshl_b32 s33, s25, 2
    s_add_u32 s33, s33, s24
    s_lshl_b32 s33, s33, 12
    v_lshlrev_b32 v11, 4, v0
    buffer_load_dwordx4 v[12:15], v11, s[20:23], s33 offen offset:0
    buffer_load_dwordx4 v[16:19], v11, s[20:23], s33 offen offset:1024
    buffer_load_dwordx4 v[20:23], v11, s[20:23], s33 offen offset:2048
    buffer_load_dwordx4 v[24:27], v11, s[20:23], s33 offen offset:3072
    s_mov_b32 s27, 0
    buffer_load_dwordx4 a[112:115], v1, s[8:11], s27 offen offset:0
    buffer_load_dwordx4 a[116:119], v1, s[8:11], s27 offen offset:2048
    buffer_load_dwordx4 a[120:123], v2, s[8:11], s27 offen offset:0
    buffer_load_dwordx4 a[124:127], v2, s[8:11], s27 offen offset:2048
    buffer_load_dwordx4 a[128:131], v1, s[8:11], s27 offen offset:1024
    buffer_load_dwordx4 a[132:135], v1, s[8:11], s27 offen offset:3072
    buffer_load_dwordx4 a[136:139], v2, s[8:11], s27 offen offset:1024
    buffer_load_dwordx4 a[140:143], v2, s[8:11], s27 offen offset:3072
    s_mov_b32 s27, 262144
    v_lshrrev_b32 v11, 2, v0
    v_mul_u32_u24 v10, 224, v11
    v_and_b32 v11, 3, v0
    v_lshl_add_u32 v10, v11, 3, v10
    v_add_u32 v10, 65536, v10
    ds_read_b64_tr_b16 a[0:1], v10 offset:0
    ds_read_b64_tr_b16 a[2:3], v10 offset:3584
    ds_read_b64_tr_b16 a[28:29], v10 offset:14336
    ds_read_b64_tr_b16 a[30:31], v10 offset:17920
    ds_read_b64_tr_b16 a[4:5], v10 offset:32
    ds_read_b64_tr_b16 a[6:7], v10 offset:3616
    ds_read_b64_tr_b16 a[32:33], v10 offset:14368
    ds_read_b64_tr_b16 a[34:35], v10 offset:17952
    ds_read_b64_tr_b16 a[8:9], v10 offset:64
    ds_read_b64_tr_b16 a[10:11], v10 offset:3648
    ds_read_b64_tr_b16 a[36:37], v10 offset:14400
    ds_read_b64_tr_b16 a[38:39], v10 offset:17984
    ds_read_b64_tr_b16 a[12:13], v10 offset:96
    ds_read_b64_tr_b16 a[14:15], v10 offset:3680
    ds_read_b64_tr_b16 a[40:41], v10 offset:14432
    ds_read_b64_tr_b16 a[42:43], v10 offset:18016
    ds_read_b64_tr_b16 a[16:17], v10 offset:128
    ds_read_b64_tr_b16 a[18:19], v10 offset:3712
    ds_read_b64_tr_b16 a[44:45], v10 offset:14464
    ds_read_b64_tr_b16 a[46:47], v10 offset:18048
    ds_read_b64_tr_b16 a[20:21], v10 offset:160
    ds_read_b64_tr_b16 a[22:23], v10 offset:3744
    ds_read_b64_tr_b16 a[48:49], v10 offset:14496
    ds_read_b64_tr_b16 a[50:51], v10 offset:18080
    ds_read_b64_tr_b16 a[24:25], v10 offset:192
    ds_read_b64_tr_b16 a[26:27], v10 offset:3776
    ds_read_b64_tr_b16 a[52:53], v10 offset:14528
    ds_read_b64_tr_b16 a[54:55], v10 offset:18112
    s_waitcnt vmcnt(8)
    s_mov_b32 s45, 0x3a800000
    v_add_f32 v12, v12, v13
    v_add_f32 v14, v14, v15
    v_add_f32 v16, v16, v17
    v_add_f32 v18, v18, v19
    v_add_f32 v20, v20, v21
    v_add_f32 v22, v22, v23
    v_add_f32 v24, v24, v25
    v_add_f32 v26, v26, v27
    v_add_f32 v12, v12, v14
    v_add_f32 v16, v16, v18
    v_add_f32 v20, v20, v22
    v_add_f32 v24, v24, v26
    s_nop 1
    v_add_f32_dpp v12, v12, v12 quad_perm:[1,0,3,2] row_mask:0xf bank_mask:0xf
    v_add_f32_dpp v16, v16, v16 quad_perm:[1,0,3,2] row_mask:0xf bank_mask:0xf
    v_add_f32_dpp v20, v20, v20 quad_perm:[1,0,3,2] row_mask:0xf bank_mask:0xf
    v_add_f32_dpp v24, v24, v24 quad_perm:[1,0,3,2] row_mask:0xf bank_mask:0xf
    s_nop 1
    v_add_f32_dpp v12, v12, v12 quad_perm:[2,3,0,1] row_mask:0xf bank_mask:0xf
    v_add_f32_dpp v16, v16, v16 quad_perm:[2,3,0,1] row_mask:0xf bank_mask:0xf
    v_add_f32_dpp v20, v20, v20 quad_perm:[2,3,0,1] row_mask:0xf bank_mask:0xf
    v_add_f32_dpp v24, v24, v24 quad_perm:[2,3,0,1] row_mask:0xf bank_mask:0xf
    v_and_b32 v13, 15, v0
    v_lshlrev_b32 v13, 4, v13
    v_mov_b32 v14, 0x3727c5ac
    ds_bpermute_b32 v28, v13, v12
    ds_bpermute_b32 v29, v13, v16
    ds_bpermute_b32 v30, v13, v20
    ds_bpermute_b32 v31, v13, v24
    s_waitcnt lgkmcnt(0)
    v_fma_f32 v28, v28, s45, v14
    v_fma_f32 v29, v29, s45, v14
    v_fma_f32 v30, v30, s45, v14
    v_fma_f32 v31, v31, s45, v14
    v_rsq_f32 v16, v28
    v_rsq_f32 v17, v29
    v_rsq_f32 v18, v30
    v_rsq_f32 v19, v31
    v_mul_f32 v20, 0xc0135761, v16
    v_mul_f32 v21, v16, v16
    v_mul_f32 v21, v21, v16
    v_mul_f32 v21, 0xbdd2d3e8, v21
    v_mul_f32 v22, 0xc0135761, v17
    v_mul_f32 v23, v17, v17
    v_mul_f32 v23, v23, v17
    v_mul_f32 v23, 0xbdd2d3e8, v23
    v_mul_f32 v24, 0xc0135761, v18
    v_mul_f32 v25, v18, v18
    v_mul_f32 v25, v25, v18
    v_mul_f32 v25, 0xbdd2d3e8, v25
    v_mul_f32 v26, 0xc0135761, v19
    v_mul_f32 v27, v19, v19
    v_mul_f32 v27, v27, v19
    v_mul_f32 v27, 0xbdd2d3e8, v27
    s_waitcnt vmcnt(4)
    s_mov_b32 s44, 8
L_k3_ffn_kernel_4_loop:
    s_waitcnt vmcnt(11) lgkmcnt(0)
    v_mfma_f32_16x16x32_bf16 v[32:35], a[0:3], a[112:115], v[32:35]
    ds_read_b64_tr_b16 a[56:57], v10 offset:7168
    v_mfma_f32_16x16x32_bf16 v[36:39], a[0:3], a[116:119], v[36:39]
    ds_read_b64_tr_b16 a[58:59], v10 offset:10752
    v_mfma_f32_16x16x32_bf16 v[40:43], a[0:3], a[120:123], v[40:43]
    buffer_load_dwordx4 a[144:147], v1, s[8:11], s27 offen offset:0
    v_mfma_f32_16x16x32_bf16 v[44:47], a[0:3], a[124:127], v[44:47]
    ds_read_b64_tr_b16 a[84:85], v10 offset:21504
    v_mfma_f32_16x16x32_bf16 v[156:159], a[28:31], a[124:127], v[156:159]
    ds_read_b64_tr_b16 a[86:87], v10 offset:25088
    v_mfma_f32_16x16x32_bf16 v[152:155], a[28:31], a[120:123], v[152:155]
    v_mfma_f32_16x16x32_bf16 v[148:151], a[28:31], a[116:119], v[148:151]
    ds_read_b64_tr_b16 a[60:61], v10 offset:7200
    v_mfma_f32_16x16x32_bf16 v[144:147], a[28:31], a[112:115], v[144:147]
    ds_read_b64_tr_b16 a[62:63], v10 offset:10784
    buffer_load_dwordx4 a[148:151], v1, s[8:11], s27 offen offset:2048
    v_mfma_f32_16x16x32_bf16 v[48:51], a[4:7], a[112:115], v[48:51]
    v_mfma_f32_16x16x32_bf16 v[52:55], a[4:7], a[116:119], v[52:55]
    ds_read_b64_tr_b16 a[88:89], v10 offset:21536
    v_mfma_f32_16x16x32_bf16 v[56:59], a[4:7], a[120:123], v[56:59]
    v_mfma_f32_16x16x32_bf16 v[60:63], a[4:7], a[124:127], v[60:63]
    ds_read_b64_tr_b16 a[90:91], v10 offset:25120
    v_mfma_f32_16x16x32_bf16 v[172:175], a[32:35], a[124:127], v[172:175]
    ds_read_b64_tr_b16 a[64:65], v10 offset:7232
    v_mfma_f32_16x16x32_bf16 v[168:171], a[32:35], a[120:123], v[168:171]
    buffer_load_dwordx4 a[152:155], v2, s[8:11], s27 offen offset:0
    v_mfma_f32_16x16x32_bf16 v[164:167], a[32:35], a[116:119], v[164:167]
    ds_read_b64_tr_b16 a[66:67], v10 offset:10816
    v_mfma_f32_16x16x32_bf16 v[160:163], a[32:35], a[112:115], v[160:163]
    ds_read_b64_tr_b16 a[92:93], v10 offset:21568
    v_mfma_f32_16x16x32_bf16 v[64:67], a[8:11], a[112:115], v[64:67]
    v_mfma_f32_16x16x32_bf16 v[68:71], a[8:11], a[116:119], v[68:71]
    ds_read_b64_tr_b16 a[94:95], v10 offset:25152
    v_mfma_f32_16x16x32_bf16 v[72:75], a[8:11], a[120:123], v[72:75]
    ds_read_b64_tr_b16 a[68:69], v10 offset:7264
    buffer_load_dwordx4 a[156:159], v2, s[8:11], s27 offen offset:2048
    v_mfma_f32_16x16x32_bf16 v[76:79], a[8:11], a[124:127], v[76:79]
    v_mfma_f32_16x16x32_bf16 v[188:191], a[36:39], a[124:127], v[188:191]
    ds_read_b64_tr_b16 a[70:71], v10 offset:10848
    v_mfma_f32_16x16x32_bf16 v[184:187], a[36:39], a[120:123], v[184:187]
    v_mfma_f32_16x16x32_bf16 v[180:183], a[36:39], a[116:119], v[180:183]
    ds_read_b64_tr_b16 a[96:97], v10 offset:21600
    v_mfma_f32_16x16x32_bf16 v[176:179], a[36:39], a[112:115], v[176:179]
    ds_read_b64_tr_b16 a[98:99], v10 offset:25184
    v_mfma_f32_16x16x32_bf16 v[80:83], a[12:15], a[112:115], v[80:83]
    v_mfma_f32_16x16x32_bf16 v[84:87], a[12:15], a[116:119], v[84:87]
    ds_read_b64_tr_b16 a[72:73], v10 offset:7296
    v_mfma_f32_16x16x32_bf16 v[88:91], a[12:15], a[120:123], v[88:91]
    ds_read_b64_tr_b16 a[74:75], v10 offset:10880
    v_mfma_f32_16x16x32_bf16 v[92:95], a[12:15], a[124:127], v[92:95]
    v_mfma_f32_16x16x32_bf16 v[204:207], a[40:43], a[124:127], v[204:207]
    ds_read_b64_tr_b16 a[100:101], v10 offset:21632
    v_mfma_f32_16x16x32_bf16 v[200:203], a[40:43], a[120:123], v[200:203]
    ds_read_b64_tr_b16 a[102:103], v10 offset:25216
    v_mfma_f32_16x16x32_bf16 v[196:199], a[40:43], a[116:119], v[196:199]
    v_mfma_f32_16x16x32_bf16 v[192:195], a[40:43], a[112:115], v[192:195]
    ds_read_b64_tr_b16 a[76:77], v10 offset:7328
    v_mfma_f32_16x16x32_bf16 v[96:99], a[16:19], a[112:115], v[96:99]
    v_mfma_f32_16x16x32_bf16 v[100:103], a[16:19], a[116:119], v[100:103]
    ds_read_b64_tr_b16 a[78:79], v10 offset:10912
    v_mfma_f32_16x16x32_bf16 v[104:107], a[16:19], a[120:123], v[104:107]
    ds_read_b64_tr_b16 a[104:105], v10 offset:21664
    v_mfma_f32_16x16x32_bf16 v[108:111], a[16:19], a[124:127], v[108:111]
    v_mfma_f32_16x16x32_bf16 v[220:223], a[44:47], a[124:127], v[220:223]
    ds_read_b64_tr_b16 a[106:107], v10 offset:25248
    v_mfma_f32_16x16x32_bf16 v[216:219], a[44:47], a[120:123], v[216:219]
    ds_read_b64_tr_b16 a[80:81], v10 offset:7360
    v_mfma_f32_16x16x32_bf16 v[212:215], a[44:47], a[116:119], v[212:215]
    v_mfma_f32_16x16x32_bf16 v[208:211], a[44:47], a[112:115], v[208:211]
    ds_read_b64_tr_b16 a[82:83], v10 offset:10944
    v_mfma_f32_16x16x32_bf16 v[112:115], a[20:23], a[112:115], v[112:115]
    ds_read_b64_tr_b16 a[108:109], v10 offset:21696
    v_mfma_f32_16x16x32_bf16 v[116:119], a[20:23], a[116:119], v[116:119]
    v_mfma_f32_16x16x32_bf16 v[120:123], a[20:23], a[120:123], v[120:123]
    ds_read_b64_tr_b16 a[110:111], v10 offset:25280
    v_mfma_f32_16x16x32_bf16 v[124:127], a[20:23], a[124:127], v[124:127]
    v_mfma_f32_16x16x32_bf16 v[236:239], a[48:51], a[124:127], v[236:239]
    v_mfma_f32_16x16x32_bf16 v[232:235], a[48:51], a[120:123], v[232:235]
    v_mfma_f32_16x16x32_bf16 v[228:231], a[48:51], a[116:119], v[228:231]
    v_mfma_f32_16x16x32_bf16 v[224:227], a[48:51], a[112:115], v[224:227]
    v_mfma_f32_16x16x32_bf16 v[128:131], a[24:27], a[112:115], v[128:131]
    v_mfma_f32_16x16x32_bf16 v[132:135], a[24:27], a[116:119], v[132:135]
    v_mfma_f32_16x16x32_bf16 v[136:139], a[24:27], a[120:123], v[136:139]
    v_mfma_f32_16x16x32_bf16 v[140:143], a[24:27], a[124:127], v[140:143]
    v_mfma_f32_16x16x32_bf16 v[252:255], a[52:55], a[124:127], v[252:255]
    v_mfma_f32_16x16x32_bf16 v[248:251], a[52:55], a[120:123], v[248:251]
    v_mfma_f32_16x16x32_bf16 v[244:247], a[52:55], a[116:119], v[244:247]
    v_mfma_f32_16x16x32_bf16 v[240:243], a[52:55], a[112:115], v[240:243]
    s_waitcnt vmcnt(4) lgkmcnt(0)
    s_barrier
    v_mfma_f32_16x16x32_bf16 v[32:35], a[56:59], a[128:131], v[32:35]
    ds_read_b64_tr_b16 a[0:1], v10 offset:28672
    s_add_u32 m0, s31, 0
    s_nop 0
    buffer_load_dwordx4 v3, s[12:15], s28 offen offset:0 lds
    v_mfma_f32_16x16x32_bf16 v[36:39], a[56:59], a[132:135], v[36:39]
    ds_read_b64_tr_b16 a[2:3], v10 offset:32256
    v_mfma_f32_16x16x32_bf16 v[40:43], a[56:59], a[136:139], v[40:43]
    v_mfma_f32_16x16x32_bf16 v[44:47], a[56:59], a[140:143], v[44:47]
    ds_read_b64_tr_b16 a[28:29], v10 offset:43008
    v_mfma_f32_16x16x32_bf16 v[156:159], a[84:87], a[140:143], v[156:159]
    ds_read_b64_tr_b16 a[30:31], v10 offset:46592
    buffer_load_dwordx4 v4, s[12:15], s28 offen offset:1024 lds
    v_mfma_f32_16x16x32_bf16 v[152:155], a[84:87], a[136:139], v[152:155]
    v_mfma_f32_16x16x32_bf16 v[148:151], a[84:87], a[132:135], v[148:151]
    ds_read_b64_tr_b16 a[4:5], v10 offset:28704
    v_mfma_f32_16x16x32_bf16 v[144:147], a[84:87], a[128:131], v[144:147]
    ds_read_b64_tr_b16 a[6:7], v10 offset:32288
    v_mfma_f32_16x16x32_bf16 v[48:51], a[60:63], a[128:131], v[48:51]
    buffer_load_dwordx4 v5, s[12:15], s28 offen offset:2048 lds
    v_mfma_f32_16x16x32_bf16 v[52:55], a[60:63], a[132:135], v[52:55]
    ds_read_b64_tr_b16 a[32:33], v10 offset:43040
    v_mfma_f32_16x16x32_bf16 v[56:59], a[60:63], a[136:139], v[56:59]
    v_mfma_f32_16x16x32_bf16 v[60:63], a[60:63], a[140:143], v[60:63]
    ds_read_b64_tr_b16 a[34:35], v10 offset:46624
    v_mfma_f32_16x16x32_bf16 v[172:175], a[88:91], a[140:143], v[172:175]
    ds_read_b64_tr_b16 a[8:9], v10 offset:28736
    buffer_load_dwordx4 v6, s[12:15], s28 offen offset:3072 lds
    v_mfma_f32_16x16x32_bf16 v[168:171], a[88:91], a[136:139], v[168:171]
    v_mfma_f32_16x16x32_bf16 v[164:167], a[88:91], a[132:135], v[164:167]
    ds_read_b64_tr_b16 a[10:11], v10 offset:32320
    v_mfma_f32_16x16x32_bf16 v[160:163], a[88:91], a[128:131], v[160:163]
    ds_read_b64_tr_b16 a[36:37], v10 offset:43072
    v_mfma_f32_16x16x32_bf16 v[64:67], a[64:67], a[128:131], v[64:67]
    s_add_u32 m0, s31, 4096
    s_nop 0
    buffer_load_dwordx4 v7, s[12:15], s28 offen offset:0 lds
    v_mfma_f32_16x16x32_bf16 v[68:71], a[64:67], a[132:135], v[68:71]
    ds_read_b64_tr_b16 a[38:39], v10 offset:46656
    v_mfma_f32_16x16x32_bf16 v[72:75], a[64:67], a[136:139], v[72:75]
    ds_read_b64_tr_b16 a[12:13], v10 offset:28768
    v_mfma_f32_16x16x32_bf16 v[76:79], a[64:67], a[140:143], v[76:79]
    v_mfma_f32_16x16x32_bf16 v[188:191], a[92:95], a[140:143], v[188:191]
    ds_read_b64_tr_b16 a[14:15], v10 offset:32352
    buffer_load_dwordx4 v8, s[12:15], s28 offen offset:1024 lds
    v_mfma_f32_16x16x32_bf16 v[184:187], a[92:95], a[136:139], v[184:187]
    v_mfma_f32_16x16x32_bf16 v[180:183], a[92:95], a[132:135], v[180:183]
    ds_read_b64_tr_b16 a[40:41], v10 offset:43104
    v_mfma_f32_16x16x32_bf16 v[176:179], a[92:95], a[128:131], v[176:179]
    ds_read_b64_tr_b16 a[42:43], v10 offset:46688
    v_mfma_f32_16x16x32_bf16 v[80:83], a[68:71], a[128:131], v[80:83]
    buffer_load_dwordx4 v9, s[12:15], s28 offen offset:2048 lds
    v_mfma_f32_16x16x32_bf16 v[84:87], a[68:71], a[132:135], v[84:87]
    ds_read_b64_tr_b16 a[16:17], v10 offset:28800
    v_mfma_f32_16x16x32_bf16 v[88:91], a[68:71], a[136:139], v[88:91]
    ds_read_b64_tr_b16 a[18:19], v10 offset:32384
    v_mfma_f32_16x16x32_bf16 v[92:95], a[68:71], a[140:143], v[92:95]
    v_mfma_f32_16x16x32_bf16 v[204:207], a[96:99], a[140:143], v[204:207]
    ds_read_b64_tr_b16 a[44:45], v10 offset:43136
    v_mfma_f32_16x16x32_bf16 v[200:203], a[96:99], a[136:139], v[200:203]
    ds_read_b64_tr_b16 a[46:47], v10 offset:46720
    v_mfma_f32_16x16x32_bf16 v[196:199], a[96:99], a[132:135], v[196:199]
    buffer_load_dwordx4 a[160:163], v1, s[8:11], s27 offen offset:1024
    v_mfma_f32_16x16x32_bf16 v[192:195], a[96:99], a[128:131], v[192:195]
    ds_read_b64_tr_b16 a[20:21], v10 offset:28832
    v_mfma_f32_16x16x32_bf16 v[96:99], a[72:75], a[128:131], v[96:99]
    v_mfma_f32_16x16x32_bf16 v[100:103], a[72:75], a[132:135], v[100:103]
    ds_read_b64_tr_b16 a[22:23], v10 offset:32416
    v_mfma_f32_16x16x32_bf16 v[104:107], a[72:75], a[136:139], v[104:107]
    ds_read_b64_tr_b16 a[48:49], v10 offset:43168
    buffer_load_dwordx4 a[164:167], v1, s[8:11], s27 offen offset:3072
    v_mfma_f32_16x16x32_bf16 v[108:111], a[72:75], a[140:143], v[108:111]
    v_mfma_f32_16x16x32_bf16 v[220:223], a[100:103], a[140:143], v[220:223]
    ds_read_b64_tr_b16 a[50:51], v10 offset:46752
    v_mfma_f32_16x16x32_bf16 v[216:219], a[100:103], a[136:139], v[216:219]
    ds_read_b64_tr_b16 a[24:25], v10 offset:28864
    v_mfma_f32_16x16x32_bf16 v[212:215], a[100:103], a[132:135], v[212:215]
    buffer_load_dwordx4 a[168:171], v2, s[8:11], s27 offen offset:1024
    v_mfma_f32_16x16x32_bf16 v[208:211], a[100:103], a[128:131], v[208:211]
    ds_read_b64_tr_b16 a[26:27], v10 offset:32448
    v_mfma_f32_16x16x32_bf16 v[112:115], a[76:79], a[128:131], v[112:115]
    ds_read_b64_tr_b16 a[52:53], v10 offset:43200
    v_mfma_f32_16x16x32_bf16 v[116:119], a[76:79], a[132:135], v[116:119]
    v_mfma_f32_16x16x32_bf16 v[120:123], a[76:79], a[136:139], v[120:123]
    ds_read_b64_tr_b16 a[54:55], v10 offset:46784
    buffer_load_dwordx4 a[172:175], v2, s[8:11], s27 offen offset:3072
    v_mfma_f32_16x16x32_bf16 v[124:127], a[76:79], a[140:143], v[124:127]
    v_mfma_f32_16x16x32_bf16 v[236:239], a[104:107], a[140:143], v[236:239]
    v_mfma_f32_16x16x32_bf16 v[232:235], a[104:107], a[136:139], v[232:235]
    v_mfma_f32_16x16x32_bf16 v[228:231], a[104:107], a[132:135], v[228:231]
    v_mfma_f32_16x16x32_bf16 v[224:227], a[104:107], a[128:131], v[224:227]
    v_mfma_f32_16x16x32_bf16 v[128:131], a[80:83], a[128:131], v[128:131]
    s_add_u32 s28, s28, 458752
    s_add_u32 s27, s27, 262144
    v_mfma_f32_16x16x32_bf16 v[132:135], a[80:83], a[132:135], v[132:135]
    v_mfma_f32_16x16x32_bf16 v[136:139], a[80:83], a[136:139], v[136:139]
    v_mfma_f32_16x16x32_bf16 v[140:143], a[80:83], a[140:143], v[140:143]
    v_mfma_f32_16x16x32_bf16 v[252:255], a[108:111], a[140:143], v[252:255]
    v_mfma_f32_16x16x32_bf16 v[248:251], a[108:111], a[136:139], v[248:251]
    v_mfma_f32_16x16x32_bf16 v[244:247], a[108:111], a[132:135], v[244:247]
    v_mfma_f32_16x16x32_bf16 v[240:243], a[108:111], a[128:131], v[240:243]
    s_waitcnt vmcnt(11) lgkmcnt(0)
    v_mfma_f32_16x16x32_bf16 v[32:35], a[0:3], a[144:147], v[32:35]
    ds_read_b64_tr_b16 a[56:57], v10 offset:35840
    v_mfma_f32_16x16x32_bf16 v[36:39], a[0:3], a[148:151], v[36:39]
    ds_read_b64_tr_b16 a[58:59], v10 offset:39424
    v_mfma_f32_16x16x32_bf16 v[40:43], a[0:3], a[152:155], v[40:43]
    buffer_load_dwordx4 a[112:115], v1, s[8:11], s27 offen offset:0
    v_mfma_f32_16x16x32_bf16 v[44:47], a[0:3], a[156:159], v[44:47]
    ds_read_b64_tr_b16 a[84:85], v10 offset:50176
    v_mfma_f32_16x16x32_bf16 v[156:159], a[28:31], a[156:159], v[156:159]
    ds_read_b64_tr_b16 a[86:87], v10 offset:53760
    v_mfma_f32_16x16x32_bf16 v[152:155], a[28:31], a[152:155], v[152:155]
    v_mfma_f32_16x16x32_bf16 v[148:151], a[28:31], a[148:151], v[148:151]
    ds_read_b64_tr_b16 a[60:61], v10 offset:35872
    v_mfma_f32_16x16x32_bf16 v[144:147], a[28:31], a[144:147], v[144:147]
    ds_read_b64_tr_b16 a[62:63], v10 offset:39456
    buffer_load_dwordx4 a[116:119], v1, s[8:11], s27 offen offset:2048
    v_mfma_f32_16x16x32_bf16 v[48:51], a[4:7], a[144:147], v[48:51]
    v_mfma_f32_16x16x32_bf16 v[52:55], a[4:7], a[148:151], v[52:55]
    ds_read_b64_tr_b16 a[88:89], v10 offset:50208
    v_mfma_f32_16x16x32_bf16 v[56:59], a[4:7], a[152:155], v[56:59]
    v_mfma_f32_16x16x32_bf16 v[60:63], a[4:7], a[156:159], v[60:63]
    ds_read_b64_tr_b16 a[90:91], v10 offset:53792
    v_mfma_f32_16x16x32_bf16 v[172:175], a[32:35], a[156:159], v[172:175]
    ds_read_b64_tr_b16 a[64:65], v10 offset:35904
    v_mfma_f32_16x16x32_bf16 v[168:171], a[32:35], a[152:155], v[168:171]
    buffer_load_dwordx4 a[120:123], v2, s[8:11], s27 offen offset:0
    v_mfma_f32_16x16x32_bf16 v[164:167], a[32:35], a[148:151], v[164:167]
    ds_read_b64_tr_b16 a[66:67], v10 offset:39488
    v_mfma_f32_16x16x32_bf16 v[160:163], a[32:35], a[144:147], v[160:163]
    ds_read_b64_tr_b16 a[92:93], v10 offset:50240
    v_mfma_f32_16x16x32_bf16 v[64:67], a[8:11], a[144:147], v[64:67]
    v_mfma_f32_16x16x32_bf16 v[68:71], a[8:11], a[148:151], v[68:71]
    ds_read_b64_tr_b16 a[94:95], v10 offset:53824
    v_mfma_f32_16x16x32_bf16 v[72:75], a[8:11], a[152:155], v[72:75]
    ds_read_b64_tr_b16 a[68:69], v10 offset:35936
    buffer_load_dwordx4 a[124:127], v2, s[8:11], s27 offen offset:2048
    v_mfma_f32_16x16x32_bf16 v[76:79], a[8:11], a[156:159], v[76:79]
    v_mfma_f32_16x16x32_bf16 v[188:191], a[36:39], a[156:159], v[188:191]
    ds_read_b64_tr_b16 a[70:71], v10 offset:39520
    v_mfma_f32_16x16x32_bf16 v[184:187], a[36:39], a[152:155], v[184:187]
    v_mfma_f32_16x16x32_bf16 v[180:183], a[36:39], a[148:151], v[180:183]
    ds_read_b64_tr_b16 a[96:97], v10 offset:50272
    v_mfma_f32_16x16x32_bf16 v[176:179], a[36:39], a[144:147], v[176:179]
    ds_read_b64_tr_b16 a[98:99], v10 offset:53856
    v_mfma_f32_16x16x32_bf16 v[80:83], a[12:15], a[144:147], v[80:83]
    v_mfma_f32_16x16x32_bf16 v[84:87], a[12:15], a[148:151], v[84:87]
    ds_read_b64_tr_b16 a[72:73], v10 offset:35968
    v_mfma_f32_16x16x32_bf16 v[88:91], a[12:15], a[152:155], v[88:91]
    ds_read_b64_tr_b16 a[74:75], v10 offset:39552
    v_mfma_f32_16x16x32_bf16 v[92:95], a[12:15], a[156:159], v[92:95]
    v_mfma_f32_16x16x32_bf16 v[204:207], a[40:43], a[156:159], v[204:207]
    ds_read_b64_tr_b16 a[100:101], v10 offset:50304
    v_mfma_f32_16x16x32_bf16 v[200:203], a[40:43], a[152:155], v[200:203]
    ds_read_b64_tr_b16 a[102:103], v10 offset:53888
    v_mfma_f32_16x16x32_bf16 v[196:199], a[40:43], a[148:151], v[196:199]
    v_mfma_f32_16x16x32_bf16 v[192:195], a[40:43], a[144:147], v[192:195]
    ds_read_b64_tr_b16 a[76:77], v10 offset:36000
    v_mfma_f32_16x16x32_bf16 v[96:99], a[16:19], a[144:147], v[96:99]
    v_mfma_f32_16x16x32_bf16 v[100:103], a[16:19], a[148:151], v[100:103]
    ds_read_b64_tr_b16 a[78:79], v10 offset:39584
    v_mfma_f32_16x16x32_bf16 v[104:107], a[16:19], a[152:155], v[104:107]
    ds_read_b64_tr_b16 a[104:105], v10 offset:50336
    v_mfma_f32_16x16x32_bf16 v[108:111], a[16:19], a[156:159], v[108:111]
    v_mfma_f32_16x16x32_bf16 v[220:223], a[44:47], a[156:159], v[220:223]
    ds_read_b64_tr_b16 a[106:107], v10 offset:53920
    v_mfma_f32_16x16x32_bf16 v[216:219], a[44:47], a[152:155], v[216:219]
    ds_read_b64_tr_b16 a[80:81], v10 offset:36032
    v_mfma_f32_16x16x32_bf16 v[212:215], a[44:47], a[148:151], v[212:215]
    v_mfma_f32_16x16x32_bf16 v[208:211], a[44:47], a[144:147], v[208:211]
    ds_read_b64_tr_b16 a[82:83], v10 offset:39616
    v_mfma_f32_16x16x32_bf16 v[112:115], a[20:23], a[144:147], v[112:115]
    ds_read_b64_tr_b16 a[108:109], v10 offset:50368
    v_mfma_f32_16x16x32_bf16 v[116:119], a[20:23], a[148:151], v[116:119]
    v_mfma_f32_16x16x32_bf16 v[120:123], a[20:23], a[152:155], v[120:123]
    ds_read_b64_tr_b16 a[110:111], v10 offset:53952
    v_mfma_f32_16x16x32_bf16 v[124:127], a[20:23], a[156:159], v[124:127]
    v_mfma_f32_16x16x32_bf16 v[236:239], a[48:51], a[156:159], v[236:239]
    v_mfma_f32_16x16x32_bf16 v[232:235], a[48:51], a[152:155], v[232:235]
    v_mfma_f32_16x16x32_bf16 v[228:231], a[48:51], a[148:151], v[228:231]
    v_mfma_f32_16x16x32_bf16 v[224:227], a[48:51], a[144:147], v[224:227]
    v_mfma_f32_16x16x32_bf16 v[128:131], a[24:27], a[144:147], v[128:131]
    v_mfma_f32_16x16x32_bf16 v[132:135], a[24:27], a[148:151], v[132:135]
    v_mfma_f32_16x16x32_bf16 v[136:139], a[24:27], a[152:155], v[136:139]
    v_mfma_f32_16x16x32_bf16 v[140:143], a[24:27], a[156:159], v[140:143]
    v_mfma_f32_16x16x32_bf16 v[252:255], a[52:55], a[156:159], v[252:255]
    v_mfma_f32_16x16x32_bf16 v[248:251], a[52:55], a[152:155], v[248:251]
    v_mfma_f32_16x16x32_bf16 v[244:247], a[52:55], a[148:151], v[244:247]
    v_mfma_f32_16x16x32_bf16 v[240:243], a[52:55], a[144:147], v[240:243]
    s_waitcnt vmcnt(4) lgkmcnt(0)
    s_barrier
    v_mfma_f32_16x16x32_bf16 v[32:35], a[56:59], a[160:163], v[32:35]
    ds_read_b64_tr_b16 a[0:1], v10 offset:0
    s_add_u32 m0, s31, 28672
    s_nop 0
    buffer_load_dwordx4 v3, s[12:15], s28 offen offset:0 lds
    v_mfma_f32_16x16x32_bf16 v[36:39], a[56:59], a[164:167], v[36:39]
    ds_read_b64_tr_b16 a[2:3], v10 offset:3584
    v_mfma_f32_16x16x32_bf16 v[40:43], a[56:59], a[168:171], v[40:43]
    v_mfma_f32_16x16x32_bf16 v[44:47], a[56:59], a[172:175], v[44:47]
    ds_read_b64_tr_b16 a[28:29], v10 offset:14336
    v_mfma_f32_16x16x32_bf16 v[156:159], a[84:87], a[172:175], v[156:159]
    ds_read_b64_tr_b16 a[30:31], v10 offset:17920
    buffer_load_dwordx4 v4, s[12:15], s28 offen offset:1024 lds
    v_mfma_f32_16x16x32_bf16 v[152:155], a[84:87], a[168:171], v[152:155]
    v_mfma_f32_16x16x32_bf16 v[148:151], a[84:87], a[164:167], v[148:151]
    ds_read_b64_tr_b16 a[4:5], v10 offset:32
    v_mfma_f32_16x16x32_bf16 v[144:147], a[84:87], a[160:163], v[144:147]
    ds_read_b64_tr_b16 a[6:7], v10 offset:3616
    v_mfma_f32_16x16x32_bf16 v[48:51], a[60:63], a[160:163], v[48:51]
    buffer_load_dwordx4 v5, s[12:15], s28 offen offset:2048 lds
    v_mfma_f32_16x16x32_bf16 v[52:55], a[60:63], a[164:167], v[52:55]
    ds_read_b64_tr_b16 a[32:33], v10 offset:14368
    v_mfma_f32_16x16x32_bf16 v[56:59], a[60:63], a[168:171], v[56:59]
    v_mfma_f32_16x16x32_bf16 v[60:63], a[60:63], a[172:175], v[60:63]
    ds_read_b64_tr_b16 a[34:35], v10 offset:17952
    v_mfma_f32_16x16x32_bf16 v[172:175], a[88:91], a[172:175], v[172:175]
    ds_read_b64_tr_b16 a[8:9], v10 offset:64
    buffer_load_dwordx4 v6, s[12:15], s28 offen offset:3072 lds
    v_mfma_f32_16x16x32_bf16 v[168:171], a[88:91], a[168:171], v[168:171]
    v_mfma_f32_16x16x32_bf16 v[164:167], a[88:91], a[164:167], v[164:167]
    ds_read_b64_tr_b16 a[10:11], v10 offset:3648
    v_mfma_f32_16x16x32_bf16 v[160:163], a[88:91], a[160:163], v[160:163]
    ds_read_b64_tr_b16 a[36:37], v10 offset:14400
    v_mfma_f32_16x16x32_bf16 v[64:67], a[64:67], a[160:163], v[64:67]
    s_add_u32 m0, s31, 32768
    s_nop 0
    buffer_load_dwordx4 v7, s[12:15], s28 offen offset:0 lds
    v_mfma_f32_16x16x32_bf16 v[68:71], a[64:67], a[164:167], v[68:71]
    ds_read_b64_tr_b16 a[38:39], v10 offset:17984
    v_mfma_f32_16x16x32_bf16 v[72:75], a[64:67], a[168:171], v[72:75]
    ds_read_b64_tr_b16 a[12:13], v10 offset:96
    v_mfma_f32_16x16x32_bf16 v[76:79], a[64:67], a[172:175], v[76:79]
    v_mfma_f32_16x16x32_bf16 v[188:191], a[92:95], a[172:175], v[188:191]
    ds_read_b64_tr_b16 a[14:15], v10 offset:3680
    buffer_load_dwordx4 v8, s[12:15], s28 offen offset:1024 lds
    v_mfma_f32_16x16x32_bf16 v[184:187], a[92:95], a[168:171], v[184:187]
    v_mfma_f32_16x16x32_bf16 v[180:183], a[92:95], a[164:167], v[180:183]
    ds_read_b64_tr_b16 a[40:41], v10 offset:14432
    v_mfma_f32_16x16x32_bf16 v[176:179], a[92:95], a[160:163], v[176:179]
    ds_read_b64_tr_b16 a[42:43], v10 offset:18016
    v_mfma_f32_16x16x32_bf16 v[80:83], a[68:71], a[160:163], v[80:83]
    buffer_load_dwordx4 v9, s[12:15], s28 offen offset:2048 lds
    v_mfma_f32_16x16x32_bf16 v[84:87], a[68:71], a[164:167], v[84:87]
    ds_read_b64_tr_b16 a[16:17], v10 offset:128
    v_mfma_f32_16x16x32_bf16 v[88:91], a[68:71], a[168:171], v[88:91]
    ds_read_b64_tr_b16 a[18:19], v10 offset:3712
    v_mfma_f32_16x16x32_bf16 v[92:95], a[68:71], a[172:175], v[92:95]
    v_mfma_f32_16x16x32_bf16 v[204:207], a[96:99], a[172:175], v[204:207]
    ds_read_b64_tr_b16 a[44:45], v10 offset:14464
    v_mfma_f32_16x16x32_bf16 v[200:203], a[96:99], a[168:171], v[200:203]
    ds_read_b64_tr_b16 a[46:47], v10 offset:18048
    v_mfma_f32_16x16x32_bf16 v[196:199], a[96:99], a[164:167], v[196:199]
    buffer_load_dwordx4 a[128:131], v1, s[8:11], s27 offen offset:1024
    v_mfma_f32_16x16x32_bf16 v[192:195], a[96:99], a[160:163], v[192:195]
    ds_read_b64_tr_b16 a[20:21], v10 offset:160
    v_mfma_f32_16x16x32_bf16 v[96:99], a[72:75], a[160:163], v[96:99]
    v_mfma_f32_16x16x32_bf16 v[100:103], a[72:75], a[164:167], v[100:103]
    ds_read_b64_tr_b16 a[22:23], v10 offset:3744
    v_mfma_f32_16x16x32_bf16 v[104:107], a[72:75], a[168:171], v[104:107]
    ds_read_b64_tr_b16 a[48:49], v10 offset:14496
    buffer_load_dwordx4 a[132:135], v1, s[8:11], s27 offen offset:3072
    v_mfma_f32_16x16x32_bf16 v[108:111], a[72:75], a[172:175], v[108:111]
    v_mfma_f32_16x16x32_bf16 v[220:223], a[100:103], a[172:175], v[220:223]
    ds_read_b64_tr_b16 a[50:51], v10 offset:18080
    v_mfma_f32_16x16x32_bf16 v[216:219], a[100:103], a[168:171], v[216:219]
    ds_read_b64_tr_b16 a[24:25], v10 offset:192
    v_mfma_f32_16x16x32_bf16 v[212:215], a[100:103], a[164:167], v[212:215]
    buffer_load_dwordx4 a[136:139], v2, s[8:11], s27 offen offset:1024
    v_mfma_f32_16x16x32_bf16 v[208:211], a[100:103], a[160:163], v[208:211]
    ds_read_b64_tr_b16 a[26:27], v10 offset:3776
    v_mfma_f32_16x16x32_bf16 v[112:115], a[76:79], a[160:163], v[112:115]
    ds_read_b64_tr_b16 a[52:53], v10 offset:14528
    v_mfma_f32_16x16x32_bf16 v[116:119], a[76:79], a[164:167], v[116:119]
    v_mfma_f32_16x16x32_bf16 v[120:123], a[76:79], a[168:171], v[120:123]
    ds_read_b64_tr_b16 a[54:55], v10 offset:18112
    buffer_load_dwordx4 a[140:143], v2, s[8:11], s27 offen offset:3072
    v_mfma_f32_16x16x32_bf16 v[124:127], a[76:79], a[172:175], v[124:127]
    v_mfma_f32_16x16x32_bf16 v[236:239], a[104:107], a[172:175], v[236:239]
    v_mfma_f32_16x16x32_bf16 v[232:235], a[104:107], a[168:171], v[232:235]
    v_mfma_f32_16x16x32_bf16 v[228:231], a[104:107], a[164:167], v[228:231]
    v_mfma_f32_16x16x32_bf16 v[224:227], a[104:107], a[160:163], v[224:227]
    v_mfma_f32_16x16x32_bf16 v[128:131], a[80:83], a[160:163], v[128:131]
    s_add_u32 s28, s28, 458752
    s_add_u32 s27, s27, 262144
    v_mfma_f32_16x16x32_bf16 v[132:135], a[80:83], a[164:167], v[132:135]
    v_mfma_f32_16x16x32_bf16 v[136:139], a[80:83], a[168:171], v[136:139]
    v_mfma_f32_16x16x32_bf16 v[140:143], a[80:83], a[172:175], v[140:143]
    v_mfma_f32_16x16x32_bf16 v[252:255], a[108:111], a[172:175], v[252:255]
    v_mfma_f32_16x16x32_bf16 v[248:251], a[108:111], a[168:171], v[248:251]
    v_mfma_f32_16x16x32_bf16 v[244:247], a[108:111], a[164:167], v[244:247]
    s_sub_u32 s44, s44, 1
    s_cmp_lg_u32 s44, 0
    v_mfma_f32_16x16x32_bf16 v[240:243], a[108:111], a[160:163], v[240:243]
    s_cbranch_scc1 L_k3_ffn_kernel_4_loop
    s_waitcnt lgkmcnt(0)
    s_lshr_b32 s33, s2, 3
    s_lshl_b32 s33, s33, 2
    s_add_u32 s33, s33, s24
    s_lshr_b32 s34, s33, 3
    s_mul_i32 s34, s34, 458752
    s_and_b32 s35, s2, 1
    s_mul_i32 s35, s35, 229376
    s_add_u32 s34, s34, s35
    s_and_b32 s33, s33, 7
    s_lshl_b32 s33, s33, 12
    s_add_u32 s33, s33, s34
    s_add_u32 s33, s33, 33554432
    v_lshlrev_b32 v12, 7, v0
    v_add_u32 v12, s33, v12
    s_mov_b32 exec_lo, 0xffffffff
    s_mov_b32 exec_hi, 0
    global_load_dword v13, v12, s[4:5]
    s_mov_b64 exec, -1
    s_cmp_lg_u32 s24, 0
    s_cbranch_scc1 L_cpf_k3_ffn_kernel_4
    s_getpc_b64 s[46:47]
L_cpfpc_k3_ffn_kernel_4:
    s_add_u32 s46, s46, L_k3_ffn_kernel_k5-L_cpfpc_k3_ffn_kernel_4
    s_addc_u32 s47, s47, 0
    v_lshlrev_b32 v14, 7, v0
    s_mov_b32 exec_lo, 0xffffffff
    s_mov_b32 exec_hi, 0xff
    global_load_dword v15, v14, s[46:47]
    s_mov_b64 exec, -1
L_cpf_k3_ffn_kernel_4:
    s_and_b32 s34, s26, 1
    s_bfe_u32 s35, s26, 0x30001
    s_lshr_b32 s36, s26, 4
    s_mul_i32 s36, s36, 56
    s_lshl_b32 s37, s35, 2
    s_lshl_b32 s39, s34, 1
    s_add_u32 s37, s37, s39
    s_add_u32 s37, s37, 0
    s_add_u32 s37, s37, s36
    s_lshr_b32 s39, s37, 1
    s_lshl_b32 s39, s39, 18
    s_and_b32 s37, s37, 1
    s_lshl_b32 s37, s37, 10
    s_add_u32 s48, s37, s39
    s_lshl_b32 s37, s35, 2
    s_lshl_b32 s39, s34, 1
    s_add_u32 s37, s37, s39
    s_add_u32 s37, s37, 1
    s_add_u32 s37, s37, s36
    s_lshr_b32 s39, s37, 1
    s_lshl_b32 s39, s39, 18
    s_and_b32 s37, s37, 1
    s_lshl_b32 s37, s37, 10
    s_add_u32 s49, s37, s39
    s_mul_i32 s37, s35, 3
    s_lshl_b32 s39, s34, 1
    s_add_u32 s37, s37, s39
    s_add_u32 s37, s37, 32
    s_add_u32 s37, s37, s36
    s_lshr_b32 s39, s37, 1
    s_lshl_b32 s39, s39, 18
    s_and_b32 s37, s37, 1
    s_lshl_b32 s37, s37, 10
    s_add_u32 s50, s37, s39
    s_mul_i32 s37, s35, 3
    s_add_u32 s37, s37, 33
    s_add_u32 s37, s37, s36
    s_lshr_b32 s39, s37, 1
    s_lshl_b32 s39, s39, 18
    s_and_b32 s37, s37, 1
    s_lshl_b32 s37, s37, 10
    s_add_u32 s51, s37, s39
    s_lshl_b32 s34, s34, 3
    s_add_u32 s51, s51, s34
    v_pk_mul_f32 v[4:5], v[32:33], v[32:33]
    v_pk_mul_f32 v[6:7], v[34:35], v[34:35]
    v_pk_fma_f32 v[4:5], v[4:5], v[20:21], v[20:21] op_sel:[0,1,0] op_sel_hi:[1,1,0]
    v_pk_fma_f32 v[6:7], v[6:7], v[20:21], v[20:21] op_sel:[0,1,0] op_sel_hi:[1,1,0]
    v_pk_mul_f32 v[4:5], v[4:5], v[32:33]
    v_pk_mul_f32 v[6:7], v[6:7], v[34:35]
    v_exp_f32 v4, v4
    v_exp_f32 v6, v6
    v_exp_f32 v5, v5
    v_exp_f32 v7, v7
    v_pk_mul_f32 v[32:33], v[32:33], v[144:145]
    v_pk_mul_f32 v[34:35], v[34:35], v[146:147]
    v_pk_fma_f32 v[4:5], v[4:5], v[28:29], v[28:29] op_sel:[0,0,0] op_sel_hi:[1,0,0]
    v_pk_fma_f32 v[6:7], v[6:7], v[28:29], v[28:29] op_sel:[0,0,0] op_sel_hi:[1,0,0]
    v_rcp_f32 v4, v4
    v_rcp_f32 v6, v6
    v_rcp_f32 v5, v5
    v_rcp_f32 v7, v7
    v_pk_mul_f32 v[32:33], v[32:33], v[4:5]
    v_pk_mul_f32 v[34:35], v[34:35], v[6:7]
    v_cvt_pk_bf16_f32 v144, v32, v33
    v_cvt_pk_bf16_f32 v145, v34, v35
    v_pk_mul_f32 v[4:5], v[48:49], v[48:49]
    v_pk_mul_f32 v[6:7], v[50:51], v[50:51]
    v_pk_fma_f32 v[4:5], v[4:5], v[20:21], v[20:21] op_sel:[0,1,0] op_sel_hi:[1,1,0]
    v_pk_fma_f32 v[6:7], v[6:7], v[20:21], v[20:21] op_sel:[0,1,0] op_sel_hi:[1,1,0]
    v_pk_mul_f32 v[4:5], v[4:5], v[48:49]
    v_pk_mul_f32 v[6:7], v[6:7], v[50:51]
    v_exp_f32 v4, v4
    v_exp_f32 v6, v6
    v_exp_f32 v5, v5
    v_exp_f32 v7, v7
    v_pk_mul_f32 v[48:49], v[48:49], v[160:161]
    v_pk_mul_f32 v[50:51], v[50:51], v[162:163]
    v_pk_fma_f32 v[4:5], v[4:5], v[28:29], v[28:29] op_sel:[0,0,0] op_sel_hi:[1,0,0]
    v_pk_fma_f32 v[6:7], v[6:7], v[28:29], v[28:29] op_sel:[0,0,0] op_sel_hi:[1,0,0]
    v_rcp_f32 v4, v4
    v_rcp_f32 v6, v6
    v_rcp_f32 v5, v5
    v_rcp_f32 v7, v7
    v_pk_mul_f32 v[48:49], v[48:49], v[4:5]
    v_pk_mul_f32 v[50:51], v[50:51], v[6:7]
    v_cvt_pk_bf16_f32 v146, v48, v49
    v_cvt_pk_bf16_f32 v147, v50, v51
    buffer_store_dwordx4 v[144:147], v1, s[16:19], s48 offen offset:0 sc1
    v_pk_mul_f32 v[4:5], v[36:37], v[36:37]
    v_pk_mul_f32 v[6:7], v[38:39], v[38:39]
    v_pk_fma_f32 v[4:5], v[4:5], v[22:23], v[22:23] op_sel:[0,1,0] op_sel_hi:[1,1,0]
    v_pk_fma_f32 v[6:7], v[6:7], v[22:23], v[22:23] op_sel:[0,1,0] op_sel_hi:[1,1,0]
    v_pk_mul_f32 v[4:5], v[4:5], v[36:37]
    v_pk_mul_f32 v[6:7], v[6:7], v[38:39]
    v_exp_f32 v4, v4
    v_exp_f32 v6, v6
    v_exp_f32 v5, v5
    v_exp_f32 v7, v7
    v_pk_mul_f32 v[36:37], v[36:37], v[148:149]
    v_pk_mul_f32 v[38:39], v[38:39], v[150:151]
    v_pk_fma_f32 v[4:5], v[4:5], v[28:29], v[28:29] op_sel:[0,1,1] op_sel_hi:[1,1,1]
    v_pk_fma_f32 v[6:7], v[6:7], v[28:29], v[28:29] op_sel:[0,1,1] op_sel_hi:[1,1,1]
    v_rcp_f32 v4, v4
    v_rcp_f32 v6, v6
    v_rcp_f32 v5, v5
    v_rcp_f32 v7, v7
    v_pk_mul_f32 v[36:37], v[36:37], v[4:5]
    v_pk_mul_f32 v[38:39], v[38:39], v[6:7]
    v_cvt_pk_bf16_f32 v148, v36, v37
    v_cvt_pk_bf16_f32 v149, v38, v39
    v_pk_mul_f32 v[4:5], v[52:53], v[52:53]
    v_pk_mul_f32 v[6:7], v[54:55], v[54:55]
    v_pk_fma_f32 v[4:5], v[4:5], v[22:23], v[22:23] op_sel:[0,1,0] op_sel_hi:[1,1,0]
    v_pk_fma_f32 v[6:7], v[6:7], v[22:23], v[22:23] op_sel:[0,1,0] op_sel_hi:[1,1,0]
    v_pk_mul_f32 v[4:5], v[4:5], v[52:53]
    v_pk_mul_f32 v[6:7], v[6:7], v[54:55]
    v_exp_f32 v4, v4
    v_exp_f32 v6, v6
    v_exp_f32 v5, v5
    v_exp_f32 v7, v7
    v_pk_mul_f32 v[52:53], v[52:53], v[164:165]
    v_pk_mul_f32 v[54:55], v[54:55], v[166:167]
    v_pk_fma_f32 v[4:5], v[4:5], v[28:29], v[28:29] op_sel:[0,1,1] op_sel_hi:[1,1,1]
    v_pk_fma_f32 v[6:7], v[6:7], v[28:29], v[28:29] op_sel:[0,1,1] op_sel_hi:[1,1,1]
    v_rcp_f32 v4, v4
    v_rcp_f32 v6, v6
    v_rcp_f32 v5, v5
    v_rcp_f32 v7, v7
    v_pk_mul_f32 v[52:53], v[52:53], v[4:5]
    v_pk_mul_f32 v[54:55], v[54:55], v[6:7]
    v_cvt_pk_bf16_f32 v150, v52, v53
    v_cvt_pk_bf16_f32 v151, v54, v55
    buffer_store_dwordx4 v[148:151], v1, s[16:19], s48 offen offset:2048 sc1
    v_pk_mul_f32 v[4:5], v[40:41], v[40:41]
    v_pk_mul_f32 v[6:7], v[42:43], v[42:43]
    v_pk_fma_f32 v[4:5], v[4:5], v[24:25], v[24:25] op_sel:[0,1,0] op_sel_hi:[1,1,0]
    v_pk_fma_f32 v[6:7], v[6:7], v[24:25], v[24:25] op_sel:[0,1,0] op_sel_hi:[1,1,0]
    v_pk_mul_f32 v[4:5], v[4:5], v[40:41]
    v_pk_mul_f32 v[6:7], v[6:7], v[42:43]
    v_exp_f32 v4, v4
    v_exp_f32 v6, v6
    v_exp_f32 v5, v5
    v_exp_f32 v7, v7
    v_pk_mul_f32 v[40:41], v[40:41], v[152:153]
    v_pk_mul_f32 v[42:43], v[42:43], v[154:155]
    v_pk_fma_f32 v[4:5], v[4:5], v[30:31], v[30:31] op_sel:[0,0,0] op_sel_hi:[1,0,0]
    v_pk_fma_f32 v[6:7], v[6:7], v[30:31], v[30:31] op_sel:[0,0,0] op_sel_hi:[1,0,0]
    v_rcp_f32 v4, v4
    v_rcp_f32 v6, v6
    v_rcp_f32 v5, v5
    v_rcp_f32 v7, v7
    v_pk_mul_f32 v[40:41], v[40:41], v[4:5]
    v_pk_mul_f32 v[42:43], v[42:43], v[6:7]
    v_cvt_pk_bf16_f32 v152, v40, v41
    v_cvt_pk_bf16_f32 v153, v42, v43
    v_pk_mul_f32 v[4:5], v[56:57], v[56:57]
    v_pk_mul_f32 v[6:7], v[58:59], v[58:59]
    v_pk_fma_f32 v[4:5], v[4:5], v[24:25], v[24:25] op_sel:[0,1,0] op_sel_hi:[1,1,0]
    v_pk_fma_f32 v[6:7], v[6:7], v[24:25], v[24:25] op_sel:[0,1,0] op_sel_hi:[1,1,0]
    v_pk_mul_f32 v[4:5], v[4:5], v[56:57]
    v_pk_mul_f32 v[6:7], v[6:7], v[58:59]
    v_exp_f32 v4, v4
    v_exp_f32 v6, v6
    v_exp_f32 v5, v5
    v_exp_f32 v7, v7
    v_pk_mul_f32 v[56:57], v[56:57], v[168:169]
    v_pk_mul_f32 v[58:59], v[58:59], v[170:171]
    v_pk_fma_f32 v[4:5], v[4:5], v[30:31], v[30:31] op_sel:[0,0,0] op_sel_hi:[1,0,0]
    v_pk_fma_f32 v[6:7], v[6:7], v[30:31], v[30:31] op_sel:[0,0,0] op_sel_hi:[1,0,0]
    v_rcp_f32 v4, v4
    v_rcp_f32 v6, v6
    v_rcp_f32 v5, v5
    v_rcp_f32 v7, v7
    v_pk_mul_f32 v[56:57], v[56:57], v[4:5]
    v_pk_mul_f32 v[58:59], v[58:59], v[6:7]
    v_cvt_pk_bf16_f32 v154, v56, v57
    v_cvt_pk_bf16_f32 v155, v58, v59
    buffer_store_dwordx4 v[152:155], v2, s[16:19], s48 offen offset:0 sc1
    v_pk_mul_f32 v[4:5], v[44:45], v[44:45]
    v_pk_mul_f32 v[6:7], v[46:47], v[46:47]
    v_pk_fma_f32 v[4:5], v[4:5], v[26:27], v[26:27] op_sel:[0,1,0] op_sel_hi:[1,1,0]
    v_pk_fma_f32 v[6:7], v[6:7], v[26:27], v[26:27] op_sel:[0,1,0] op_sel_hi:[1,1,0]
    v_pk_mul_f32 v[4:5], v[4:5], v[44:45]
    v_pk_mul_f32 v[6:7], v[6:7], v[46:47]
    v_exp_f32 v4, v4
    v_exp_f32 v6, v6
    v_exp_f32 v5, v5
    v_exp_f32 v7, v7
    v_pk_mul_f32 v[44:45], v[44:45], v[156:157]
    v_pk_mul_f32 v[46:47], v[46:47], v[158:159]
    v_pk_fma_f32 v[4:5], v[4:5], v[30:31], v[30:31] op_sel:[0,1,1] op_sel_hi:[1,1,1]
    v_pk_fma_f32 v[6:7], v[6:7], v[30:31], v[30:31] op_sel:[0,1,1] op_sel_hi:[1,1,1]
    v_rcp_f32 v4, v4
    v_rcp_f32 v6, v6
    v_rcp_f32 v5, v5
    v_rcp_f32 v7, v7
    v_pk_mul_f32 v[44:45], v[44:45], v[4:5]
    v_pk_mul_f32 v[46:47], v[46:47], v[6:7]
    v_cvt_pk_bf16_f32 v156, v44, v45
    v_cvt_pk_bf16_f32 v157, v46, v47
    v_pk_mul_f32 v[4:5], v[60:61], v[60:61]
    v_pk_mul_f32 v[6:7], v[62:63], v[62:63]
    v_pk_fma_f32 v[4:5], v[4:5], v[26:27], v[26:27] op_sel:[0,1,0] op_sel_hi:[1,1,0]
    v_pk_fma_f32 v[6:7], v[6:7], v[26:27], v[26:27] op_sel:[0,1,0] op_sel_hi:[1,1,0]
    v_pk_mul_f32 v[4:5], v[4:5], v[60:61]
    v_pk_mul_f32 v[6:7], v[6:7], v[62:63]
    v_exp_f32 v4, v4
    v_exp_f32 v6, v6
    v_exp_f32 v5, v5
    v_exp_f32 v7, v7
    v_pk_mul_f32 v[60:61], v[60:61], v[172:173]
    v_pk_mul_f32 v[62:63], v[62:63], v[174:175]
    v_pk_fma_f32 v[4:5], v[4:5], v[30:31], v[30:31] op_sel:[0,1,1] op_sel_hi:[1,1,1]
    v_pk_fma_f32 v[6:7], v[6:7], v[30:31], v[30:31] op_sel:[0,1,1] op_sel_hi:[1,1,1]
    v_rcp_f32 v4, v4
    v_rcp_f32 v6, v6
    v_rcp_f32 v5, v5
    v_rcp_f32 v7, v7
    v_pk_mul_f32 v[60:61], v[60:61], v[4:5]
    v_pk_mul_f32 v[62:63], v[62:63], v[6:7]
    v_cvt_pk_bf16_f32 v158, v60, v61
    v_cvt_pk_bf16_f32 v159, v62, v63
    buffer_store_dwordx4 v[156:159], v2, s[16:19], s48 offen offset:2048 sc1
    v_pk_mul_f32 v[4:5], v[64:65], v[64:65]
    v_pk_mul_f32 v[6:7], v[66:67], v[66:67]
    v_pk_fma_f32 v[4:5], v[4:5], v[20:21], v[20:21] op_sel:[0,1,0] op_sel_hi:[1,1,0]
    v_pk_fma_f32 v[6:7], v[6:7], v[20:21], v[20:21] op_sel:[0,1,0] op_sel_hi:[1,1,0]
    v_pk_mul_f32 v[4:5], v[4:5], v[64:65]
    v_pk_mul_f32 v[6:7], v[6:7], v[66:67]
    v_exp_f32 v4, v4
    v_exp_f32 v6, v6
    v_exp_f32 v5, v5
    v_exp_f32 v7, v7
    v_pk_mul_f32 v[64:65], v[64:65], v[176:177]
    v_pk_mul_f32 v[66:67], v[66:67], v[178:179]
    v_pk_fma_f32 v[4:5], v[4:5], v[28:29], v[28:29] op_sel:[0,0,0] op_sel_hi:[1,0,0]
    v_pk_fma_f32 v[6:7], v[6:7], v[28:29], v[28:29] op_sel:[0,0,0] op_sel_hi:[1,0,0]
    v_rcp_f32 v4, v4
    v_rcp_f32 v6, v6
    v_rcp_f32 v5, v5
    v_rcp_f32 v7, v7
    v_pk_mul_f32 v[64:65], v[64:65], v[4:5]
    v_pk_mul_f32 v[66:67], v[66:67], v[6:7]
    v_cvt_pk_bf16_f32 v176, v64, v65
    v_cvt_pk_bf16_f32 v177, v66, v67
    v_pk_mul_f32 v[4:5], v[80:81], v[80:81]
    v_pk_mul_f32 v[6:7], v[82:83], v[82:83]
    v_pk_fma_f32 v[4:5], v[4:5], v[20:21], v[20:21] op_sel:[0,1,0] op_sel_hi:[1,1,0]
    v_pk_fma_f32 v[6:7], v[6:7], v[20:21], v[20:21] op_sel:[0,1,0] op_sel_hi:[1,1,0]
    v_pk_mul_f32 v[4:5], v[4:5], v[80:81]
    v_pk_mul_f32 v[6:7], v[6:7], v[82:83]
    v_exp_f32 v4, v4
    v_exp_f32 v6, v6
    v_exp_f32 v5, v5
    v_exp_f32 v7, v7
    v_pk_mul_f32 v[80:81], v[80:81], v[192:193]
    v_pk_mul_f32 v[82:83], v[82:83], v[194:195]
    v_pk_fma_f32 v[4:5], v[4:5], v[28:29], v[28:29] op_sel:[0,0,0] op_sel_hi:[1,0,0]
    v_pk_fma_f32 v[6:7], v[6:7], v[28:29], v[28:29] op_sel:[0,0,0] op_sel_hi:[1,0,0]
    v_rcp_f32 v4, v4
    v_rcp_f32 v6, v6
    v_rcp_f32 v5, v5
    v_rcp_f32 v7, v7
    v_pk_mul_f32 v[80:81], v[80:81], v[4:5]
    v_pk_mul_f32 v[82:83], v[82:83], v[6:7]
    v_cvt_pk_bf16_f32 v178, v80, v81
    v_cvt_pk_bf16_f32 v179, v82, v83
    buffer_store_dwordx4 v[176:179], v1, s[16:19], s49 offen offset:0 sc1
    v_pk_mul_f32 v[4:5], v[68:69], v[68:69]
    v_pk_mul_f32 v[6:7], v[70:71], v[70:71]
    v_pk_fma_f32 v[4:5], v[4:5], v[22:23], v[22:23] op_sel:[0,1,0] op_sel_hi:[1,1,0]
    v_pk_fma_f32 v[6:7], v[6:7], v[22:23], v[22:23] op_sel:[0,1,0] op_sel_hi:[1,1,0]
    v_pk_mul_f32 v[4:5], v[4:5], v[68:69]
    v_pk_mul_f32 v[6:7], v[6:7], v[70:71]
    v_exp_f32 v4, v4
    v_exp_f32 v6, v6
    v_exp_f32 v5, v5
    v_exp_f32 v7, v7
    v_pk_mul_f32 v[68:69], v[68:69], v[180:181]
    v_pk_mul_f32 v[70:71], v[70:71], v[182:183]
    v_pk_fma_f32 v[4:5], v[4:5], v[28:29], v[28:29] op_sel:[0,1,1] op_sel_hi:[1,1,1]
    v_pk_fma_f32 v[6:7], v[6:7], v[28:29], v[28:29] op_sel:[0,1,1] op_sel_hi:[1,1,1]
    v_rcp_f32 v4, v4
    v_rcp_f32 v6, v6
    v_rcp_f32 v5, v5
    v_rcp_f32 v7, v7
    v_pk_mul_f32 v[68:69], v[68:69], v[4:5]
    v_pk_mul_f32 v[70:71], v[70:71], v[6:7]
    v_cvt_pk_bf16_f32 v180, v68, v69
    v_cvt_pk_bf16_f32 v181, v70, v71
    v_pk_mul_f32 v[4:5], v[84:85], v[84:85]
    v_pk_mul_f32 v[6:7], v[86:87], v[86:87]
    v_pk_fma_f32 v[4:5], v[4:5], v[22:23], v[22:23] op_sel:[0,1,0] op_sel_hi:[1,1,0]
    v_pk_fma_f32 v[6:7], v[6:7], v[22:23], v[22:23] op_sel:[0,1,0] op_sel_hi:[1,1,0]
    v_pk_mul_f32 v[4:5], v[4:5], v[84:85]
    v_pk_mul_f32 v[6:7], v[6:7], v[86:87]
    v_exp_f32 v4, v4
    v_exp_f32 v6, v6
    v_exp_f32 v5, v5
    v_exp_f32 v7, v7
    v_pk_mul_f32 v[84:85], v[84:85], v[196:197]
    v_pk_mul_f32 v[86:87], v[86:87], v[198:199]
    v_pk_fma_f32 v[4:5], v[4:5], v[28:29], v[28:29] op_sel:[0,1,1] op_sel_hi:[1,1,1]
    v_pk_fma_f32 v[6:7], v[6:7], v[28:29], v[28:29] op_sel:[0,1,1] op_sel_hi:[1,1,1]
    v_rcp_f32 v4, v4
    v_rcp_f32 v6, v6
    v_rcp_f32 v5, v5
    v_rcp_f32 v7, v7
    v_pk_mul_f32 v[84:85], v[84:85], v[4:5]
    v_pk_mul_f32 v[86:87], v[86:87], v[6:7]
    v_cvt_pk_bf16_f32 v182, v84, v85
    v_cvt_pk_bf16_f32 v183, v86, v87
    buffer_store_dwordx4 v[180:183], v1, s[16:19], s49 offen offset:2048 sc1
    v_pk_mul_f32 v[4:5], v[72:73], v[72:73]
    v_pk_mul_f32 v[6:7], v[74:75], v[74:75]
    v_pk_fma_f32 v[4:5], v[4:5], v[24:25], v[24:25] op_sel:[0,1,0] op_sel_hi:[1,1,0]
    v_pk_fma_f32 v[6:7], v[6:7], v[24:25], v[24:25] op_sel:[0,1,0] op_sel_hi:[1,1,0]
    v_pk_mul_f32 v[4:5], v[4:5], v[72:73]
    v_pk_mul_f32 v[6:7], v[6:7], v[74:75]
    v_exp_f32 v4, v4
    v_exp_f32 v6, v6
    v_exp_f32 v5, v5
    v_exp_f32 v7, v7
    v_pk_mul_f32 v[72:73], v[72:73], v[184:185]
    v_pk_mul_f32 v[74:75], v[74:75], v[186:187]
    v_pk_fma_f32 v[4:5], v[4:5], v[30:31], v[30:31] op_sel:[0,0,0] op_sel_hi:[1,0,0]
    v_pk_fma_f32 v[6:7], v[6:7], v[30:31], v[30:31] op_sel:[0,0,0] op_sel_hi:[1,0,0]
    v_rcp_f32 v4, v4
    v_rcp_f32 v6, v6
    v_rcp_f32 v5, v5
    v_rcp_f32 v7, v7
    v_pk_mul_f32 v[72:73], v[72:73], v[4:5]
    v_pk_mul_f32 v[74:75], v[74:75], v[6:7]
    v_cvt_pk_bf16_f32 v184, v72, v73
    v_cvt_pk_bf16_f32 v185, v74, v75
    v_pk_mul_f32 v[4:5], v[88:89], v[88:89]
    v_pk_mul_f32 v[6:7], v[90:91], v[90:91]
    v_pk_fma_f32 v[4:5], v[4:5], v[24:25], v[24:25] op_sel:[0,1,0] op_sel_hi:[1,1,0]
    v_pk_fma_f32 v[6:7], v[6:7], v[24:25], v[24:25] op_sel:[0,1,0] op_sel_hi:[1,1,0]
    v_pk_mul_f32 v[4:5], v[4:5], v[88:89]
    v_pk_mul_f32 v[6:7], v[6:7], v[90:91]
    v_exp_f32 v4, v4
    v_exp_f32 v6, v6
    v_exp_f32 v5, v5
    v_exp_f32 v7, v7
    v_pk_mul_f32 v[88:89], v[88:89], v[200:201]
    v_pk_mul_f32 v[90:91], v[90:91], v[202:203]
    v_pk_fma_f32 v[4:5], v[4:5], v[30:31], v[30:31] op_sel:[0,0,0] op_sel_hi:[1,0,0]
    v_pk_fma_f32 v[6:7], v[6:7], v[30:31], v[30:31] op_sel:[0,0,0] op_sel_hi:[1,0,0]
    v_rcp_f32 v4, v4
    v_rcp_f32 v6, v6
    v_rcp_f32 v5, v5
    v_rcp_f32 v7, v7
    v_pk_mul_f32 v[88:89], v[88:89], v[4:5]
    v_pk_mul_f32 v[90:91], v[90:91], v[6:7]
    v_cvt_pk_bf16_f32 v186, v88, v89
    v_cvt_pk_bf16_f32 v187, v90, v91
    buffer_store_dwordx4 v[184:187], v2, s[16:19], s49 offen offset:0 sc1
    v_pk_mul_f32 v[4:5], v[76:77], v[76:77]
    v_pk_mul_f32 v[6:7], v[78:79], v[78:79]
    v_pk_fma_f32 v[4:5], v[4:5], v[26:27], v[26:27] op_sel:[0,1,0] op_sel_hi:[1,1,0]
    v_pk_fma_f32 v[6:7], v[6:7], v[26:27], v[26:27] op_sel:[0,1,0] op_sel_hi:[1,1,0]
    v_pk_mul_f32 v[4:5], v[4:5], v[76:77]
    v_pk_mul_f32 v[6:7], v[6:7], v[78:79]
    v_exp_f32 v4, v4
    v_exp_f32 v6, v6
    v_exp_f32 v5, v5
    v_exp_f32 v7, v7
    v_pk_mul_f32 v[76:77], v[76:77], v[188:189]
    v_pk_mul_f32 v[78:79], v[78:79], v[190:191]
    v_pk_fma_f32 v[4:5], v[4:5], v[30:31], v[30:31] op_sel:[0,1,1] op_sel_hi:[1,1,1]
    v_pk_fma_f32 v[6:7], v[6:7], v[30:31], v[30:31] op_sel:[0,1,1] op_sel_hi:[1,1,1]
    v_rcp_f32 v4, v4
    v_rcp_f32 v6, v6
    v_rcp_f32 v5, v5
    v_rcp_f32 v7, v7
    v_pk_mul_f32 v[76:77], v[76:77], v[4:5]
    v_pk_mul_f32 v[78:79], v[78:79], v[6:7]
    v_cvt_pk_bf16_f32 v188, v76, v77
    v_cvt_pk_bf16_f32 v189, v78, v79
    v_pk_mul_f32 v[4:5], v[92:93], v[92:93]
    v_pk_mul_f32 v[6:7], v[94:95], v[94:95]
    v_pk_fma_f32 v[4:5], v[4:5], v[26:27], v[26:27] op_sel:[0,1,0] op_sel_hi:[1,1,0]
    v_pk_fma_f32 v[6:7], v[6:7], v[26:27], v[26:27] op_sel:[0,1,0] op_sel_hi:[1,1,0]
    v_pk_mul_f32 v[4:5], v[4:5], v[92:93]
    v_pk_mul_f32 v[6:7], v[6:7], v[94:95]
    v_exp_f32 v4, v4
    v_exp_f32 v6, v6
    v_exp_f32 v5, v5
    v_exp_f32 v7, v7
    v_pk_mul_f32 v[92:93], v[92:93], v[204:205]
    v_pk_mul_f32 v[94:95], v[94:95], v[206:207]
    v_pk_fma_f32 v[4:5], v[4:5], v[30:31], v[30:31] op_sel:[0,1,1] op_sel_hi:[1,1,1]
    v_pk_fma_f32 v[6:7], v[6:7], v[30:31], v[30:31] op_sel:[0,1,1] op_sel_hi:[1,1,1]
    v_rcp_f32 v4, v4
    v_rcp_f32 v6, v6
    v_rcp_f32 v5, v5
    v_rcp_f32 v7, v7
    v_pk_mul_f32 v[92:93], v[92:93], v[4:5]
    v_pk_mul_f32 v[94:95], v[94:95], v[6:7]
    v_cvt_pk_bf16_f32 v190, v92, v93
    v_cvt_pk_bf16_f32 v191, v94, v95
    buffer_store_dwordx4 v[188:191], v2, s[16:19], s49 offen offset:2048 sc1
    v_pk_mul_f32 v[4:5], v[96:97], v[96:97]
    v_pk_mul_f32 v[6:7], v[98:99], v[98:99]
    v_pk_fma_f32 v[4:5], v[4:5], v[20:21], v[20:21] op_sel:[0,1,0] op_sel_hi:[1,1,0]
    v_pk_fma_f32 v[6:7], v[6:7], v[20:21], v[20:21] op_sel:[0,1,0] op_sel_hi:[1,1,0]
    v_pk_mul_f32 v[4:5], v[4:5], v[96:97]
    v_pk_mul_f32 v[6:7], v[6:7], v[98:99]
    v_exp_f32 v4, v4
    v_exp_f32 v6, v6
    v_exp_f32 v5, v5
    v_exp_f32 v7, v7
    v_pk_mul_f32 v[96:97], v[96:97], v[208:209]
    v_pk_mul_f32 v[98:99], v[98:99], v[210:211]
    v_pk_fma_f32 v[4:5], v[4:5], v[28:29], v[28:29] op_sel:[0,0,0] op_sel_hi:[1,0,0]
    v_pk_fma_f32 v[6:7], v[6:7], v[28:29], v[28:29] op_sel:[0,0,0] op_sel_hi:[1,0,0]
    v_rcp_f32 v4, v4
    v_rcp_f32 v6, v6
    v_rcp_f32 v5, v5
    v_rcp_f32 v7, v7
    v_pk_mul_f32 v[96:97], v[96:97], v[4:5]
    v_pk_mul_f32 v[98:99], v[98:99], v[6:7]
    v_cvt_pk_bf16_f32 v208, v96, v97
    v_cvt_pk_bf16_f32 v209, v98, v99
    v_pk_mul_f32 v[4:5], v[112:113], v[112:113]
    v_pk_mul_f32 v[6:7], v[114:115], v[114:115]
    v_pk_fma_f32 v[4:5], v[4:5], v[20:21], v[20:21] op_sel:[0,1,0] op_sel_hi:[1,1,0]
    v_pk_fma_f32 v[6:7], v[6:7], v[20:21], v[20:21] op_sel:[0,1,0] op_sel_hi:[1,1,0]
    v_pk_mul_f32 v[4:5], v[4:5], v[112:113]
    v_pk_mul_f32 v[6:7], v[6:7], v[114:115]
    v_exp_f32 v4, v4
    v_exp_f32 v6, v6
    v_exp_f32 v5, v5
    v_exp_f32 v7, v7
    v_pk_mul_f32 v[112:113], v[112:113], v[224:225]
    v_pk_mul_f32 v[114:115], v[114:115], v[226:227]
    v_pk_fma_f32 v[4:5], v[4:5], v[28:29], v[28:29] op_sel:[0,0,0] op_sel_hi:[1,0,0]
    v_pk_fma_f32 v[6:7], v[6:7], v[28:29], v[28:29] op_sel:[0,0,0] op_sel_hi:[1,0,0]
    v_rcp_f32 v4, v4
    v_rcp_f32 v6, v6
    v_rcp_f32 v5, v5
    v_rcp_f32 v7, v7
    v_pk_mul_f32 v[112:113], v[112:113], v[4:5]
    v_pk_mul_f32 v[114:115], v[114:115], v[6:7]
    v_cvt_pk_bf16_f32 v210, v112, v113
    v_cvt_pk_bf16_f32 v211, v114, v115
    buffer_store_dwordx4 v[208:211], v1, s[16:19], s50 offen offset:0 sc1
    v_pk_mul_f32 v[4:5], v[100:101], v[100:101]
    v_pk_mul_f32 v[6:7], v[102:103], v[102:103]
    v_pk_fma_f32 v[4:5], v[4:5], v[22:23], v[22:23] op_sel:[0,1,0] op_sel_hi:[1,1,0]
    v_pk_fma_f32 v[6:7], v[6:7], v[22:23], v[22:23] op_sel:[0,1,0] op_sel_hi:[1,1,0]
    v_pk_mul_f32 v[4:5], v[4:5], v[100:101]
    v_pk_mul_f32 v[6:7], v[6:7], v[102:103]
    v_exp_f32 v4, v4
    v_exp_f32 v6, v6
    v_exp_f32 v5, v5
    v_exp_f32 v7, v7
    v_pk_mul_f32 v[100:101], v[100:101], v[212:213]
    v_pk_mul_f32 v[102:103], v[102:103], v[214:215]
    v_pk_fma_f32 v[4:5], v[4:5], v[28:29], v[28:29] op_sel:[0,1,1] op_sel_hi:[1,1,1]
    v_pk_fma_f32 v[6:7], v[6:7], v[28:29], v[28:29] op_sel:[0,1,1] op_sel_hi:[1,1,1]
    v_rcp_f32 v4, v4
    v_rcp_f32 v6, v6
    v_rcp_f32 v5, v5
    v_rcp_f32 v7, v7
    v_pk_mul_f32 v[100:101], v[100:101], v[4:5]
    v_pk_mul_f32 v[102:103], v[102:103], v[6:7]
    v_cvt_pk_bf16_f32 v212, v100, v101
    v_cvt_pk_bf16_f32 v213, v102, v103
    v_pk_mul_f32 v[4:5], v[116:117], v[116:117]
    v_pk_mul_f32 v[6:7], v[118:119], v[118:119]
    v_pk_fma_f32 v[4:5], v[4:5], v[22:23], v[22:23] op_sel:[0,1,0] op_sel_hi:[1,1,0]
    v_pk_fma_f32 v[6:7], v[6:7], v[22:23], v[22:23] op_sel:[0,1,0] op_sel_hi:[1,1,0]
    v_pk_mul_f32 v[4:5], v[4:5], v[116:117]
    v_pk_mul_f32 v[6:7], v[6:7], v[118:119]
    v_exp_f32 v4, v4
    v_exp_f32 v6, v6
    v_exp_f32 v5, v5
    v_exp_f32 v7, v7
    v_pk_mul_f32 v[116:117], v[116:117], v[228:229]
    v_pk_mul_f32 v[118:119], v[118:119], v[230:231]
    v_pk_fma_f32 v[4:5], v[4:5], v[28:29], v[28:29] op_sel:[0,1,1] op_sel_hi:[1,1,1]
    v_pk_fma_f32 v[6:7], v[6:7], v[28:29], v[28:29] op_sel:[0,1,1] op_sel_hi:[1,1,1]
    v_rcp_f32 v4, v4
    v_rcp_f32 v6, v6
    v_rcp_f32 v5, v5
    v_rcp_f32 v7, v7
    v_pk_mul_f32 v[116:117], v[116:117], v[4:5]
    v_pk_mul_f32 v[118:119], v[118:119], v[6:7]
    v_cvt_pk_bf16_f32 v214, v116, v117
    v_cvt_pk_bf16_f32 v215, v118, v119
    buffer_store_dwordx4 v[212:215], v1, s[16:19], s50 offen offset:2048 sc1
    v_pk_mul_f32 v[4:5], v[104:105], v[104:105]
    v_pk_mul_f32 v[6:7], v[106:107], v[106:107]
    v_pk_fma_f32 v[4:5], v[4:5], v[24:25], v[24:25] op_sel:[0,1,0] op_sel_hi:[1,1,0]
    v_pk_fma_f32 v[6:7], v[6:7], v[24:25], v[24:25] op_sel:[0,1,0] op_sel_hi:[1,1,0]
    v_pk_mul_f32 v[4:5], v[4:5], v[104:105]
    v_pk_mul_f32 v[6:7], v[6:7], v[106:107]
    v_exp_f32 v4, v4
    v_exp_f32 v6, v6
    v_exp_f32 v5, v5
    v_exp_f32 v7, v7
    v_pk_mul_f32 v[104:105], v[104:105], v[216:217]
    v_pk_mul_f32 v[106:107], v[106:107], v[218:219]
    v_pk_fma_f32 v[4:5], v[4:5], v[30:31], v[30:31] op_sel:[0,0,0] op_sel_hi:[1,0,0]
    v_pk_fma_f32 v[6:7], v[6:7], v[30:31], v[30:31] op_sel:[0,0,0] op_sel_hi:[1,0,0]
    v_rcp_f32 v4, v4
    v_rcp_f32 v6, v6
    v_rcp_f32 v5, v5
    v_rcp_f32 v7, v7
    v_pk_mul_f32 v[104:105], v[104:105], v[4:5]
    v_pk_mul_f32 v[106:107], v[106:107], v[6:7]
    v_cvt_pk_bf16_f32 v216, v104, v105
    v_cvt_pk_bf16_f32 v217, v106, v107
    v_pk_mul_f32 v[4:5], v[120:121], v[120:121]
    v_pk_mul_f32 v[6:7], v[122:123], v[122:123]
    v_pk_fma_f32 v[4:5], v[4:5], v[24:25], v[24:25] op_sel:[0,1,0] op_sel_hi:[1,1,0]
    v_pk_fma_f32 v[6:7], v[6:7], v[24:25], v[24:25] op_sel:[0,1,0] op_sel_hi:[1,1,0]
    v_pk_mul_f32 v[4:5], v[4:5], v[120:121]
    v_pk_mul_f32 v[6:7], v[6:7], v[122:123]
    v_exp_f32 v4, v4
    v_exp_f32 v6, v6
    v_exp_f32 v5, v5
    v_exp_f32 v7, v7
    v_pk_mul_f32 v[120:121], v[120:121], v[232:233]
    v_pk_mul_f32 v[122:123], v[122:123], v[234:235]
    v_pk_fma_f32 v[4:5], v[4:5], v[30:31], v[30:31] op_sel:[0,0,0] op_sel_hi:[1,0,0]
    v_pk_fma_f32 v[6:7], v[6:7], v[30:31], v[30:31] op_sel:[0,0,0] op_sel_hi:[1,0,0]
    v_rcp_f32 v4, v4
    v_rcp_f32 v6, v6
    v_rcp_f32 v5, v5
    v_rcp_f32 v7, v7
    v_pk_mul_f32 v[120:121], v[120:121], v[4:5]
    v_pk_mul_f32 v[122:123], v[122:123], v[6:7]
    v_cvt_pk_bf16_f32 v218, v120, v121
    v_cvt_pk_bf16_f32 v219, v122, v123
    buffer_store_dwordx4 v[216:219], v2, s[16:19], s50 offen offset:0 sc1
    v_pk_mul_f32 v[4:5], v[108:109], v[108:109]
    v_pk_mul_f32 v[6:7], v[110:111], v[110:111]
    v_pk_fma_f32 v[4:5], v[4:5], v[26:27], v[26:27] op_sel:[0,1,0] op_sel_hi:[1,1,0]
    v_pk_fma_f32 v[6:7], v[6:7], v[26:27], v[26:27] op_sel:[0,1,0] op_sel_hi:[1,1,0]
    v_pk_mul_f32 v[4:5], v[4:5], v[108:109]
    v_pk_mul_f32 v[6:7], v[6:7], v[110:111]
    v_exp_f32 v4, v4
    v_exp_f32 v6, v6
    v_exp_f32 v5, v5
    v_exp_f32 v7, v7
    v_pk_mul_f32 v[108:109], v[108:109], v[220:221]
    v_pk_mul_f32 v[110:111], v[110:111], v[222:223]
    v_pk_fma_f32 v[4:5], v[4:5], v[30:31], v[30:31] op_sel:[0,1,1] op_sel_hi:[1,1,1]
    v_pk_fma_f32 v[6:7], v[6:7], v[30:31], v[30:31] op_sel:[0,1,1] op_sel_hi:[1,1,1]
    v_rcp_f32 v4, v4
    v_rcp_f32 v6, v6
    v_rcp_f32 v5, v5
    v_rcp_f32 v7, v7
    v_pk_mul_f32 v[108:109], v[108:109], v[4:5]
    v_pk_mul_f32 v[110:111], v[110:111], v[6:7]
    v_cvt_pk_bf16_f32 v220, v108, v109
    v_cvt_pk_bf16_f32 v221, v110, v111
    v_pk_mul_f32 v[4:5], v[124:125], v[124:125]
    v_pk_mul_f32 v[6:7], v[126:127], v[126:127]
    v_pk_fma_f32 v[4:5], v[4:5], v[26:27], v[26:27] op_sel:[0,1,0] op_sel_hi:[1,1,0]
    v_pk_fma_f32 v[6:7], v[6:7], v[26:27], v[26:27] op_sel:[0,1,0] op_sel_hi:[1,1,0]
    v_pk_mul_f32 v[4:5], v[4:5], v[124:125]
    v_pk_mul_f32 v[6:7], v[6:7], v[126:127]
    v_exp_f32 v4, v4
    v_exp_f32 v6, v6
    v_exp_f32 v5, v5
    v_exp_f32 v7, v7
    v_pk_mul_f32 v[124:125], v[124:125], v[236:237]
    v_pk_mul_f32 v[126:127], v[126:127], v[238:239]
    v_pk_fma_f32 v[4:5], v[4:5], v[30:31], v[30:31] op_sel:[0,1,1] op_sel_hi:[1,1,1]
    v_pk_fma_f32 v[6:7], v[6:7], v[30:31], v[30:31] op_sel:[0,1,1] op_sel_hi:[1,1,1]
    v_rcp_f32 v4, v4
    v_rcp_f32 v6, v6
    v_rcp_f32 v5, v5
    v_rcp_f32 v7, v7
    v_pk_mul_f32 v[124:125], v[124:125], v[4:5]
    v_pk_mul_f32 v[126:127], v[126:127], v[6:7]
    v_cvt_pk_bf16_f32 v222, v124, v125
    v_cvt_pk_bf16_f32 v223, v126, v127
    buffer_store_dwordx4 v[220:223], v2, s[16:19], s50 offen offset:2048 sc1
    v_pk_mul_f32 v[4:5], v[128:129], v[128:129]
    v_pk_mul_f32 v[6:7], v[130:131], v[130:131]
    v_pk_fma_f32 v[4:5], v[4:5], v[20:21], v[20:21] op_sel:[0,1,0] op_sel_hi:[1,1,0]
    v_pk_fma_f32 v[6:7], v[6:7], v[20:21], v[20:21] op_sel:[0,1,0] op_sel_hi:[1,1,0]
    v_pk_mul_f32 v[4:5], v[4:5], v[128:129]
    v_pk_mul_f32 v[6:7], v[6:7], v[130:131]
    v_exp_f32 v4, v4
    v_exp_f32 v6, v6
    v_exp_f32 v5, v5
    v_exp_f32 v7, v7
    v_pk_mul_f32 v[128:129], v[128:129], v[240:241]
    v_pk_mul_f32 v[130:131], v[130:131], v[242:243]
    v_pk_fma_f32 v[4:5], v[4:5], v[28:29], v[28:29] op_sel:[0,0,0] op_sel_hi:[1,0,0]
    v_pk_fma_f32 v[6:7], v[6:7], v[28:29], v[28:29] op_sel:[0,0,0] op_sel_hi:[1,0,0]
    v_rcp_f32 v4, v4
    v_rcp_f32 v6, v6
    v_rcp_f32 v5, v5
    v_rcp_f32 v7, v7
    v_pk_mul_f32 v[128:129], v[128:129], v[4:5]
    v_pk_mul_f32 v[130:131], v[130:131], v[6:7]
    v_cvt_pk_bf16_f32 v240, v128, v129
    v_cvt_pk_bf16_f32 v241, v130, v131
    buffer_store_dwordx2 v[240:241], v1, s[16:19], s51 offen offset:0 sc1
    v_pk_mul_f32 v[4:5], v[132:133], v[132:133]
    v_pk_mul_f32 v[6:7], v[134:135], v[134:135]
    v_pk_fma_f32 v[4:5], v[4:5], v[22:23], v[22:23] op_sel:[0,1,0] op_sel_hi:[1,1,0]
    v_pk_fma_f32 v[6:7], v[6:7], v[22:23], v[22:23] op_sel:[0,1,0] op_sel_hi:[1,1,0]
    v_pk_mul_f32 v[4:5], v[4:5], v[132:133]
    v_pk_mul_f32 v[6:7], v[6:7], v[134:135]
    v_exp_f32 v4, v4
    v_exp_f32 v6, v6
    v_exp_f32 v5, v5
    v_exp_f32 v7, v7
    v_pk_mul_f32 v[132:133], v[132:133], v[244:245]
    v_pk_mul_f32 v[134:135], v[134:135], v[246:247]
    v_pk_fma_f32 v[4:5], v[4:5], v[28:29], v[28:29] op_sel:[0,1,1] op_sel_hi:[1,1,1]
    v_pk_fma_f32 v[6:7], v[6:7], v[28:29], v[28:29] op_sel:[0,1,1] op_sel_hi:[1,1,1]
    v_rcp_f32 v4, v4
    v_rcp_f32 v6, v6
    v_rcp_f32 v5, v5
    v_rcp_f32 v7, v7
    v_pk_mul_f32 v[132:133], v[132:133], v[4:5]
    v_pk_mul_f32 v[134:135], v[134:135], v[6:7]
    v_cvt_pk_bf16_f32 v244, v132, v133
    v_cvt_pk_bf16_f32 v245, v134, v135
    buffer_store_dwordx2 v[244:245], v1, s[16:19], s51 offen offset:2048 sc1
    v_pk_mul_f32 v[4:5], v[136:137], v[136:137]
    v_pk_mul_f32 v[6:7], v[138:139], v[138:139]
    v_pk_fma_f32 v[4:5], v[4:5], v[24:25], v[24:25] op_sel:[0,1,0] op_sel_hi:[1,1,0]
    v_pk_fma_f32 v[6:7], v[6:7], v[24:25], v[24:25] op_sel:[0,1,0] op_sel_hi:[1,1,0]
    v_pk_mul_f32 v[4:5], v[4:5], v[136:137]
    v_pk_mul_f32 v[6:7], v[6:7], v[138:139]
    v_exp_f32 v4, v4
    v_exp_f32 v6, v6
    v_exp_f32 v5, v5
    v_exp_f32 v7, v7
    v_pk_mul_f32 v[136:137], v[136:137], v[248:249]
    v_pk_mul_f32 v[138:139], v[138:139], v[250:251]
    v_pk_fma_f32 v[4:5], v[4:5], v[30:31], v[30:31] op_sel:[0,0,0] op_sel_hi:[1,0,0]
    v_pk_fma_f32 v[6:7], v[6:7], v[30:31], v[30:31] op_sel:[0,0,0] op_sel_hi:[1,0,0]
    v_rcp_f32 v4, v4
    v_rcp_f32 v6, v6
    v_rcp_f32 v5, v5
    v_rcp_f32 v7, v7
    v_pk_mul_f32 v[136:137], v[136:137], v[4:5]
    v_pk_mul_f32 v[138:139], v[138:139], v[6:7]
    v_cvt_pk_bf16_f32 v248, v136, v137
    v_cvt_pk_bf16_f32 v249, v138, v139
    buffer_store_dwordx2 v[248:249], v2, s[16:19], s51 offen offset:0 sc1
    v_pk_mul_f32 v[4:5], v[140:141], v[140:141]
    v_pk_mul_f32 v[6:7], v[142:143], v[142:143]
    v_pk_fma_f32 v[4:5], v[4:5], v[26:27], v[26:27] op_sel:[0,1,0] op_sel_hi:[1,1,0]
    v_pk_fma_f32 v[6:7], v[6:7], v[26:27], v[26:27] op_sel:[0,1,0] op_sel_hi:[1,1,0]
    v_pk_mul_f32 v[4:5], v[4:5], v[140:141]
    v_pk_mul_f32 v[6:7], v[6:7], v[142:143]
    v_exp_f32 v4, v4
    v_exp_f32 v6, v6
    v_exp_f32 v5, v5
    v_exp_f32 v7, v7
    v_pk_mul_f32 v[140:141], v[140:141], v[252:253]
    v_pk_mul_f32 v[142:143], v[142:143], v[254:255]
    v_pk_fma_f32 v[4:5], v[4:5], v[30:31], v[30:31] op_sel:[0,1,1] op_sel_hi:[1,1,1]
    v_pk_fma_f32 v[6:7], v[6:7], v[30:31], v[30:31] op_sel:[0,1,1] op_sel_hi:[1,1,1]
    v_rcp_f32 v4, v4
    v_rcp_f32 v6, v6
    v_rcp_f32 v5, v5
    v_rcp_f32 v7, v7
    v_pk_mul_f32 v[140:141], v[140:141], v[4:5]
    v_pk_mul_f32 v[142:143], v[142:143], v[6:7]
    v_cvt_pk_bf16_f32 v252, v140, v141
    v_cvt_pk_bf16_f32 v253, v142, v143
    buffer_store_dwordx2 v[252:253], v2, s[16:19], s51 offen offset:2048 sc1
    s_lshl_b32 s91, s25, 5
    s_add_u32 s91, s91, s26
    s_lshl_b32 s91, s91, 7
L_k3_ffn_kernel_k5:
    s_lshl_b32 s91, s25, 1
    s_lshr_b32 s33, s24, 1
    s_add_u32 s91, s91, s33
    s_lshl_b32 s91, s91, 1
    s_lshr_b32 s33, s26, 4
    s_add_u32 s91, s91, s33
    s_lshl_b32 s91, s91, 8
    s_mov_b64 s[42:43], s[88:89]
    s_and_b32 s3, s2, 7
    s_lshr_b32 s33, s2, 3
    s_and_b32 s27, s3, 1
    s_lshr_b32 s25, s3, 1
    s_lshl_b32 s25, s25, 2
    s_and_b32 s34, s33, 3
    s_add_u32 s25, s25, s34
    s_lshr_b32 s26, s33, 2
    s_lshl_b32 s34, s25, 3
    s_lshl_b32 s35, s24, 1
    s_add_u32 s34, s34, s35
    s_add_u32 s60, s34, s27
    s_lshl_b32 s34, s60, 11
    v_lshlrev_b32 v10, 4, v0
    v_add_u32 v1, s34, v10
    v_xor_b32 v2, 2048, v1
    s_mul_i32 s34, s26, 917504
    s_lshl_b32 s30, s24, 11
    s_add_u32 s34, s34, s30
    v_add_u32 v3, s34, v10
    v_add_u32 v4, 458752, v3
    s_mul_i32 s56, s27, 7340032
    s_add_u32 s58, s56, 7340032
    s_mul_i32 s57, s27, 229376
    s_add_u32 s59, s57, 229376
    s_mov_b32 s28, s56
    s_mov_b32 s29, s57
    v_lshrrev_b32 v10, 4, v0
    v_bfe_u32 v11, v0, 2, 2
    v_lshl_add_u32 v12, v10, 2, v11
    v_lshlrev_b32 v12, 7, v12
    v_and_b32 v13, 3, v0
    v_lshl_add_u32 v12, v13, 3, v12
    v_lshrrev_b32 v11, 1, v11
    v_and_b32 v10, 1, v10
    v_lshl_or_b32 v10, v10, 1, v11
    v_lshl_or_b32 v6, v10, 5, v12
    v_xor_b32 v7, 32, v6
    v_xor_b32 v8, 64, v6
    v_xor_b32 v9, 96, v6
    s_add_u32 s8, s4, 17825792
    s_addc_u32 s9, s5, 0
    s_and_b32 s9, s9, 0xffff
    s_mov_b32 s10, 14680064
    s_mov_b32 s11, 0x20000
    s_add_u32 s12, s4, 33554432
    s_addc_u32 s13, s5, 0
    s_and_b32 s13, s13, 0xffff
    s_mov_b32 s14, 7340032
    s_mov_b32 s15, 0x20000
    s_waitcnt vmcnt(8)
    s_add_u32 s46, s4, 61898752
    s_addc_u32 s47, s5, 0
    v_mov_b32 v12, s91
    v_mov_b32 v13, 1
    s_mov_b64 exec, 1
    global_atomic_add v12, v13, s[46:47] sc1
    s_mov_b64 exec, -1
    s_add_u32 m0, s30, 0
    s_nop 0
    buffer_load_dwordx4 v3, s[12:15], s29 offen lds
    buffer_load_dwordx4 v3, s[12:15], s29 offen offset:1024 lds
    s_add_u32 m0, s30, 8192
    s_nop 0
    buffer_load_dwordx4 v4, s[12:15], s29 offen lds
    buffer_load_dwordx4 v4, s[12:15], s29 offen offset:1024 lds
    s_add_u32 s57, s57, 8192
    s_cmp_lt_u32 s57, s59
    s_cselect_b32 s29, s57, 0x7ff00000
    s_add_u32 m0, s30, 16384
    s_nop 0
    buffer_load_dwordx4 v3, s[12:15], s29 offen lds
    buffer_load_dwordx4 v3, s[12:15], s29 offen offset:1024 lds
    s_add_u32 m0, s30, 24576
    s_nop 0
    buffer_load_dwordx4 v4, s[12:15], s29 offen lds
    buffer_load_dwordx4 v4, s[12:15], s29 offen offset:1024 lds
    s_add_u32 s57, s57, 8192
    s_cmp_lt_u32 s57, s59
    s_cselect_b32 s29, s57, 0x7ff00000
    s_add_u32 m0, s30, 32768
    s_nop 0
    buffer_load_dwordx4 v3, s[12:15], s29 offen lds
    buffer_load_dwordx4 v3, s[12:15], s29 offen offset:1024 lds
    s_add_u32 m0, s30, 40960
    s_nop 0
    buffer_load_dwordx4 v4, s[12:15], s29 offen lds
    buffer_load_dwordx4 v4, s[12:15], s29 offen offset:1024 lds
    s_add_u32 s57, s57, 8192
    s_cmp_lt_u32 s57, s59
    s_cselect_b32 s29, s57, 0x7ff00000
    s_add_u32 m0, s30, 49152
    s_nop 0
    buffer_load_dwordx4 v3, s[12:15], s29 offen lds
    buffer_load_dwordx4 v3, s[12:15], s29 offen offset:1024 lds
    s_add_u32 m0, s30, 57344
    s_nop 0
    buffer_load_dwordx4 v4, s[12:15], s29 offen lds
    buffer_load_dwordx4 v4, s[12:15], s29 offen offset:1024 lds
    s_add_u32 s57, s57, 8192
    s_cmp_lt_u32 s57, s59
    s_cselect_b32 s29, s57, 0x7ff00000
    v_mov_b64 v[16:17], 0
    v_mov_b64 v[18:19], 0
    v_mov_b64 v[20:21], 0
    v_mov_b64 v[22:23], 0
    v_mov_b64 v[24:25], 0
    v_mov_b64 v[26:27], 0
    v_mov_b64 v[28:29], 0
    v_mov_b64 v[30:31], 0
    v_mov_b64 v[32:33], 0
    v_mov_b64 v[34:35], 0
    v_mov_b64 v[36:37], 0
    v_mov_b64 v[38:39], 0
    v_mov_b64 v[40:41], 0
    v_mov_b64 v[42:43], 0
    v_mov_b64 v[44:45], 0
    v_mov_b64 v[46:47], 0
    v_mov_b64 v[48:49], 0
    v_mov_b64 v[50:51], 0
    v_mov_b64 v[52:53], 0
    v_mov_b64 v[54:55], 0
    v_mov_b64 v[56:57], 0
    v_mov_b64 v[58:59], 0
    v_mov_b64 v[60:61], 0
    v_mov_b64 v[62:63], 0
    v_mov_b64 v[64:65], 0
    v_mov_b64 v[66:67], 0
    v_mov_b64 v[68:69], 0
    v_mov_b64 v[70:71], 0
    v_mov_b64 v[72:73], 0
    v_mov_b64 v[74:75], 0
    v_mov_b64 v[76:77], 0
    v_mov_b64 v[78:79], 0
    s_cmp_lg_u32 s24, 0
    s_cbranch_scc1 L_k3_ffn_kernel_h5
    s_lshl_b32 s33, s25, 1
    s_add_u32 s33, s33, s27
    s_lshl_b32 s33, s33, 8
    s_add_u32 s46, s4, 61898752
    s_addc_u32 s47, s5, 0
    v_mov_b32 v12, s33
    s_mov_b32 s37, 0x8000
L_k3_ffn_kernel_sp0:
    global_load_dword v13, v12, s[46:47] sc1
    s_waitcnt vmcnt(0)
    v_readfirstlane_b32 s34, v13
    s_sub_u32 s37, s37, 1
    s_cmp_eq_u32 s37, 0
    s_cbranch_scc1 L_k3_ffn_kernel_sg0
    s_cmp_lt_u32 s34, 32
    s_cbranch_scc1 L_k3_ffn_kernel_sp0
L_k3_ffn_kernel_sg0:
L_k3_ffn_kernel_h5:
    s_waitcnt vmcnt(0)
    s_barrier
    s_add_u32 s46, s4, 61898880
    s_addc_u32 s47, s5, 0
    v_mov_b32 v12, s91
    v_mov_b32 v13, 1
    s_mov_b64 exec, 1
    global_atomic_add v12, v13, s[46:47] sc1
    s_mov_b64 exec, -1
    ds_read_b64_tr_b16 v[80:81], v6 offset:0
    ds_read_b64_tr_b16 v[82:83], v6 offset:2048
    ds_read_b64_tr_b16 v[84:85], v7 offset:0
    ds_read_b64_tr_b16 v[86:87], v7 offset:2048
    ds_read_b64_tr_b16 v[88:89], v8 offset:0
    ds_read_b64_tr_b16 v[90:91], v8 offset:2048
    ds_read_b64_tr_b16 v[92:93], v9 offset:0
    ds_read_b64_tr_b16 v[94:95], v9 offset:2048
    ds_read_b64_tr_b16 v[96:97], v6 offset:8192
    ds_read_b64_tr_b16 v[98:99], v6 offset:10240
    ds_read_b64_tr_b16 v[100:101], v7 offset:8192
    ds_read_b64_tr_b16 v[102:103], v7 offset:10240
    ds_read_b64_tr_b16 v[104:105], v8 offset:8192
    ds_read_b64_tr_b16 v[106:107], v8 offset:10240
    ds_read_b64_tr_b16 v[108:109], v9 offset:8192
    ds_read_b64_tr_b16 v[110:111], v9 offset:10240
    ds_read_b64_tr_b16 v[112:113], v6 offset:4096
    ds_read_b64_tr_b16 v[114:115], v6 offset:6144
    ds_read_b64_tr_b16 v[116:117], v7 offset:4096
    ds_read_b64_tr_b16 v[118:119], v7 offset:6144
    ds_read_b64_tr_b16 v[120:121], v8 offset:4096
    ds_read_b64_tr_b16 v[122:123], v8 offset:6144
    ds_read_b64_tr_b16 v[124:125], v9 offset:4096
    ds_read_b64_tr_b16 v[126:127], v9 offset:6144
    ds_read_b64_tr_b16 v[128:129], v6 offset:12288
    ds_read_b64_tr_b16 v[130:131], v6 offset:14336
    ds_read_b64_tr_b16 v[132:133], v7 offset:12288
    ds_read_b64_tr_b16 v[134:135], v7 offset:14336
    ds_read_b64_tr_b16 v[136:137], v8 offset:12288
    ds_read_b64_tr_b16 v[138:139], v8 offset:14336
    ds_read_b64_tr_b16 v[140:141], v9 offset:12288
    ds_read_b64_tr_b16 v[142:143], v9 offset:14336
    buffer_load_dwordx4 a[0:3], v1, s[8:11], s28 offen offset:0
    buffer_load_dwordx4 a[8:11], v1, s[8:11], s28 offen offset:1024
    buffer_load_dwordx4 a[4:7], v2, s[8:11], s28 offen offset:0
    buffer_load_dwordx4 a[12:15], v2, s[8:11], s28 offen offset:1024
    s_add_u32 s56, s56, 262144
    s_cmp_lt_u32 s56, s58
    s_cselect_b32 s28, s56, 0x7ff00000
    buffer_load_dwordx4 a[16:19], v1, s[8:11], s28 offen offset:0
    buffer_load_dwordx4 a[24:27], v1, s[8:11], s28 offen offset:1024
    buffer_load_dwordx4 a[20:23], v2, s[8:11], s28 offen offset:0
    buffer_load_dwordx4 a[28:31], v2, s[8:11], s28 offen offset:1024
    s_add_u32 s56, s56, 262144
    s_cmp_lt_u32 s56, s58
    s_cselect_b32 s28, s56, 0x7ff00000
    buffer_load_dwordx4 a[32:35], v1, s[8:11], s28 offen offset:0
    buffer_load_dwordx4 a[40:43], v1, s[8:11], s28 offen offset:1024
    buffer_load_dwordx4 a[36:39], v2, s[8:11], s28 offen offset:0
    buffer_load_dwordx4 a[44:47], v2, s[8:11], s28 offen offset:1024
    s_add_u32 s56, s56, 262144
    s_cmp_lt_u32 s56, s58
    s_cselect_b32 s28, s56, 0x7ff00000
    s_add_u32 s20, s4, 13631488
    s_addc_u32 s21, s5, 0
    s_and_b32 s21, s21, 0xffff
    s_mov_b32 s22, 4194304
    s_mov_b32 s23, 0x20000
    s_lshl_b32 s34, s26, 19
    s_add_u32 s35, s34, 262144
    buffer_load_dwordx4 v[208:211], v1, s[20:23], s34 offen offset:0
    buffer_load_dwordx4 v[212:215], v1, s[20:23], s34 offen offset:1024
    buffer_load_dwordx4 v[216:219], v1, s[20:23], s35 offen offset:0
    buffer_load_dwordx4 v[220:223], v1, s[20:23], s35 offen offset:1024
    s_add_u32 s20, s4, 4616192
    s_addc_u32 s21, s5, 0
    s_and_b32 s21, s21, 0xffff
    s_mov_b32 s22, 8192
    s_mov_b32 s23, 0x20000
    v_and_b32 v10, 15, v0
    v_lshlrev_b32 v10, 2, v10
    s_lshl_b32 s34, s60, 6
    buffer_load_dword v224, v10, s[20:23], s34 offen
    s_mov_b32 s44, 6
L_k3_ffn_kernel_5_loop:
    s_waitcnt vmcnt(13) lgkmcnt(0)
    s_barrier
    s_add_u32 m0, s30, 0
    s_nop 0
    buffer_load_dwordx4 v3, s[12:15], s29 offen lds
    v_mfma_f32_16x16x32_bf16 v[16:19], v[80:83], a[0:3], v[16:19]
    buffer_load_dwordx4 v3, s[12:15], s29 offen offset:1024 lds
    ds_read_b64_tr_b16 v[144:145], v6 offset:16384
    ds_read_b64_tr_b16 v[146:147], v6 offset:18432
    v_mfma_f32_16x16x32_bf16 v[48:51], v[80:83], a[4:7], v[48:51]
    ds_read_b64_tr_b16 v[148:149], v7 offset:16384
    v_mfma_f32_16x16x32_bf16 v[20:23], v[84:87], a[0:3], v[20:23]
    ds_read_b64_tr_b16 v[150:151], v7 offset:18432
    v_mfma_f32_16x16x32_bf16 v[52:55], v[84:87], a[4:7], v[52:55]
    s_add_u32 m0, s30, 8192
    s_nop 0
    buffer_load_dwordx4 v4, s[12:15], s29 offen lds
    ds_read_b64_tr_b16 v[152:153], v8 offset:16384
    v_mfma_f32_16x16x32_bf16 v[24:27], v[88:91], a[0:3], v[24:27]
    ds_read_b64_tr_b16 v[154:155], v8 offset:18432
    v_mfma_f32_16x16x32_bf16 v[56:59], v[88:91], a[4:7], v[56:59]
    ds_read_b64_tr_b16 v[156:157], v9 offset:16384
    v_mfma_f32_16x16x32_bf16 v[28:31], v[92:95], a[0:3], v[28:31]
    buffer_load_dwordx4 v4, s[12:15], s29 offen offset:1024 lds
    s_add_u32 s57, s57, 8192
    s_cmp_lt_u32 s57, s59
    s_cselect_b32 s29, s57, 0x7ff00000
    ds_read_b64_tr_b16 v[158:159], v9 offset:18432
    v_mfma_f32_16x16x32_bf16 v[60:63], v[92:95], a[4:7], v[60:63]
    ds_read_b64_tr_b16 v[160:161], v6 offset:24576
    ds_read_b64_tr_b16 v[162:163], v6 offset:26624
    v_mfma_f32_16x16x32_bf16 v[32:35], v[96:99], a[0:3], v[32:35]
    ds_read_b64_tr_b16 v[164:165], v7 offset:24576
    v_mfma_f32_16x16x32_bf16 v[64:67], v[96:99], a[4:7], v[64:67]
    buffer_load_dwordx4 a[48:51], v1, s[8:11], s28 offen offset:0
    ds_read_b64_tr_b16 v[166:167], v7 offset:26624
    v_mfma_f32_16x16x32_bf16 v[36:39], v[100:103], a[0:3], v[36:39]
    ds_read_b64_tr_b16 v[168:169], v8 offset:24576
    v_mfma_f32_16x16x32_bf16 v[68:71], v[100:103], a[4:7], v[68:71]
    ds_read_b64_tr_b16 v[170:171], v8 offset:26624
    v_mfma_f32_16x16x32_bf16 v[40:43], v[104:107], a[0:3], v[40:43]
    buffer_load_dwordx4 a[56:59], v1, s[8:11], s28 offen offset:1024
    ds_read_b64_tr_b16 v[172:173], v9 offset:24576
    v_mfma_f32_16x16x32_bf16 v[72:75], v[104:107], a[4:7], v[72:75]
    ds_read_b64_tr_b16 v[174:175], v9 offset:26624
    v_mfma_f32_16x16x32_bf16 v[44:47], v[108:111], a[0:3], v[44:47]
    ds_read_b64_tr_b16 v[176:177], v6 offset:20480
    ds_read_b64_tr_b16 v[178:179], v6 offset:22528
    v_mfma_f32_16x16x32_bf16 v[76:79], v[108:111], a[4:7], v[76:79]
    buffer_load_dwordx4 a[52:55], v2, s[8:11], s28 offen offset:0
    ds_read_b64_tr_b16 v[180:181], v7 offset:20480
    v_mfma_f32_16x16x32_bf16 v[16:19], v[112:115], a[8:11], v[16:19]
    ds_read_b64_tr_b16 v[182:183], v7 offset:22528
    v_mfma_f32_16x16x32_bf16 v[48:51], v[112:115], a[12:15], v[48:51]
    ds_read_b64_tr_b16 v[184:185], v8 offset:20480
    v_mfma_f32_16x16x32_bf16 v[20:23], v[116:119], a[8:11], v[20:23]
    buffer_load_dwordx4 a[60:63], v2, s[8:11], s28 offen offset:1024
    s_add_u32 s56, s56, 262144
    s_cmp_lt_u32 s56, s58
    s_cselect_b32 s28, s56, 0x7ff00000
    ds_read_b64_tr_b16 v[186:187], v8 offset:22528
    v_mfma_f32_16x16x32_bf16 v[52:55], v[116:119], a[12:15], v[52:55]
    ds_read_b64_tr_b16 v[188:189], v9 offset:20480
    v_mfma_f32_16x16x32_bf16 v[24:27], v[120:123], a[8:11], v[24:27]
    ds_read_b64_tr_b16 v[190:191], v9 offset:22528
    v_mfma_f32_16x16x32_bf16 v[56:59], v[120:123], a[12:15], v[56:59]
    ds_read_b64_tr_b16 v[192:193], v6 offset:28672
    ds_read_b64_tr_b16 v[194:195], v6 offset:30720
    v_mfma_f32_16x16x32_bf16 v[28:31], v[124:127], a[8:11], v[28:31]
    ds_read_b64_tr_b16 v[196:197], v7 offset:28672
    v_mfma_f32_16x16x32_bf16 v[60:63], v[124:127], a[12:15], v[60:63]
    ds_read_b64_tr_b16 v[198:199], v7 offset:30720
    v_mfma_f32_16x16x32_bf16 v[32:35], v[128:131], a[8:11], v[32:35]
    ds_read_b64_tr_b16 v[200:201], v8 offset:28672
    v_mfma_f32_16x16x32_bf16 v[64:67], v[128:131], a[12:15], v[64:67]
    ds_read_b64_tr_b16 v[202:203], v8 offset:30720
    v_mfma_f32_16x16x32_bf16 v[36:39], v[132:135], a[8:11], v[36:39]
    ds_read_b64_tr_b16 v[204:205], v9 offset:28672
    v_mfma_f32_16x16x32_bf16 v[68:71], v[132:135], a[12:15], v[68:71]
    ds_read_b64_tr_b16 v[206:207], v9 offset:30720
    v_mfma_f32_16x16x32_bf16 v[40:43], v[136:139], a[8:11], v[40:43]
    v_mfma_f32_16x16x32_bf16 v[72:75], v[136:139], a[12:15], v[72:75]
    v_mfma_f32_16x16x32_bf16 v[44:47], v[140:143], a[8:11], v[44:47]
    v_mfma_f32_16x16x32_bf16 v[76:79], v[140:143], a[12:15], v[76:79]
    s_waitcnt vmcnt(16) lgkmcnt(0)
    s_barrier
    s_add_u32 m0, s30, 16384
    s_nop 0
    buffer_load_dwordx4 v3, s[12:15], s29 offen lds
    v_mfma_f32_16x16x32_bf16 v[16:19], v[144:147], a[16:19], v[16:19]
    buffer_load_dwordx4 v3, s[12:15], s29 offen offset:1024 lds
    ds_read_b64_tr_b16 v[80:81], v6 offset:32768
    ds_read_b64_tr_b16 v[82:83], v6 offset:34816
    v_mfma_f32_16x16x32_bf16 v[48:51], v[144:147], a[20:23], v[48:51]
    ds_read_b64_tr_b16 v[84:85], v7 offset:32768
    v_mfma_f32_16x16x32_bf16 v[20:23], v[148:151], a[16:19], v[20:23]
    ds_read_b64_tr_b16 v[86:87], v7 offset:34816
    v_mfma_f32_16x16x32_bf16 v[52:55], v[148:151], a[20:23], v[52:55]
    s_add_u32 m0, s30, 24576
    s_nop 0
    buffer_load_dwordx4 v4, s[12:15], s29 offen lds
    ds_read_b64_tr_b16 v[88:89], v8 offset:32768
    v_mfma_f32_16x16x32_bf16 v[24:27], v[152:155], a[16:19], v[24:27]
    ds_read_b64_tr_b16 v[90:91], v8 offset:34816
    v_mfma_f32_16x16x32_bf16 v[56:59], v[152:155], a[20:23], v[56:59]
    ds_read_b64_tr_b16 v[92:93], v9 offset:32768
    v_mfma_f32_16x16x32_bf16 v[28:31], v[156:159], a[16:19], v[28:31]
    buffer_load_dwordx4 v4, s[12:15], s29 offen offset:1024 lds
    s_add_u32 s57, s57, 8192
    s_cmp_lt_u32 s57, s59
    s_cselect_b32 s29, s57, 0x7ff00000
    ds_read_b64_tr_b16 v[94:95], v9 offset:34816
    v_mfma_f32_16x16x32_bf16 v[60:63], v[156:159], a[20:23], v[60:63]
    ds_read_b64_tr_b16 v[96:97], v6 offset:40960
    ds_read_b64_tr_b16 v[98:99], v6 offset:43008
    v_mfma_f32_16x16x32_bf16 v[32:35], v[160:163], a[16:19], v[32:35]
    ds_read_b64_tr_b16 v[100:101], v7 offset:40960
    v_mfma_f32_16x16x32_bf16 v[64:67], v[160:163], a[20:23], v[64:67]
    buffer_load_dwordx4 a[0:3], v1, s[8:11], s28 offen offset:0
    ds_read_b64_tr_b16 v[102:103], v7 offset:43008
    v_mfma_f32_16x16x32_bf16 v[36:39], v[164:167], a[16:19], v[36:39]
    ds_read_b64_tr_b16 v[104:105], v8 offset:40960
    v_mfma_f32_16x16x32_bf16 v[68:71], v[164:167], a[20:23], v[68:71]
    ds_read_b64_tr_b16 v[106:107], v8 offset:43008
    v_mfma_f32_16x16x32_bf16 v[40:43], v[168:171], a[16:19], v[40:43]
    buffer_load_dwordx4 a[8:11], v1, s[8:11], s28 offen offset:1024
    ds_read_b64_tr_b16 v[108:109], v9 offset:40960
    v_mfma_f32_16x16x32_bf16 v[72:75], v[168:171], a[20:23], v[72:75]
    ds_read_b64_tr_b16 v[110:111], v9 offset:43008
    v_mfma_f32_16x16x32_bf16 v[44:47], v[172:175], a[16:19], v[44:47]
    ds_read_b64_tr_b16 v[112:113], v6 offset:36864
    ds_read_b64_tr_b16 v[114:115], v6 offset:38912
    v_mfma_f32_16x16x32_bf16 v[76:79], v[172:175], a[20:23], v[76:79]
    buffer_load_dwordx4 a[4:7], v2, s[8:11], s28 offen offset:0
    ds_read_b64_tr_b16 v[116:117], v7 offset:36864
    v_mfma_f32_16x16x32_bf16 v[16:19], v[176:179], a[24:27], v[16:19]
    ds_read_b64_tr_b16 v[118:119], v7 offset:38912
    v_mfma_f32_16x16x32_bf16 v[48:51], v[176:179], a[28:31], v[48:51]
    ds_read_b64_tr_b16 v[120:121], v8 offset:36864
    v_mfma_f32_16x16x32_bf16 v[20:23], v[180:183], a[24:27], v[20:23]
    buffer_load_dwordx4 a[12:15], v2, s[8:11], s28 offen offset:1024
    s_add_u32 s56, s56, 262144
    s_cmp_lt_u32 s56, s58
    s_cselect_b32 s28, s56, 0x7ff00000
    ds_read_b64_tr_b16 v[122:123], v8 offset:38912
    v_mfma_f32_16x16x32_bf16 v[52:55], v[180:183], a[28:31], v[52:55]
    ds_read_b64_tr_b16 v[124:125], v9 offset:36864
    v_mfma_f32_16x16x32_bf16 v[24:27], v[184:187], a[24:27], v[24:27]
    ds_read_b64_tr_b16 v[126:127], v9 offset:38912
    v_mfma_f32_16x16x32_bf16 v[56:59], v[184:187], a[28:31], v[56:59]
    ds_read_b64_tr_b16 v[128:129], v6 offset:45056
    ds_read_b64_tr_b16 v[130:131], v6 offset:47104
    v_mfma_f32_16x16x32_bf16 v[28:31], v[188:191], a[24:27], v[28:31]
    ds_read_b64_tr_b16 v[132:133], v7 offset:45056
    v_mfma_f32_16x16x32_bf16 v[60:63], v[188:191], a[28:31], v[60:63]
    ds_read_b64_tr_b16 v[134:135], v7 offset:47104
    v_mfma_f32_16x16x32_bf16 v[32:35], v[192:195], a[24:27], v[32:35]
    ds_read_b64_tr_b16 v[136:137], v8 offset:45056
    v_mfma_f32_16x16x32_bf16 v[64:67], v[192:195], a[28:31], v[64:67]
    ds_read_b64_tr_b16 v[138:139], v8 offset:47104
    v_mfma_f32_16x16x32_bf16 v[36:39], v[196:199], a[24:27], v[36:39]
    ds_read_b64_tr_b16 v[140:141], v9 offset:45056
    v_mfma_f32_16x16x32_bf16 v[68:71], v[196:199], a[28:31], v[68:71]
    ds_read_b64_tr_b16 v[142:143], v9 offset:47104
    v_mfma_f32_16x16x32_bf16 v[40:43], v[200:203], a[24:27], v[40:43]
    v_mfma_f32_16x16x32_bf16 v[72:75], v[200:203], a[28:31], v[72:75]
    v_mfma_f32_16x16x32_bf16 v[44:47], v[204:207], a[24:27], v[44:47]
    v_mfma_f32_16x16x32_bf16 v[76:79], v[204:207], a[28:31], v[76:79]
    s_waitcnt vmcnt(16) lgkmcnt(0)
    s_barrier
    s_add_u32 m0, s30, 32768
    s_nop 0
    buffer_load_dwordx4 v3, s[12:15], s29 offen lds
    v_mfma_f32_16x16x32_bf16 v[16:19], v[80:83], a[32:35], v[16:19]
    buffer_load_dwordx4 v3, s[12:15], s29 offen offset:1024 lds
    ds_read_b64_tr_b16 v[144:145], v6 offset:49152
    ds_read_b64_tr_b16 v[146:147], v6 offset:51200
    v_mfma_f32_16x16x32_bf16 v[48:51], v[80:83], a[36:39], v[48:51]
    ds_read_b64_tr_b16 v[148:149], v7 offset:49152
    v_mfma_f32_16x16x32_bf16 v[20:23], v[84:87], a[32:35], v[20:23]
    ds_read_b64_tr_b16 v[150:151], v7 offset:51200
    v_mfma_f32_16x16x32_bf16 v[52:55], v[84:87], a[36:39], v[52:55]
    s_add_u32 m0, s30, 40960
    s_nop 0
    buffer_load_dwordx4 v4, s[12:15], s29 offen lds
    ds_read_b64_tr_b16 v[152:153], v8 offset:49152
    v_mfma_f32_16x16x32_bf16 v[24:27], v[88:91], a[32:35], v[24:27]
    ds_read_b64_tr_b16 v[154:155], v8 offset:51200
    v_mfma_f32_16x16x32_bf16 v[56:59], v[88:91], a[36:39], v[56:59]
    ds_read_b64_tr_b16 v[156:157], v9 offset:49152
    v_mfma_f32_16x16x32_bf16 v[28:31], v[92:95], a[32:35], v[28:31]
    buffer_load_dwordx4 v4, s[12:15], s29 offen offset:1024 lds
    s_add_u32 s57, s57, 8192
    s_cmp_lt_u32 s57, s59
    s_cselect_b32 s29, s57, 0x7ff00000
    ds_read_b64_tr_b16 v[158:159], v9 offset:51200
    v_mfma_f32_16x16x32_bf16 v[60:63], v[92:95], a[36:39], v[60:63]
    ds_read_b64_tr_b16 v[160:161], v6 offset:57344
    ds_read_b64_tr_b16 v[162:163], v6 offset:59392
    v_mfma_f32_16x16x32_bf16 v[32:35], v[96:99], a[32:35], v[32:35]
    ds_read_b64_tr_b16 v[164:165], v7 offset:57344
    v_mfma_f32_16x16x32_bf16 v[64:67], v[96:99], a[36:39], v[64:67]
    buffer_load_dwordx4 a[16:19], v1, s[8:11], s28 offen offset:0
    ds_read_b64_tr_b16 v[166:167], v7 offset:59392
    v_mfma_f32_16x16x32_bf16 v[36:39], v[100:103], a[32:35], v[36:39]
    ds_read_b64_tr_b16 v[168:169], v8 offset:57344
    v_mfma_f32_16x16x32_bf16 v[68:71], v[100:103], a[36:39], v[68:71]
    ds_read_b64_tr_b16 v[170:171], v8 offset:59392
    v_mfma_f32_16x16x32_bf16 v[40:43], v[104:107], a[32:35], v[40:43]
    buffer_load_dwordx4 a[24:27], v1, s[8:11], s28 offen offset:1024
    ds_read_b64_tr_b16 v[172:173], v9 offset:57344
    v_mfma_f32_16x16x32_bf16 v[72:75], v[104:107], a[36:39], v[72:75]
    ds_read_b64_tr_b16 v[174:175], v9 offset:59392
    v_mfma_f32_16x16x32_bf16 v[44:47], v[108:111], a[32:35], v[44:47]
    ds_read_b64_tr_b16 v[176:177], v6 offset:53248
    ds_read_b64_tr_b16 v[178:179], v6 offset:55296
    v_mfma_f32_16x16x32_bf16 v[76:79], v[108:111], a[36:39], v[76:79]
    buffer_load_dwordx4 a[20:23], v2, s[8:11], s28 offen offset:0
    ds_read_b64_tr_b16 v[180:181], v7 offset:53248
    v_mfma_f32_16x16x32_bf16 v[16:19], v[112:115], a[40:43], v[16:19]
    ds_read_b64_tr_b16 v[182:183], v7 offset:55296
    v_mfma_f32_16x16x32_bf16 v[48:51], v[112:115], a[44:47], v[48:51]
    ds_read_b64_tr_b16 v[184:185], v8 offset:53248
    v_mfma_f32_16x16x32_bf16 v[20:23], v[116:119], a[40:43], v[20:23]
    buffer_load_dwordx4 a[28:31], v2, s[8:11], s28 offen offset:1024
    s_add_u32 s56, s56, 262144
    s_cmp_lt_u32 s56, s58
    s_cselect_b32 s28, s56, 0x7ff00000
    ds_read_b64_tr_b16 v[186:187], v8 offset:55296
    v_mfma_f32_16x16x32_bf16 v[52:55], v[116:119], a[44:47], v[52:55]
    ds_read_b64_tr_b16 v[188:189], v9 offset:53248
    v_mfma_f32_16x16x32_bf16 v[24:27], v[120:123], a[40:43], v[24:27]
    ds_read_b64_tr_b16 v[190:191], v9 offset:55296
    v_mfma_f32_16x16x32_bf16 v[56:59], v[120:123], a[44:47], v[56:59]
    ds_read_b64_tr_b16 v[192:193], v6 offset:61440
    ds_read_b64_tr_b16 v[194:195], v6 offset:63488
    v_mfma_f32_16x16x32_bf16 v[28:31], v[124:127], a[40:43], v[28:31]
    ds_read_b64_tr_b16 v[196:197], v7 offset:61440
    v_mfma_f32_16x16x32_bf16 v[60:63], v[124:127], a[44:47], v[60:63]
    ds_read_b64_tr_b16 v[198:199], v7 offset:63488
    v_mfma_f32_16x16x32_bf16 v[32:35], v[128:131], a[40:43], v[32:35]
    ds_read_b64_tr_b16 v[200:201], v8 offset:61440
    v_mfma_f32_16x16x32_bf16 v[64:67], v[128:131], a[44:47], v[64:67]
    ds_read_b64_tr_b16 v[202:203], v8 offset:63488
    v_mfma_f32_16x16x32_bf16 v[36:39], v[132:135], a[40:43], v[36:39]
    ds_read_b64_tr_b16 v[204:205], v9 offset:61440
    v_mfma_f32_16x16x32_bf16 v[68:71], v[132:135], a[44:47], v[68:71]
    ds_read_b64_tr_b16 v[206:207], v9 offset:63488
    v_mfma_f32_16x16x32_bf16 v[40:43], v[136:139], a[40:43], v[40:43]
    v_mfma_f32_16x16x32_bf16 v[72:75], v[136:139], a[44:47], v[72:75]
    v_mfma_f32_16x16x32_bf16 v[44:47], v[140:143], a[40:43], v[44:47]
    v_mfma_f32_16x16x32_bf16 v[76:79], v[140:143], a[44:47], v[76:79]
    s_waitcnt vmcnt(16) lgkmcnt(0)
    s_barrier
    s_add_u32 m0, s30, 49152
    s_nop 0
    buffer_load_dwordx4 v3, s[12:15], s29 offen lds
    v_mfma_f32_16x16x32_bf16 v[16:19], v[144:147], a[48:51], v[16:19]
    buffer_load_dwordx4 v3, s[12:15], s29 offen offset:1024 lds
    ds_read_b64_tr_b16 v[80:81], v6 offset:0
    ds_read_b64_tr_b16 v[82:83], v6 offset:2048
    v_mfma_f32_16x16x32_bf16 v[48:51], v[144:147], a[52:55], v[48:51]
    ds_read_b64_tr_b16 v[84:85], v7 offset:0
    v_mfma_f32_16x16x32_bf16 v[20:23], v[148:151], a[48:51], v[20:23]
    ds_read_b64_tr_b16 v[86:87], v7 offset:2048
    v_mfma_f32_16x16x32_bf16 v[52:55], v[148:151], a[52:55], v[52:55]
    s_add_u32 m0, s30, 57344
    s_nop 0
    buffer_load_dwordx4 v4, s[12:15], s29 offen lds
    ds_read_b64_tr_b16 v[88:89], v8 offset:0
    v_mfma_f32_16x16x32_bf16 v[24:27], v[152:155], a[48:51], v[24:27]
    ds_read_b64_tr_b16 v[90:91], v8 offset:2048
    v_mfma_f32_16x16x32_bf16 v[56:59], v[152:155], a[52:55], v[56:59]
    ds_read_b64_tr_b16 v[92:93], v9 offset:0
    v_mfma_f32_16x16x32_bf16 v[28:31], v[156:159], a[48:51], v[28:31]
    buffer_load_dwordx4 v4, s[12:15], s29 offen offset:1024 lds
    s_add_u32 s57, s57, 8192
    s_cmp_lt_u32 s57, s59
    s_cselect_b32 s29, s57, 0x7ff00000
    ds_read_b64_tr_b16 v[94:95], v9 offset:2048
    v_mfma_f32_16x16x32_bf16 v[60:63], v[156:159], a[52:55], v[60:63]
    ds_read_b64_tr_b16 v[96:97], v6 offset:8192
    ds_read_b64_tr_b16 v[98:99], v6 offset:10240
    v_mfma_f32_16x16x32_bf16 v[32:35], v[160:163], a[48:51], v[32:35]
    ds_read_b64_tr_b16 v[100:101], v7 offset:8192
    v_mfma_f32_16x16x32_bf16 v[64:67], v[160:163], a[52:55], v[64:67]
    buffer_load_dwordx4 a[32:35], v1, s[8:11], s28 offen offset:0
    ds_read_b64_tr_b16 v[102:103], v7 offset:10240
    v_mfma_f32_16x16x32_bf16 v[36:39], v[164:167], a[48:51], v[36:39]
    ds_read_b64_tr_b16 v[104:105], v8 offset:8192
    v_mfma_f32_16x16x32_bf16 v[68:71], v[164:167], a[52:55], v[68:71]
    ds_read_b64_tr_b16 v[106:107], v8 offset:10240
    v_mfma_f32_16x16x32_bf16 v[40:43], v[168:171], a[48:51], v[40:43]
    buffer_load_dwordx4 a[40:43], v1, s[8:11], s28 offen offset:1024
    ds_read_b64_tr_b16 v[108:109], v9 offset:8192
    v_mfma_f32_16x16x32_bf16 v[72:75], v[168:171], a[52:55], v[72:75]
    ds_read_b64_tr_b16 v[110:111], v9 offset:10240
    v_mfma_f32_16x16x32_bf16 v[44:47], v[172:175], a[48:51], v[44:47]
    ds_read_b64_tr_b16 v[112:113], v6 offset:4096
    ds_read_b64_tr_b16 v[114:115], v6 offset:6144
    v_mfma_f32_16x16x32_bf16 v[76:79], v[172:175], a[52:55], v[76:79]
    buffer_load_dwordx4 a[36:39], v2, s[8:11], s28 offen offset:0
    ds_read_b64_tr_b16 v[116:117], v7 offset:4096
    v_mfma_f32_16x16x32_bf16 v[16:19], v[176:179], a[56:59], v[16:19]
    ds_read_b64_tr_b16 v[118:119], v7 offset:6144
    v_mfma_f32_16x16x32_bf16 v[48:51], v[176:179], a[60:63], v[48:51]
    ds_read_b64_tr_b16 v[120:121], v8 offset:4096
    v_mfma_f32_16x16x32_bf16 v[20:23], v[180:183], a[56:59], v[20:23]
    buffer_load_dwordx4 a[44:47], v2, s[8:11], s28 offen offset:1024
    s_add_u32 s56, s56, 262144
    s_cmp_lt_u32 s56, s58
    s_cselect_b32 s28, s56, 0x7ff00000
    ds_read_b64_tr_b16 v[122:123], v8 offset:6144
    v_mfma_f32_16x16x32_bf16 v[52:55], v[180:183], a[60:63], v[52:55]
    ds_read_b64_tr_b16 v[124:125], v9 offset:4096
    v_mfma_f32_16x16x32_bf16 v[24:27], v[184:187], a[56:59], v[24:27]
    ds_read_b64_tr_b16 v[126:127], v9 offset:6144
    v_mfma_f32_16x16x32_bf16 v[56:59], v[184:187], a[60:63], v[56:59]
    ds_read_b64_tr_b16 v[128:129], v6 offset:12288
    ds_read_b64_tr_b16 v[130:131], v6 offset:14336
    v_mfma_f32_16x16x32_bf16 v[28:31], v[188:191], a[56:59], v[28:31]
    ds_read_b64_tr_b16 v[132:133], v7 offset:12288
    v_mfma_f32_16x16x32_bf16 v[60:63], v[188:191], a[60:63], v[60:63]
    ds_read_b64_tr_b16 v[134:135], v7 offset:14336
    v_mfma_f32_16x16x32_bf16 v[32:35], v[192:195], a[56:59], v[32:35]
    ds_read_b64_tr_b16 v[136:137], v8 offset:12288
    v_mfma_f32_16x16x32_bf16 v[64:67], v[192:195], a[60:63], v[64:67]
    ds_read_b64_tr_b16 v[138:139], v8 offset:14336
    v_mfma_f32_16x16x32_bf16 v[36:39], v[196:199], a[56:59], v[36:39]
    ds_read_b64_tr_b16 v[140:141], v9 offset:12288
    v_mfma_f32_16x16x32_bf16 v[68:71], v[196:199], a[60:63], v[68:71]
    ds_read_b64_tr_b16 v[142:143], v9 offset:14336
    v_mfma_f32_16x16x32_bf16 v[40:43], v[200:203], a[56:59], v[40:43]
    v_mfma_f32_16x16x32_bf16 v[72:75], v[200:203], a[60:63], v[72:75]
    v_mfma_f32_16x16x32_bf16 v[44:47], v[204:207], a[56:59], v[44:47]
    v_mfma_f32_16x16x32_bf16 v[76:79], v[204:207], a[60:63], v[76:79]
    s_cmp_eq_u32 s44, 5
    s_cbranch_scc1 L_k3_ffn_kernel_5_g1r
    s_cmp_eq_u32 s44, 4
    s_cbranch_scc1 L_k3_ffn_kernel_5_g1c
L_k3_ffn_kernel_5_g1b:
    s_sub_u32 s44, s44, 1
    s_cmp_lg_u32 s44, 0
    s_cbranch_scc1 L_k3_ffn_kernel_5_loop
    s_waitcnt vmcnt(16) lgkmcnt(0)
    s_barrier
    buffer_load_dwordx4 a[48:51], v1, s[8:11], s28 offen offset:0
    buffer_load_dwordx4 a[56:59], v1, s[8:11], s28 offen offset:1024
    buffer_load_dwordx4 a[52:55], v2, s[8:11], s28 offen offset:0
    buffer_load_dwordx4 a[60:63], v2, s[8:11], s28 offen offset:1024
    s_add_u32 s56, s56, 262144
    s_cmp_lt_u32 s56, s58
    s_cselect_b32 s28, s56, 0x7ff00000
    v_mfma_f32_16x16x32_bf16 v[48:51], v[80:83], a[4:7], v[48:51]
    ds_read_b64_tr_b16 v[144:145], v6 offset:16384
    ds_read_b64_tr_b16 v[146:147], v6 offset:18432
    ds_read_b64_tr_b16 v[148:149], v7 offset:16384
    v_mfma_f32_16x16x32_bf16 v[52:55], v[84:87], a[4:7], v[52:55]
    ds_read_b64_tr_b16 v[150:151], v7 offset:18432
    ds_read_b64_tr_b16 v[152:153], v8 offset:16384
    v_mfma_f32_16x16x32_bf16 v[56:59], v[88:91], a[4:7], v[56:59]
    ds_read_b64_tr_b16 v[154:155], v8 offset:18432
    ds_read_b64_tr_b16 v[156:157], v9 offset:16384
    v_mfma_f32_16x16x32_bf16 v[60:63], v[92:95], a[4:7], v[60:63]
    ds_read_b64_tr_b16 v[158:159], v9 offset:18432
    ds_read_b64_tr_b16 v[160:161], v6 offset:24576
    ds_read_b64_tr_b16 v[162:163], v6 offset:26624
    v_mfma_f32_16x16x32_bf16 v[64:67], v[96:99], a[4:7], v[64:67]
    ds_read_b64_tr_b16 v[164:165], v7 offset:24576
    ds_read_b64_tr_b16 v[166:167], v7 offset:26624
    v_mfma_f32_16x16x32_bf16 v[68:71], v[100:103], a[4:7], v[68:71]
    ds_read_b64_tr_b16 v[168:169], v8 offset:24576
    ds_read_b64_tr_b16 v[170:171], v8 offset:26624
    v_mfma_f32_16x16x32_bf16 v[72:75], v[104:107], a[4:7], v[72:75]
    ds_read_b64_tr_b16 v[172:173], v9 offset:24576
    ds_read_b64_tr_b16 v[174:175], v9 offset:26624
    v_mfma_f32_16x16x32_bf16 v[76:79], v[108:111], a[4:7], v[76:79]
    ds_read_b64_tr_b16 v[176:177], v6 offset:20480
    ds_read_b64_tr_b16 v[178:179], v6 offset:22528
    ds_read_b64_tr_b16 v[180:181], v7 offset:20480
    v_mfma_f32_16x16x32_bf16 v[48:51], v[112:115], a[12:15], v[48:51]
    ds_read_b64_tr_b16 v[182:183], v7 offset:22528
    ds_read_b64_tr_b16 v[184:185], v8 offset:20480
    v_mfma_f32_16x16x32_bf16 v[52:55], v[116:119], a[12:15], v[52:55]
    ds_read_b64_tr_b16 v[186:187], v8 offset:22528
    ds_read_b64_tr_b16 v[188:189], v9 offset:20480
    v_mfma_f32_16x16x32_bf16 v[56:59], v[120:123], a[12:15], v[56:59]
    ds_read_b64_tr_b16 v[190:191], v9 offset:22528
    ds_read_b64_tr_b16 v[192:193], v6 offset:28672
    ds_read_b64_tr_b16 v[194:195], v6 offset:30720
    v_mfma_f32_16x16x32_bf16 v[60:63], v[124:127], a[12:15], v[60:63]
    ds_read_b64_tr_b16 v[196:197], v7 offset:28672
    ds_read_b64_tr_b16 v[198:199], v7 offset:30720
    v_mfma_f32_16x16x32_bf16 v[64:67], v[128:131], a[12:15], v[64:67]
    ds_read_b64_tr_b16 v[200:201], v8 offset:28672
    ds_read_b64_tr_b16 v[202:203], v8 offset:30720
    v_mfma_f32_16x16x32_bf16 v[68:71], v[132:135], a[12:15], v[68:71]
    ds_read_b64_tr_b16 v[204:205], v9 offset:28672
    ds_read_b64_tr_b16 v[206:207], v9 offset:30720
    v_mfma_f32_16x16x32_bf16 v[72:75], v[136:139], a[12:15], v[72:75]
    v_mfma_f32_16x16x32_bf16 v[76:79], v[140:143], a[12:15], v[76:79]
    s_waitcnt vmcnt(12) lgkmcnt(0)
    s_barrier
    v_mfma_f32_16x16x32_bf16 v[48:51], v[144:147], a[20:23], v[48:51]
    ds_read_b64_tr_b16 v[80:81], v6 offset:32768
    ds_read_b64_tr_b16 v[82:83], v6 offset:34816
    ds_read_b64_tr_b16 v[84:85], v7 offset:32768
    v_mfma_f32_16x16x32_bf16 v[52:55], v[148:151], a[20:23], v[52:55]
    ds_read_b64_tr_b16 v[86:87], v7 offset:34816
    ds_read_b64_tr_b16 v[88:89], v8 offset:32768
    v_mfma_f32_16x16x32_bf16 v[56:59], v[152:155], a[20:23], v[56:59]
    ds_read_b64_tr_b16 v[90:91], v8 offset:34816
    ds_read_b64_tr_b16 v[92:93], v9 offset:32768
    v_mfma_f32_16x16x32_bf16 v[60:63], v[156:159], a[20:23], v[60:63]
    ds_read_b64_tr_b16 v[94:95], v9 offset:34816
    ds_read_b64_tr_b16 v[96:97], v6 offset:40960
    ds_read_b64_tr_b16 v[98:99], v6 offset:43008
    v_mfma_f32_16x16x32_bf16 v[64:67], v[160:163], a[20:23], v[64:67]
    ds_read_b64_tr_b16 v[100:101], v7 offset:40960
    ds_read_b64_tr_b16 v[102:103], v7 offset:43008
    v_mfma_f32_16x16x32_bf16 v[68:71], v[164:167], a[20:23], v[68:71]
    ds_read_b64_tr_b16 v[104:105], v8 offset:40960
    ds_read_b64_tr_b16 v[106:107], v8 offset:43008
    v_mfma_f32_16x16x32_bf16 v[72:75], v[168:171], a[20:23], v[72:75]
    ds_read_b64_tr_b16 v[108:109], v9 offset:40960
    ds_read_b64_tr_b16 v[110:111], v9 offset:43008
    v_mfma_f32_16x16x32_bf16 v[76:79], v[172:175], a[20:23], v[76:79]
    ds_read_b64_tr_b16 v[112:113], v6 offset:36864
    ds_read_b64_tr_b16 v[114:115], v6 offset:38912
    ds_read_b64_tr_b16 v[116:117], v7 offset:36864
    v_mfma_f32_16x16x32_bf16 v[48:51], v[176:179], a[28:31], v[48:51]
    ds_read_b64_tr_b16 v[118:119], v7 offset:38912
    ds_read_b64_tr_b16 v[120:121], v8 offset:36864
    v_mfma_f32_16x16x32_bf16 v[52:55], v[180:183], a[28:31], v[52:55]
    ds_read_b64_tr_b16 v[122:123], v8 offset:38912
    ds_read_b64_tr_b16 v[124:125], v9 offset:36864
    v_mfma_f32_16x16x32_bf16 v[56:59], v[184:187], a[28:31], v[56:59]
    ds_read_b64_tr_b16 v[126:127], v9 offset:38912
    ds_read_b64_tr_b16 v[128:129], v6 offset:45056
    ds_read_b64_tr_b16 v[130:131], v6 offset:47104
    v_mfma_f32_16x16x32_bf16 v[60:63], v[188:191], a[28:31], v[60:63]
    ds_read_b64_tr_b16 v[132:133], v7 offset:45056
    ds_read_b64_tr_b16 v[134:135], v7 offset:47104
    v_mfma_f32_16x16x32_bf16 v[64:67], v[192:195], a[28:31], v[64:67]
    ds_read_b64_tr_b16 v[136:137], v8 offset:45056
    ds_read_b64_tr_b16 v[138:139], v8 offset:47104
    v_mfma_f32_16x16x32_bf16 v[68:71], v[196:199], a[28:31], v[68:71]
    ds_read_b64_tr_b16 v[140:141], v9 offset:45056
    ds_read_b64_tr_b16 v[142:143], v9 offset:47104
    v_mfma_f32_16x16x32_bf16 v[72:75], v[200:203], a[28:31], v[72:75]
    v_mfma_f32_16x16x32_bf16 v[76:79], v[204:207], a[28:31], v[76:79]
    s_waitcnt vmcnt(4) lgkmcnt(0)
    s_barrier
    v_mfma_f32_16x16x32_bf16 v[48:51], v[80:83], a[36:39], v[48:51]
    ds_read_b64_tr_b16 v[144:145], v6 offset:49152
    ds_read_b64_tr_b16 v[146:147], v6 offset:51200
    ds_read_b64_tr_b16 v[148:149], v7 offset:49152
    v_mfma_f32_16x16x32_bf16 v[52:55], v[84:87], a[36:39], v[52:55]
    ds_read_b64_tr_b16 v[150:151], v7 offset:51200
    ds_read_b64_tr_b16 v[152:153], v8 offset:49152
    v_mfma_f32_16x16x32_bf16 v[56:59], v[88:91], a[36:39], v[56:59]
    ds_read_b64_tr_b16 v[154:155], v8 offset:51200
    ds_read_b64_tr_b16 v[156:157], v9 offset:49152
    v_mfma_f32_16x16x32_bf16 v[60:63], v[92:95], a[36:39], v[60:63]
    ds_read_b64_tr_b16 v[158:159], v9 offset:51200
    ds_read_b64_tr_b16 v[160:161], v6 offset:57344
    ds_read_b64_tr_b16 v[162:163], v6 offset:59392
    v_mfma_f32_16x16x32_bf16 v[64:67], v[96:99], a[36:39], v[64:67]
    ds_read_b64_tr_b16 v[164:165], v7 offset:57344
    ds_read_b64_tr_b16 v[166:167], v7 offset:59392
    v_mfma_f32_16x16x32_bf16 v[68:71], v[100:103], a[36:39], v[68:71]
    ds_read_b64_tr_b16 v[168:169], v8 offset:57344
    ds_read_b64_tr_b16 v[170:171], v8 offset:59392
    v_mfma_f32_16x16x32_bf16 v[72:75], v[104:107], a[36:39], v[72:75]
    ds_read_b64_tr_b16 v[172:173], v9 offset:57344
    ds_read_b64_tr_b16 v[174:175], v9 offset:59392
    v_mfma_f32_16x16x32_bf16 v[76:79], v[108:111], a[36:39], v[76:79]
    ds_read_b64_tr_b16 v[176:177], v6 offset:53248
    ds_read_b64_tr_b16 v[178:179], v6 offset:55296
    ds_read_b64_tr_b16 v[180:181], v7 offset:53248
    v_mfma_f32_16x16x32_bf16 v[48:51], v[112:115], a[44:47], v[48:51]
    ds_read_b64_tr_b16 v[182:183], v7 offset:55296
    ds_read_b64_tr_b16 v[184:185], v8 offset:53248
    v_mfma_f32_16x16x32_bf16 v[52:55], v[116:119], a[44:47], v[52:55]
    ds_read_b64_tr_b16 v[186:187], v8 offset:55296
    ds_read_b64_tr_b16 v[188:189], v9 offset:53248
    v_mfma_f32_16x16x32_bf16 v[56:59], v[120:123], a[44:47], v[56:59]
    ds_read_b64_tr_b16 v[190:191], v9 offset:55296
    ds_read_b64_tr_b16 v[192:193], v6 offset:61440
    ds_read_b64_tr_b16 v[194:195], v6 offset:63488
    v_mfma_f32_16x16x32_bf16 v[60:63], v[124:127], a[44:47], v[60:63]
    ds_read_b64_tr_b16 v[196:197], v7 offset:61440
    ds_read_b64_tr_b16 v[198:199], v7 offset:63488
    v_mfma_f32_16x16x32_bf16 v[64:67], v[128:131], a[44:47], v[64:67]
    ds_read_b64_tr_b16 v[200:201], v8 offset:61440
    ds_read_b64_tr_b16 v[202:203], v8 offset:63488
    v_mfma_f32_16x16x32_bf16 v[68:71], v[132:135], a[44:47], v[68:71]
    ds_read_b64_tr_b16 v[204:205], v9 offset:61440
    ds_read_b64_tr_b16 v[206:207], v9 offset:63488
    v_mfma_f32_16x16x32_bf16 v[72:75], v[136:139], a[44:47], v[72:75]
    v_mfma_f32_16x16x32_bf16 v[76:79], v[140:143], a[44:47], v[76:79]
    s_waitcnt vmcnt(0) lgkmcnt(0)
    v_mfma_f32_16x16x32_bf16 v[48:51], v[144:147], a[52:55], v[48:51]
    ds_read_b64_tr_b16 v[80:81], v6 offset:0
    ds_read_b64_tr_b16 v[82:83], v6 offset:2048
    ds_read_b64_tr_b16 v[84:85], v7 offset:0
    v_mfma_f32_16x16x32_bf16 v[52:55], v[148:151], a[52:55], v[52:55]
    ds_read_b64_tr_b16 v[86:87], v7 offset:2048
    ds_read_b64_tr_b16 v[88:89], v8 offset:0
    v_mfma_f32_16x16x32_bf16 v[56:59], v[152:155], a[52:55], v[56:59]
    ds_read_b64_tr_b16 v[90:91], v8 offset:2048
    ds_read_b64_tr_b16 v[92:93], v9 offset:0
    v_mfma_f32_16x16x32_bf16 v[60:63], v[156:159], a[52:55], v[60:63]
    ds_read_b64_tr_b16 v[94:95], v9 offset:2048
    ds_read_b64_tr_b16 v[96:97], v6 offset:8192
    ds_read_b64_tr_b16 v[98:99], v6 offset:10240
    v_mfma_f32_16x16x32_bf16 v[64:67], v[160:163], a[52:55], v[64:67]
    ds_read_b64_tr_b16 v[100:101], v7 offset:8192
    ds_read_b64_tr_b16 v[102:103], v7 offset:10240
    v_mfma_f32_16x16x32_bf16 v[68:71], v[164:167], a[52:55], v[68:71]
    ds_read_b64_tr_b16 v[104:105], v8 offset:8192
    ds_read_b64_tr_b16 v[106:107], v8 offset:10240
    v_mfma_f32_16x16x32_bf16 v[72:75], v[168:171], a[52:55], v[72:75]
    ds_read_b64_tr_b16 v[108:109], v9 offset:8192
    ds_read_b64_tr_b16 v[110:111], v9 offset:10240
    v_mfma_f32_16x16x32_bf16 v[76:79], v[172:175], a[52:55], v[76:79]
    ds_read_b64_tr_b16 v[112:113], v6 offset:4096
    ds_read_b64_tr_b16 v[114:115], v6 offset:6144
    ds_read_b64_tr_b16 v[116:117], v7 offset:4096
    v_mfma_f32_16x16x32_bf16 v[48:51], v[176:179], a[60:63], v[48:51]
    ds_read_b64_tr_b16 v[118:119], v7 offset:6144
    ds_read_b64_tr_b16 v[120:121], v8 offset:4096
    v_mfma_f32_16x16x32_bf16 v[52:55], v[180:183], a[60:63], v[52:55]
    ds_read_b64_tr_b16 v[122:123], v8 offset:6144
    ds_read_b64_tr_b16 v[124:125], v9 offset:4096
    v_mfma_f32_16x16x32_bf16 v[56:59], v[184:187], a[60:63], v[56:59]
    ds_read_b64_tr_b16 v[126:127], v9 offset:6144
    ds_read_b64_tr_b16 v[128:129], v6 offset:12288
    ds_read_b64_tr_b16 v[130:131], v6 offset:14336
    v_mfma_f32_16x16x32_bf16 v[60:63], v[188:191], a[60:63], v[60:63]
    ds_read_b64_tr_b16 v[132:133], v7 offset:12288
    ds_read_b64_tr_b16 v[134:135], v7 offset:14336
    v_mfma_f32_16x16x32_bf16 v[64:67], v[192:195], a[60:63], v[64:67]
    ds_read_b64_tr_b16 v[136:137], v8 offset:12288
    ds_read_b64_tr_b16 v[138:139], v8 offset:14336
    v_mfma_f32_16x16x32_bf16 v[68:71], v[196:199], a[60:63], v[68:71]
    ds_read_b64_tr_b16 v[140:141], v9 offset:12288
    ds_read_b64_tr_b16 v[142:143], v9 offset:14336
    v_mfma_f32_16x16x32_bf16 v[72:75], v[200:203], a[60:63], v[72:75]
    v_mfma_f32_16x16x32_bf16 v[76:79], v[204:207], a[60:63], v[76:79]
    s_lshl_b32 s34, s25, 3
    s_add_u32 s34, s34, s26
    s_lshl_b32 s34, s34, 1
    s_add_u32 s35, s34, s27
    s_lshl_b32 s35, s35, 2
    s_add_u32 s35, s35, s24
    s_xor_b32 s36, s35, 4
    s_add_u32 s8, s4, 50331648
    s_addc_u32 s9, s5, 0
    s_and_b32 s9, s9, 0xffff
    s_mov_b32 s10, 8388608
    s_mov_b32 s11, 0x20000
    s_add_u32 s12, s4, 61931520
    s_addc_u32 s13, s5, 0
    s_and_b32 s13, s13, 0xffff
    s_mov_b32 s14, 131072
    s_mov_b32 s15, 0x20000
    v_lshlrev_b32 v10, 4, v0
    s_lshl_b32 s37, s35, 13
    s_add_u32 s38, s37, 4096
    buffer_store_dwordx4 v[48:51], v10, s[8:11], s37 offen offset:0 sc1
    buffer_store_dwordx4 v[52:55], v10, s[8:11], s37 offen offset:1024 sc1
    buffer_store_dwordx4 v[56:59], v10, s[8:11], s37 offen offset:2048 sc1
    buffer_store_dwordx4 v[60:63], v10, s[8:11], s37 offen offset:3072 sc1
    buffer_store_dwordx4 v[64:67], v10, s[8:11], s38 offen offset:0 sc1
    buffer_store_dwordx4 v[68:71], v10, s[8:11], s38 offen offset:1024 sc1
    buffer_store_dwordx4 v[72:75], v10, s[8:11], s38 offen offset:2048 sc1
    buffer_store_dwordx4 v[76:79], v10, s[8:11], s38 offen offset:3072 sc1
    s_waitcnt lgkmcnt(0)
    v_mfma_f32_16x16x32_bf16 v[16:19], v[80:83], a[0:3], v[16:19]
    ds_read_b64_tr_b16 v[144:145], v6 offset:16384
    ds_read_b64_tr_b16 v[146:147], v6 offset:18432
    ds_read_b64_tr_b16 v[148:149], v7 offset:16384
    v_mfma_f32_16x16x32_bf16 v[20:23], v[84:87], a[0:3], v[20:23]
    ds_read_b64_tr_b16 v[150:151], v7 offset:18432
    ds_read_b64_tr_b16 v[152:153], v8 offset:16384
    v_mfma_f32_16x16x32_bf16 v[24:27], v[88:91], a[0:3], v[24:27]
    ds_read_b64_tr_b16 v[154:155], v8 offset:18432
    ds_read_b64_tr_b16 v[156:157], v9 offset:16384
    v_mfma_f32_16x16x32_bf16 v[28:31], v[92:95], a[0:3], v[28:31]
    ds_read_b64_tr_b16 v[158:159], v9 offset:18432
    ds_read_b64_tr_b16 v[160:161], v6 offset:24576
    ds_read_b64_tr_b16 v[162:163], v6 offset:26624
    v_mfma_f32_16x16x32_bf16 v[32:35], v[96:99], a[0:3], v[32:35]
    ds_read_b64_tr_b16 v[164:165], v7 offset:24576
    ds_read_b64_tr_b16 v[166:167], v7 offset:26624
    v_mfma_f32_16x16x32_bf16 v[36:39], v[100:103], a[0:3], v[36:39]
    ds_read_b64_tr_b16 v[168:169], v8 offset:24576
    ds_read_b64_tr_b16 v[170:171], v8 offset:26624
    v_mfma_f32_16x16x32_bf16 v[40:43], v[104:107], a[0:3], v[40:43]
    ds_read_b64_tr_b16 v[172:173], v9 offset:24576
    ds_read_b64_tr_b16 v[174:175], v9 offset:26624
    v_mfma_f32_16x16x32_bf16 v[44:47], v[108:111], a[0:3], v[44:47]
    ds_read_b64_tr_b16 v[176:177], v6 offset:20480
    ds_read_b64_tr_b16 v[178:179], v6 offset:22528
    ds_read_b64_tr_b16 v[180:181], v7 offset:20480
    v_mfma_f32_16x16x32_bf16 v[16:19], v[112:115], a[8:11], v[16:19]
    ds_read_b64_tr_b16 v[182:183], v7 offset:22528
    ds_read_b64_tr_b16 v[184:185], v8 offset:20480
    v_mfma_f32_16x16x32_bf16 v[20:23], v[116:119], a[8:11], v[20:23]
    ds_read_b64_tr_b16 v[186:187], v8 offset:22528
    ds_read_b64_tr_b16 v[188:189], v9 offset:20480
    v_mfma_f32_16x16x32_bf16 v[24:27], v[120:123], a[8:11], v[24:27]
    ds_read_b64_tr_b16 v[190:191], v9 offset:22528
    ds_read_b64_tr_b16 v[192:193], v6 offset:28672
    ds_read_b64_tr_b16 v[194:195], v6 offset:30720
    v_mfma_f32_16x16x32_bf16 v[28:31], v[124:127], a[8:11], v[28:31]
    ds_read_b64_tr_b16 v[196:197], v7 offset:28672
    ds_read_b64_tr_b16 v[198:199], v7 offset:30720
    v_mfma_f32_16x16x32_bf16 v[32:35], v[128:131], a[8:11], v[32:35]
    ds_read_b64_tr_b16 v[200:201], v8 offset:28672
    ds_read_b64_tr_b16 v[202:203], v8 offset:30720
    v_mfma_f32_16x16x32_bf16 v[36:39], v[132:135], a[8:11], v[36:39]
    ds_read_b64_tr_b16 v[204:205], v9 offset:28672
    ds_read_b64_tr_b16 v[206:207], v9 offset:30720
    v_mfma_f32_16x16x32_bf16 v[40:43], v[136:139], a[8:11], v[40:43]
    v_mfma_f32_16x16x32_bf16 v[44:47], v[140:143], a[8:11], v[44:47]
    s_waitcnt lgkmcnt(0)
    v_mfma_f32_16x16x32_bf16 v[16:19], v[144:147], a[16:19], v[16:19]
    ds_read_b64_tr_b16 v[80:81], v6 offset:32768
    ds_read_b64_tr_b16 v[82:83], v6 offset:34816
    ds_read_b64_tr_b16 v[84:85], v7 offset:32768
    v_mfma_f32_16x16x32_bf16 v[20:23], v[148:151], a[16:19], v[20:23]
    ds_read_b64_tr_b16 v[86:87], v7 offset:34816
    ds_read_b64_tr_b16 v[88:89], v8 offset:32768
    v_mfma_f32_16x16x32_bf16 v[24:27], v[152:155], a[16:19], v[24:27]
    ds_read_b64_tr_b16 v[90:91], v8 offset:34816
    ds_read_b64_tr_b16 v[92:93], v9 offset:32768
    v_mfma_f32_16x16x32_bf16 v[28:31], v[156:159], a[16:19], v[28:31]
    ds_read_b64_tr_b16 v[94:95], v9 offset:34816
    ds_read_b64_tr_b16 v[96:97], v6 offset:40960
    ds_read_b64_tr_b16 v[98:99], v6 offset:43008
    v_mfma_f32_16x16x32_bf16 v[32:35], v[160:163], a[16:19], v[32:35]
    ds_read_b64_tr_b16 v[100:101], v7 offset:40960
    ds_read_b64_tr_b16 v[102:103], v7 offset:43008
    v_mfma_f32_16x16x32_bf16 v[36:39], v[164:167], a[16:19], v[36:39]
    ds_read_b64_tr_b16 v[104:105], v8 offset:40960
    ds_read_b64_tr_b16 v[106:107], v8 offset:43008
    v_mfma_f32_16x16x32_bf16 v[40:43], v[168:171], a[16:19], v[40:43]
    ds_read_b64_tr_b16 v[108:109], v9 offset:40960
    ds_read_b64_tr_b16 v[110:111], v9 offset:43008
    v_mfma_f32_16x16x32_bf16 v[44:47], v[172:175], a[16:19], v[44:47]
    ds_read_b64_tr_b16 v[112:113], v6 offset:36864
    ds_read_b64_tr_b16 v[114:115], v6 offset:38912
    ds_read_b64_tr_b16 v[116:117], v7 offset:36864
    v_mfma_f32_16x16x32_bf16 v[16:19], v[176:179], a[24:27], v[16:19]
    ds_read_b64_tr_b16 v[118:119], v7 offset:38912
    ds_read_b64_tr_b16 v[120:121], v8 offset:36864
    v_mfma_f32_16x16x32_bf16 v[20:23], v[180:183], a[24:27], v[20:23]
    ds_read_b64_tr_b16 v[122:123], v8 offset:38912
    ds_read_b64_tr_b16 v[124:125], v9 offset:36864
    v_mfma_f32_16x16x32_bf16 v[24:27], v[184:187], a[24:27], v[24:27]
    ds_read_b64_tr_b16 v[126:127], v9 offset:38912
    ds_read_b64_tr_b16 v[128:129], v6 offset:45056
    ds_read_b64_tr_b16 v[130:131], v6 offset:47104
    v_mfma_f32_16x16x32_bf16 v[28:31], v[188:191], a[24:27], v[28:31]
    ds_read_b64_tr_b16 v[132:133], v7 offset:45056
    ds_read_b64_tr_b16 v[134:135], v7 offset:47104
    v_mfma_f32_16x16x32_bf16 v[32:35], v[192:195], a[24:27], v[32:35]
    ds_read_b64_tr_b16 v[136:137], v8 offset:45056
    ds_read_b64_tr_b16 v[138:139], v8 offset:47104
    v_mfma_f32_16x16x32_bf16 v[36:39], v[196:199], a[24:27], v[36:39]
    ds_read_b64_tr_b16 v[140:141], v9 offset:45056
    ds_read_b64_tr_b16 v[142:143], v9 offset:47104
    v_mfma_f32_16x16x32_bf16 v[40:43], v[200:203], a[24:27], v[40:43]
    v_mfma_f32_16x16x32_bf16 v[44:47], v[204:207], a[24:27], v[44:47]
    s_waitcnt lgkmcnt(0)
    v_mfma_f32_16x16x32_bf16 v[16:19], v[80:83], a[32:35], v[16:19]
    ds_read_b64_tr_b16 v[144:145], v6 offset:49152
    ds_read_b64_tr_b16 v[146:147], v6 offset:51200
    ds_read_b64_tr_b16 v[148:149], v7 offset:49152
    v_mfma_f32_16x16x32_bf16 v[20:23], v[84:87], a[32:35], v[20:23]
    ds_read_b64_tr_b16 v[150:151], v7 offset:51200
    ds_read_b64_tr_b16 v[152:153], v8 offset:49152
    v_mfma_f32_16x16x32_bf16 v[24:27], v[88:91], a[32:35], v[24:27]
    ds_read_b64_tr_b16 v[154:155], v8 offset:51200
    ds_read_b64_tr_b16 v[156:157], v9 offset:49152
    v_mfma_f32_16x16x32_bf16 v[28:31], v[92:95], a[32:35], v[28:31]
    ds_read_b64_tr_b16 v[158:159], v9 offset:51200
    ds_read_b64_tr_b16 v[160:161], v6 offset:57344
    ds_read_b64_tr_b16 v[162:163], v6 offset:59392
    v_mfma_f32_16x16x32_bf16 v[32:35], v[96:99], a[32:35], v[32:35]
    ds_read_b64_tr_b16 v[164:165], v7 offset:57344
    ds_read_b64_tr_b16 v[166:167], v7 offset:59392
    v_mfma_f32_16x16x32_bf16 v[36:39], v[100:103], a[32:35], v[36:39]
    ds_read_b64_tr_b16 v[168:169], v8 offset:57344
    ds_read_b64_tr_b16 v[170:171], v8 offset:59392
    v_mfma_f32_16x16x32_bf16 v[40:43], v[104:107], a[32:35], v[40:43]
    ds_read_b64_tr_b16 v[172:173], v9 offset:57344
    ds_read_b64_tr_b16 v[174:175], v9 offset:59392
    v_mfma_f32_16x16x32_bf16 v[44:47], v[108:111], a[32:35], v[44:47]
    ds_read_b64_tr_b16 v[176:177], v6 offset:53248
    ds_read_b64_tr_b16 v[178:179], v6 offset:55296
    ds_read_b64_tr_b16 v[180:181], v7 offset:53248
    v_mfma_f32_16x16x32_bf16 v[16:19], v[112:115], a[40:43], v[16:19]
    ds_read_b64_tr_b16 v[182:183], v7 offset:55296
    ds_read_b64_tr_b16 v[184:185], v8 offset:53248
    v_mfma_f32_16x16x32_bf16 v[20:23], v[116:119], a[40:43], v[20:23]
    ds_read_b64_tr_b16 v[186:187], v8 offset:55296
    ds_read_b64_tr_b16 v[188:189], v9 offset:53248
    v_mfma_f32_16x16x32_bf16 v[24:27], v[120:123], a[40:43], v[24:27]
    ds_read_b64_tr_b16 v[190:191], v9 offset:55296
    ds_read_b64_tr_b16 v[192:193], v6 offset:61440
    ds_read_b64_tr_b16 v[194:195], v6 offset:63488
    v_mfma_f32_16x16x32_bf16 v[28:31], v[124:127], a[40:43], v[28:31]
    ds_read_b64_tr_b16 v[196:197], v7 offset:61440
    ds_read_b64_tr_b16 v[198:199], v7 offset:63488
    v_mfma_f32_16x16x32_bf16 v[32:35], v[128:131], a[40:43], v[32:35]
    ds_read_b64_tr_b16 v[200:201], v8 offset:61440
    ds_read_b64_tr_b16 v[202:203], v8 offset:63488
    v_mfma_f32_16x16x32_bf16 v[36:39], v[132:135], a[40:43], v[36:39]
    ds_read_b64_tr_b16 v[204:205], v9 offset:61440
    ds_read_b64_tr_b16 v[206:207], v9 offset:63488
    v_mfma_f32_16x16x32_bf16 v[40:43], v[136:139], a[40:43], v[40:43]
    v_mfma_f32_16x16x32_bf16 v[44:47], v[140:143], a[40:43], v[44:47]
    s_waitcnt lgkmcnt(0)
    v_mfma_f32_16x16x32_bf16 v[16:19], v[144:147], a[48:51], v[16:19]
    v_mfma_f32_16x16x32_bf16 v[20:23], v[148:151], a[48:51], v[20:23]
    v_mfma_f32_16x16x32_bf16 v[24:27], v[152:155], a[48:51], v[24:27]
    v_mfma_f32_16x16x32_bf16 v[28:31], v[156:159], a[48:51], v[28:31]
    v_mfma_f32_16x16x32_bf16 v[32:35], v[160:163], a[48:51], v[32:35]
    v_mfma_f32_16x16x32_bf16 v[36:39], v[164:167], a[48:51], v[36:39]
    v_mfma_f32_16x16x32_bf16 v[40:43], v[168:171], a[48:51], v[40:43]
    v_mfma_f32_16x16x32_bf16 v[44:47], v[172:175], a[48:51], v[44:47]
    v_mfma_f32_16x16x32_bf16 v[16:19], v[176:179], a[56:59], v[16:19]
    v_mfma_f32_16x16x32_bf16 v[20:23], v[180:183], a[56:59], v[20:23]
    v_mfma_f32_16x16x32_bf16 v[24:27], v[184:187], a[56:59], v[24:27]
    v_mfma_f32_16x16x32_bf16 v[28:31], v[188:191], a[56:59], v[28:31]
    v_mfma_f32_16x16x32_bf16 v[32:35], v[192:195], a[56:59], v[32:35]
    v_mfma_f32_16x16x32_bf16 v[36:39], v[196:199], a[56:59], v[36:39]
    v_mfma_f32_16x16x32_bf16 v[40:43], v[200:203], a[56:59], v[40:43]
    v_mfma_f32_16x16x32_bf16 v[44:47], v[204:207], a[56:59], v[44:47]
    s_nop 7
    v_lshlrev_b32 v11, 16, v208
    v_and_b32 v12, 0xffff0000, v208
    v_add_f32 v11, v11, v224
    v_add_f32 v12, v12, v224
    v_add_f32 v16, v16, v11
    v_add_f32 v17, v17, v12
    v_lshlrev_b32 v11, 16, v209
    v_and_b32 v12, 0xffff0000, v209
    v_add_f32 v11, v11, v224
    v_add_f32 v12, v12, v224
    v_add_f32 v18, v18, v11
    v_add_f32 v19, v19, v12
    v_lshlrev_b32 v11, 16, v210
    v_and_b32 v12, 0xffff0000, v210
    v_add_f32 v11, v11, v224
    v_add_f32 v12, v12, v224
    v_add_f32 v20, v20, v11
    v_add_f32 v21, v21, v12
    v_lshlrev_b32 v11, 16, v211
    v_and_b32 v12, 0xffff0000, v211
    v_add_f32 v11, v11, v224
    v_add_f32 v12, v12, v224
    v_add_f32 v22, v22, v11
    v_add_f32 v23, v23, v12
    v_lshlrev_b32 v11, 16, v212
    v_and_b32 v12, 0xffff0000, v212
    v_add_f32 v11, v11, v224
    v_add_f32 v12, v12, v224
    v_add_f32 v24, v24, v11
    v_add_f32 v25, v25, v12
    v_lshlrev_b32 v11, 16, v213
    v_and_b32 v12, 0xffff0000, v213
    v_add_f32 v11, v11, v224
    v_add_f32 v12, v12, v224
    v_add_f32 v26, v26, v11
    v_add_f32 v27, v27, v12
    v_lshlrev_b32 v11, 16, v214
    v_and_b32 v12, 0xffff0000, v214
    v_add_f32 v11, v11, v224
    v_add_f32 v12, v12, v224
    v_add_f32 v28, v28, v11
    v_add_f32 v29, v29, v12
    v_lshlrev_b32 v11, 16, v215
    v_and_b32 v12, 0xffff0000, v215
    v_add_f32 v11, v11, v224
    v_add_f32 v12, v12, v224
    v_add_f32 v30, v30, v11
    v_add_f32 v31, v31, v12
    v_lshlrev_b32 v11, 16, v216
    v_and_b32 v12, 0xffff0000, v216
    v_add_f32 v11, v11, v224
    v_add_f32 v12, v12, v224
    v_add_f32 v32, v32, v11
    v_add_f32 v33, v33, v12
    v_lshlrev_b32 v11, 16, v217
    v_and_b32 v12, 0xffff0000, v217
    v_add_f32 v11, v11, v224
    v_add_f32 v12, v12, v224
    v_add_f32 v34, v34, v11
    v_add_f32 v35, v35, v12
    v_lshlrev_b32 v11, 16, v218
    v_and_b32 v12, 0xffff0000, v218
    v_add_f32 v11, v11, v224
    v_add_f32 v12, v12, v224
    v_add_f32 v36, v36, v11
    v_add_f32 v37, v37, v12
    v_lshlrev_b32 v11, 16, v219
    v_and_b32 v12, 0xffff0000, v219
    v_add_f32 v11, v11, v224
    v_add_f32 v12, v12, v224
    v_add_f32 v38, v38, v11
    v_add_f32 v39, v39, v12
    v_lshlrev_b32 v11, 16, v220
    v_and_b32 v12, 0xffff0000, v220
    v_add_f32 v11, v11, v224
    v_add_f32 v12, v12, v224
    v_add_f32 v40, v40, v11
    v_add_f32 v41, v41, v12
    v_lshlrev_b32 v11, 16, v221
    v_and_b32 v12, 0xffff0000, v221
    v_add_f32 v11, v11, v224
    v_add_f32 v12, v12, v224
    v_add_f32 v42, v42, v11
    v_add_f32 v43, v43, v12
    v_lshlrev_b32 v11, 16, v222
    v_and_b32 v12, 0xffff0000, v222
    v_add_f32 v11, v11, v224
    v_add_f32 v12, v12, v224
    v_add_f32 v44, v44, v11
    v_add_f32 v45, v45, v12
    v_lshlrev_b32 v11, 16, v223
    v_and_b32 v12, 0xffff0000, v223
    v_add_f32 v11, v11, v224
    v_add_f32 v12, v12, v224
    v_add_f32 v46, v46, v11
    v_add_f32 v47, v47, v12
    v_mov_b32 v226, 0
    v_mov_b32 v227, 1
    s_lshl_b32 s35, s35, 7
    s_lshl_b32 s39, s36, 7
    s_waitcnt vmcnt(0)
    buffer_store_dword v227, v226, s[12:15], s35 offen sc1
    s_mov_b32 s16, s42
    s_and_b32 s17, s43, 0xffff
    s_mov_b32 s18, 4194304
    s_mov_b32 s19, 0x20000
    s_lshl_b32 s45, s24, 12
    v_and_b32 v11, 15, v0
    v_lshrrev_b32 v12, 1, v11
    v_lshrrev_b32 v13, 5, v0
    v_xor_b32 v12, v12, v13
    v_lshlrev_b32 v12, 4, v12
    v_lshl_add_u32 v12, v11, 7, v12
    v_bfe_u32 v13, v0, 4, 1
    v_lshl_add_u32 v12, v13, 3, v12
    v_add_u32 v80, s45, v12
    v_xor_b32 v81, 32, v80
    v_xor_b32 v82, 64, v80
    v_xor_b32 v83, 96, v80
    s_lshl_b32 s34, s60, 15
    s_lshl_b32 s47, s26, 8
    s_add_u32 s34, s34, s47
    v_lshrrev_b32 v11, 3, v0
    v_lshlrev_b32 v11, 11, v11
    v_add_u32 v11, s34, v11
    v_and_b32 v12, 7, v0
    v_lshrrev_b32 v13, 4, v0
    v_xor_b32 v12, v12, v13
    v_lshl_add_u32 v84, v12, 4, v11
    v_xor_b32 v12, 4, v12
    v_lshl_add_u32 v85, v12, 4, v11
    v_add_u32 v85, 16384, v85
    s_mov_b32 s44, 0x8000
L_k3_ffn_kernel_5_poll:
    v_mov_b32 v11, 0
    s_mov_b64 exec, 1
    buffer_atomic_or v11, v226, s[12:15], s39 offen sc0 sc1
    s_mov_b64 exec, -1
    s_waitcnt vmcnt(0)
    v_readfirstlane_b32 s34, v11
    s_sub_u32 s44, s44, 1
    s_cmp_eq_u32 s44, 0
    s_cbranch_scc1 L_k3_ffn_kernel_5_got
    s_cmp_lg_u32 s34, 1
    s_cbranch_scc1 L_k3_ffn_kernel_5_poll
L_k3_ffn_kernel_5_got:
    s_lshl_b32 s37, s36, 13
    s_add_u32 s38, s37, 4096
    buffer_load_dwordx4 v[144:147], v10, s[8:11], s37 offen offset:0 sc1
    buffer_load_dwordx4 v[148:151], v10, s[8:11], s37 offen offset:1024 sc1
    buffer_load_dwordx4 v[152:155], v10, s[8:11], s37 offen offset:2048 sc1
    buffer_load_dwordx4 v[156:159], v10, s[8:11], s37 offen offset:3072 sc1
    buffer_load_dwordx4 v[160:163], v10, s[8:11], s38 offen offset:0 sc1
    buffer_load_dwordx4 v[164:167], v10, s[8:11], s38 offen offset:1024 sc1
    buffer_load_dwordx4 v[168:171], v10, s[8:11], s38 offen offset:2048 sc1
    buffer_load_dwordx4 v[172:175], v10, s[8:11], s38 offen offset:3072 sc1
    s_barrier
    s_waitcnt vmcnt(7)
    v_add_f32 v16, v16, v144
    v_add_f32 v17, v17, v145
    v_add_f32 v18, v18, v146
    v_add_f32 v19, v19, v147
    v_cvt_pk_bf16_f32 v16, v16, v17
    v_cvt_pk_bf16_f32 v17, v18, v19
    ds_write_b64 v80, v[16:17] offset:0
    s_waitcnt vmcnt(6)
    v_add_f32 v20, v20, v148
    v_add_f32 v21, v21, v149
    v_add_f32 v22, v22, v150
    v_add_f32 v23, v23, v151
    v_cvt_pk_bf16_f32 v20, v20, v21
    v_cvt_pk_bf16_f32 v21, v22, v23
    ds_write_b64 v81, v[20:21] offset:0
    s_waitcnt vmcnt(5)
    v_add_f32 v24, v24, v152
    v_add_f32 v25, v25, v153
    v_add_f32 v26, v26, v154
    v_add_f32 v27, v27, v155
    v_cvt_pk_bf16_f32 v24, v24, v25
    v_cvt_pk_bf16_f32 v25, v26, v27
    ds_write_b64 v82, v[24:25] offset:0
    s_waitcnt vmcnt(4)
    v_add_f32 v28, v28, v156
    v_add_f32 v29, v29, v157
    v_add_f32 v30, v30, v158
    v_add_f32 v31, v31, v159
    v_cvt_pk_bf16_f32 v28, v28, v29
    v_cvt_pk_bf16_f32 v29, v30, v31
    ds_write_b64 v83, v[28:29] offset:0
    s_waitcnt vmcnt(3)
    v_add_f32 v32, v32, v160
    v_add_f32 v33, v33, v161
    v_add_f32 v34, v34, v162
    v_add_f32 v35, v35, v163
    v_cvt_pk_bf16_f32 v32, v32, v33
    v_cvt_pk_bf16_f32 v33, v34, v35
    ds_write_b64 v80, v[32:33] offset:2048
    s_waitcnt vmcnt(2)
    v_add_f32 v36, v36, v164
    v_add_f32 v37, v37, v165
    v_add_f32 v38, v38, v166
    v_add_f32 v39, v39, v167
    v_cvt_pk_bf16_f32 v36, v36, v37
    v_cvt_pk_bf16_f32 v37, v38, v39
    ds_write_b64 v81, v[36:37] offset:2048
    s_waitcnt vmcnt(1)
    v_add_f32 v40, v40, v168
    v_add_f32 v41, v41, v169
    v_add_f32 v42, v42, v170
    v_add_f32 v43, v43, v171
    v_cvt_pk_bf16_f32 v40, v40, v41
    v_cvt_pk_bf16_f32 v41, v42, v43
    ds_write_b64 v82, v[40:41] offset:2048
    s_waitcnt vmcnt(0)
    v_add_f32 v44, v44, v172
    v_add_f32 v45, v45, v173
    v_add_f32 v46, v46, v174
    v_add_f32 v47, v47, v175
    v_cvt_pk_bf16_f32 v44, v44, v45
    v_cvt_pk_bf16_f32 v45, v46, v47
    ds_write_b64 v83, v[44:45] offset:2048
    v_lshlrev_b32 v11, 4, v0
    v_add_u32 v11, s45, v11
    s_waitcnt lgkmcnt(0)
    ds_read_b128 v[88:91], v11 offset:0
    ds_read_b128 v[92:95], v11 offset:1024
    ds_read_b128 v[96:99], v11 offset:2048
    ds_read_b128 v[100:103], v11 offset:3072
    s_waitcnt lgkmcnt(3)
    buffer_store_dwordx4 v[88:91], v84, s[16:19], 0 offen offset:0
    s_waitcnt lgkmcnt(2)
    buffer_store_dwordx4 v[92:95], v85, s[16:19], 0 offen offset:0
    s_waitcnt lgkmcnt(1)
    buffer_store_dwordx4 v[96:99], v84, s[16:19], 0 offen offset:128
    s_waitcnt lgkmcnt(0)
    buffer_store_dwordx4 v[100:103], v85, s[16:19], 0 offen offset:128
    s_branch L_k3_ffn_kernel_5_done
L_k3_ffn_kernel_5_g1r:
    s_lshl_b32 s33, s25, 1
    s_add_u32 s33, s33, s27
    s_lshl_b32 s33, s33, 8
    s_add_u32 s46, s4, 61898880
    s_addc_u32 s47, s5, 0
    v_mov_b32 v12, s33
    global_load_dword v228, v12, s[46:47] sc1
    s_branch L_k3_ffn_kernel_5_g1b
L_k3_ffn_kernel_5_g1c:
    v_readfirstlane_b32 s34, v228
    s_nop 0
    s_cmp_ge_u32 s34, 32
    s_cbranch_scc1 L_k3_ffn_kernel_5_g1b
    s_lshl_b32 s33, s25, 1
    s_add_u32 s33, s33, s27
    s_lshl_b32 s33, s33, 8
    s_add_u32 s46, s4, 61898880
    s_addc_u32 s47, s5, 0
    v_mov_b32 v12, s33
    s_mov_b32 s37, 0x8000
L_k3_ffn_kernel_sp1:
    global_load_dword v13, v12, s[46:47] sc1
    s_waitcnt vmcnt(0)
    v_readfirstlane_b32 s34, v13
    s_sub_u32 s37, s37, 1
    s_cmp_eq_u32 s37, 0
    s_cbranch_scc1 L_k3_ffn_kernel_sg1
    s_cmp_lt_u32 s34, 32
    s_cbranch_scc1 L_k3_ffn_kernel_sp1
L_k3_ffn_kernel_sg1:
    s_branch L_k3_ffn_kernel_5_g1b
L_k3_ffn_kernel_5_done:
L_k3_ffn_kernel_end:
    s_endpgm
.section .rodata,"a"
.p2align 6
.amdhsa_kernel k2_attn_kernel
  .amdhsa_next_free_vgpr 188
  .amdhsa_next_free_sgpr 102
  .amdhsa_accum_offset 188
  .amdhsa_group_segment_fixed_size 0
  .amdhsa_kernarg_size 96
  .amdhsa_user_sgpr_count 2
  .amdhsa_user_sgpr_kernarg_segment_ptr 1
  .amdhsa_system_sgpr_workgroup_id_x 1
  .amdhsa_float_denorm_mode_32 3
.end_amdhsa_kernel

.p2align 6
.amdhsa_kernel k3_ffn_kernel
  .amdhsa_next_free_vgpr 432
  .amdhsa_next_free_sgpr 102
  .amdhsa_accum_offset 256
  .amdhsa_group_segment_fixed_size 0
  .amdhsa_kernarg_size 96
  .amdhsa_user_sgpr_count 2
  .amdhsa_user_sgpr_kernarg_segment_ptr 1
  .amdhsa_system_sgpr_workgroup_id_x 1
  .amdhsa_float_denorm_mode_32 3
.end_amdhsa_kernel
```
